```python
import torch

def _softmax(x, axis=-1):
    return torch.softmax(x, dim=axis)
def _gelu(x):
    return torch.nn.functional.gelu(x, approximate="tanh")
def _silu(x):
    return torch.nn.functional.silu(x)
def _sigmoid(x):
    return torch.sigmoid(x)
def _layernorm(x, axis=-1, eps=1e-5):
    m = x.mean(dim=axis, keepdim=True)
    v = x.var(dim=axis, keepdim=True, unbiased=False)
    return (x - m) / torch.sqrt(v + eps)
def _scatter_add(tgt, idx, src, axis=0):
    return tgt.clone().index_add_(axis, idx, src)
def _segment_sum(src, seg, n):
    out = torch.zeros((n,) + src.shape[1:], dtype=src.dtype)
    return out.index_add_(0, seg, src)
def _pad(x, pw):
    flat = tuple(v for pair in reversed(pw) for v in pair)
    return torch.nn.functional.pad(x, flat)

kernel_name = 'parallel_sum__grouped_kv_mqa__mixer_token_mlp__prompt'

def setup_inputs():

    _w = (lambda a: (lambda t: t.to(torch.bfloat16) if t.is_floating_point() else t)(torch.as_tensor(a)))
    def _A_setup():
        B, S, D, H = 1, 2048, 640, 32
        Dh = D // H
        return {
            "x": _w((lambda *s: torch.randn(*s, dtype=torch.bfloat16) * 0.05)(B, S, D)),
            "wq": _w((lambda *s: torch.randn(*s, dtype=torch.bfloat16) * 0.05)(D, H * Dh)),
            "wk": _w((lambda *s: torch.randn(*s, dtype=torch.bfloat16) * 0.05)(D, Dh)),
            "wv": _w((lambda *s: torch.randn(*s, dtype=torch.bfloat16) * 0.05)(D, Dh)),
            "wo": _w((lambda *s: torch.randn(*s, dtype=torch.bfloat16) * 0.05)(H * Dh, D)),
        }
    _A_in = _A_setup()

    def _B_setup():
        B, S, D, F = 1, 2048, 640, 1728
        return {
            "x": _w((lambda *s: torch.randn(*s, dtype=torch.bfloat16) * 0.05)(B, S, D)),
            "w1": _w((lambda *s: torch.randn(*s, dtype=torch.bfloat16) * 1.6)(S, F) * (S ** -0.5)),
            "b1": _w((lambda *s: torch.randn(*s, dtype=torch.bfloat16) * 12.8)(F) * 0.02),
            "w2": _w((lambda *s: torch.randn(*s, dtype=torch.bfloat16) * 0.8)(F, S) * (F ** -0.5)),
            "b2": _w((lambda *s: torch.randn(*s, dtype=torch.bfloat16) * 12.8)(S) * 0.02),
        }
    _B_in = _B_setup()

    return {
        "A_x": _A_in["x"],
        "A_wq": _A_in["wq"],
        "A_wk": _A_in["wk"],
        "A_wv": _A_in["wv"],
        "A_wo": _A_in["wo"],
        "B_x": _B_in["x"],
        "B_w1": _B_in["w1"],
        "B_b1": _B_in["b1"],
        "B_w2": _B_in["w2"],
        "B_b2": _B_in["b2"],
    }

def reference(A_x, A_wq, A_wk, A_wv, A_wo, B_x, B_w1, B_b1, B_w2, B_b2):
    def _A_ref(x, wq, wk, wv, wo):
        B, S, D = x.shape
        H = 32
        Dh = D // H
        q = (lambda x, *d: x.permute(*d))((x @ wq).reshape(B, S, H, Dh), 0, 2, 1, 3)
        k = x @ wk
        v = x @ wv
        scores = torch.einsum("bhqd,bkd->bhqk", q, k) * (Dh ** -0.5)
        p = _softmax(scores, axis=-1)
        o = torch.einsum("bhqk,bkd->bhqd", p, v)
        return (lambda x, *d: x.permute(*d))(o, 0, 2, 1, 3).reshape(B, S, H * Dh) @ wo

    def _B_ref(x, w1, b1, w2, b2):
        B, S, D = x.shape
        h = _layernorm(x, axis=-1)
        u = torch.einsum("bsd,sf->bdf", h, w1) + b1
        u = _gelu(u)
        y = torch.einsum("bdf,fs->bds", u, w2) + b2
        return (lambda x, *d: x.permute(*d))(y, 0, 2, 1)

    x = A_x
    xn = _layernorm(x, axis=-1)
    return x + _A_ref(xn, A_wq, A_wk, A_wv, A_wo) + _B_ref(xn, B_w1, B_b1, B_w2, B_b2)
```

```asm
; @launch grid=(256,1,1) block=(768,1,1) lds=162048
.amdgcn_target "amdgcn-amd-amdhsa--gfx950"
.text
.globl parallel_sum__grouped_kv_mqa__mixer_token_mlp__prompt_kernel
.p2align 8
.type parallel_sum__grouped_kv_mqa__mixer_token_mlp__prompt_kernel,@function
parallel_sum__grouped_kv_mqa__mixer_token_mlp__prompt_kernel:
    s_cmp_ge_u32 s2, 256
    s_cbranch_scc1 K1_end
    s_load_dwordx8 s[4:11], s[0:1], 0
    s_load_dwordx2 s[14:15], s[0:1], 96
    s_load_dwordx2 s[68:69], s[0:1], 48
    s_load_dwordx2 s[12:13], s[0:1], 88
    v_lshrrev_b32 v1, 6, v0
    v_and_b32 v0, 63, v0
    s_and_b32 s16, s2, 7
    v_readfirstlane_b32 s19, v1
    s_lshl_b32 s16, s16, 2
    s_bfe_u32 s49, s2, 0x20003
    s_add_u32 s16, s16, s49
    s_lshr_b32 s17, s2, 5
    s_and_b32 s52, s19, 3
    s_add_u32 s18, s49, s17
    s_mul_i32 s50, s18, 205
    s_lshr_b32 s50, s50, 10
    s_mul_i32 s50, s50, 5
    s_sub_u32 s18, s18, s50
    s_mul_i32 s18, s18, 2
    s_cmp_lt_u32 s19, 8
    s_cbranch_scc1 K1_comp
    s_setprio 2
    v_lshrrev_b32 v1, 3, v0
    v_and_b32 v2, 7, v0
    v_lshrrev_b32 v4, 1, v1
    v_xor_b32 v4, v4, v2
    s_lshl_b32 s49, s16, 2
    s_add_u32 s49, s49, s52
    s_mul_i32 s49, s49, 20480
    v_mul_u32_u24 v3, 1280, v1
    v_lshl_add_u32 v12, v4, 4, v3
    v_add_u32 v12, s49, v12
    v_xor_b32 v13, 64, v12
    v_add_u32 v13, 9216, v13
    s_lshl_b32 s48, s52, 11
    s_waitcnt lgkmcnt(0)
    s_mov_b32 s20, s4
    s_mov_b32 s21, s5
    s_mov_b32 s22, 2621440
    s_mov_b32 s23, 0x20000
    s_cmp_ge_u32 s17, 4
    s_cbranch_scc1 K1_lno
    s_add_u32 s44, s18, 0
    s_sub_u32 s43, s44, 10
    s_cselect_b32 s44, s44, s43
    s_add_u32 m0, s48, 0
    s_lshl_b32 s44, s44, 7
    buffer_load_dwordx4 v12, s[20:23], s44 offen offset:0 lds
    buffer_load_dwordx4 v13, s[20:23], s44 offen offset:1024 lds
    s_add_u32 s44, s18, 1
    s_sub_u32 s43, s44, 10
    s_cselect_b32 s44, s44, s43
    s_add_u32 m0, s48, 8192
    s_lshl_b32 s44, s44, 7
    buffer_load_dwordx4 v12, s[20:23], s44 offen offset:0 lds
    buffer_load_dwordx4 v13, s[20:23], s44 offen offset:1024 lds
    v_lshrrev_b32 v3, 1, v0
    v_and_b32 v17, 0x13, v3
    v_bfe_u32 v4, v3, 2, 1
    v_lshl_or_b32 v17, v4, 3, v17
    v_bfe_u32 v4, v3, 3, 1
    v_lshl_or_b32 v17, v4, 2, v17
    v_mul_u32_u24 v17, 40, v17
    v_and_b32 v3, 1, v0
    v_lshl_add_u32 v17, v3, 4, v17
    s_lshl_b32 s45, s52, 10
    s_mul_i32 s46, s52, 1280
    s_and_b32 s49, s17, 1
    s_lshl_b32 s49, s49, 5
    s_add_u32 s46, s46, s49
    s_cmp_ge_u32 s17, 2
    s_cselect_b32 s8, s10, s8
    s_cselect_b32 s9, s11, s9
    s_mov_b32 s28, s8
    s_mov_b32 s29, s9
    s_mov_b32 s30, 25600
    s_mov_b32 s31, 0x20000
    s_add_u32 s44, s18, 0
    s_sub_u32 s43, s44, 10
    s_cselect_b32 s44, s44, s43
    s_mul_i32 s44, s44, 2560
    s_add_u32 m0, s45, 81920
    s_add_u32 s44, s44, s46
    buffer_load_dwordx4 v17, s[28:31], s44 offen lds
    s_add_u32 s44, s18, 2
    s_sub_u32 s43, s44, 10
    s_cselect_b32 s44, s44, s43
    s_add_u32 m0, s48, 16384
    s_lshl_b32 s44, s44, 7
    buffer_load_dwordx4 v12, s[20:23], s44 offen offset:0 lds
    buffer_load_dwordx4 v13, s[20:23], s44 offen offset:1024 lds
    s_add_u32 s44, s18, 3
    s_sub_u32 s43, s44, 10
    s_cselect_b32 s44, s44, s43
    s_add_u32 m0, s48, 24576
    s_lshl_b32 s44, s44, 7
    buffer_load_dwordx4 v12, s[20:23], s44 offen offset:0 lds
    buffer_load_dwordx4 v13, s[20:23], s44 offen offset:1024 lds
    s_add_u32 s44, s18, 2
    s_sub_u32 s43, s44, 10
    s_cselect_b32 s44, s44, s43
    s_mul_i32 s44, s44, 2560
    s_add_u32 m0, s45, 86016
    s_add_u32 s44, s44, s46
    buffer_load_dwordx4 v17, s[28:31], s44 offen lds
    s_add_u32 s44, s18, 4
    s_sub_u32 s43, s44, 10
    s_cselect_b32 s44, s44, s43
    s_add_u32 m0, s48, 32768
    s_lshl_b32 s44, s44, 7
    buffer_load_dwordx4 v12, s[20:23], s44 offen offset:0 lds
    buffer_load_dwordx4 v13, s[20:23], s44 offen offset:1024 lds
    s_add_u32 s44, s18, 5
    s_sub_u32 s43, s44, 10
    s_cselect_b32 s44, s44, s43
    s_add_u32 m0, s48, 40960
    s_lshl_b32 s44, s44, 7
    buffer_load_dwordx4 v12, s[20:23], s44 offen offset:0 lds
    buffer_load_dwordx4 v13, s[20:23], s44 offen offset:1024 lds
    s_add_u32 s44, s18, 4
    s_sub_u32 s43, s44, 10
    s_cselect_b32 s44, s44, s43
    s_mul_i32 s44, s44, 2560
    s_add_u32 m0, s45, 90112
    s_add_u32 s44, s44, s46
    buffer_load_dwordx4 v17, s[28:31], s44 offen lds
    s_add_u32 s44, s18, 6
    s_sub_u32 s43, s44, 10
    s_cselect_b32 s44, s44, s43
    s_add_u32 m0, s48, 49152
    s_lshl_b32 s44, s44, 7
    buffer_load_dwordx4 v12, s[20:23], s44 offen offset:0 lds
    buffer_load_dwordx4 v13, s[20:23], s44 offen offset:1024 lds
    s_add_u32 s44, s18, 7
    s_sub_u32 s43, s44, 10
    s_cselect_b32 s44, s44, s43
    s_add_u32 m0, s48, 57344
    s_lshl_b32 s44, s44, 7
    buffer_load_dwordx4 v12, s[20:23], s44 offen offset:0 lds
    buffer_load_dwordx4 v13, s[20:23], s44 offen offset:1024 lds
    s_add_u32 s44, s18, 6
    s_sub_u32 s43, s44, 10
    s_cselect_b32 s44, s44, s43
    s_mul_i32 s44, s44, 2560
    s_add_u32 m0, s45, 94208
    s_add_u32 s44, s44, s46
    buffer_load_dwordx4 v17, s[28:31], s44 offen lds
    s_add_u32 s44, s18, 8
    s_sub_u32 s43, s44, 10
    s_cselect_b32 s44, s44, s43
    s_add_u32 m0, s48, 65536
    s_lshl_b32 s44, s44, 7
    buffer_load_dwordx4 v12, s[20:23], s44 offen offset:0 lds
    buffer_load_dwordx4 v13, s[20:23], s44 offen offset:1024 lds
    s_add_u32 s44, s18, 9
    s_sub_u32 s43, s44, 10
    s_cselect_b32 s44, s44, s43
    s_add_u32 m0, s48, 73728
    s_lshl_b32 s44, s44, 7
    buffer_load_dwordx4 v12, s[20:23], s44 offen offset:0 lds
    buffer_load_dwordx4 v13, s[20:23], s44 offen offset:1024 lds
    s_add_u32 s44, s18, 8
    s_sub_u32 s43, s44, 10
    s_cselect_b32 s44, s44, s43
    s_mul_i32 s44, s44, 2560
    s_add_u32 m0, s45, 98304
    s_add_u32 s44, s44, s46
    buffer_load_dwordx4 v17, s[28:31], s44 offen lds
    v_lshrrev_b32 v1, 3, v0
    v_and_b32 v2, 7, v0
    v_bfe_u32 v4, v1, 1, 1
    v_lshlrev_b32 v4, 2, v4
    v_xor_b32 v4, v4, v2
    v_mul_u32_u24 v3, 1280, v1
    v_lshl_add_u32 v14, v4, 4, v3
    v_xor_b32 v15, 32, v14
    v_add_u32 v15, 9216, v15
    s_mul_i32 s47, s52, 20480
    s_mul_i32 s49, s17, 160
    s_add_u32 s47, s47, s49
    s_lshl_b32 s51, s52, 9
    s_lshl_b32 s48, s52, 11
    v_bfe_u32 v3, v0, 1, 4
    v_and_b32 v16, 0x13, v3
    v_bfe_u32 v4, v3, 2, 1
    v_lshl_or_b32 v16, v4, 3, v16
    v_bfe_u32 v4, v3, 3, 1
    v_lshl_or_b32 v16, v4, 2, v16
    v_mul_u32_u24 v16, 1280, v16
    v_and_b32 v3, 1, v0
    v_lshl_add_u32 v16, v3, 4, v16
    v_add_u32 v16, 128, v16
    s_mov_b32 s24, s6
    s_mov_b32 s25, s7
    s_mov_b32 s26, 819200
    s_mov_b32 s27, 0x20000
    v_and_b32 v5, 15, v0
    v_lshrrev_b32 v6, 4, v0
    v_lshrrev_b32 v3, 1, v5
    v_xor_b32 v3, v3, v6
    v_lshl_add_u32 v4, v5, 7, s48
    v_lshl_add_u32 v18, v3, 4, v4
    v_xor_b32 v19, 64, v18
    v_and_b32 v24, 3, v0
    v_lshlrev_b32 v24, 2, v24
    v_mov_b32 v8, 0x3f803f80
    v_mov_b32 v9, 0x3f803f80
    v_mov_b32 v10, 0x3f803f80
    v_mov_b32 v11, 0x3f803f80
    s_waitcnt vmcnt(23)
    ds_read_b128 v[28:31], v18 offset:0
    ds_read_b128 v[32:35], v19 offset:0
    v_lshrrev_b32 v1, 2, v5
    v_cmp_eq_u32 s[60:61], v1, v6
    v_and_b32 v2, 3, v5
    v_cmp_eq_u32 s[62:63], 1, v2
    v_cmp_eq_u32 s[64:65], 2, v2
    v_cmp_eq_u32 s[66:67], 3, v2
    s_lshl_b32 s49, s52, 8
    s_add_u32 s49, s49, 160000
    v_lshl_add_u32 v20, v5, 4, s49
    s_lshl_b32 s49, s52, 6
    s_add_u32 s50, s49, 161024
    v_lshl_add_u32 v21, v5, 2, s50
    s_add_u32 s50, s49, 161536
    v_lshl_add_u32 v22, v5, 2, s50
    v_lshl_add_u32 v2, v6, 3, v1
    v_and_b32 v3, 1, v5
    v_lshlrev_b32 v3, 3, v3
    v_lshl_add_u32 v25, v2, 7, v3
    v_bfe_u32 v2, v5, 3, 1
    v_lshlrev_b32 v2, 2, v2
    v_and_b32 v3, 1, v6
    v_lshl_or_b32 v2, v3, 1, v2
    v_bfe_u32 v4, v5, 1, 1
    s_lshl_b32 s49, s52, 1
    v_add_u32 v4, s49, v4
    v_xor_b32 v2, v2, v4
    v_lshl_add_u32 v25, v2, 4, v25
    v_add_u32 v25, 102400, v25
    v_add_u32 v27, 4096, v25
    v_lshl_add_u32 v1, v3, 2, v1
    v_lshrrev_b32 v2, 5, v0
    v_lshl_add_u32 v1, v2, 4, v1
    v_and_b32 v2, 3, v5
    v_lshlrev_b32 v2, 3, v2
    v_lshl_add_u32 v1, v1, 5, v2
    s_and_b32 s49, s52, 1
    s_lshl_b32 s49, s49, 10
    s_add_u32 s49, s49, 110592
    v_add_u32 v26, s49, v1
    s_waitcnt lgkmcnt(0)
    s_waitcnt vmcnt(20)
    ds_read_b128 v[36:39], v18 offset:8192
    ds_read_b128 v[40:43], v19 offset:8192
    v_mfma_f32_16x16x32_bf16 v[68:71], v[28:31], v[28:31], 0
    v_mfma_f32_16x16x32_bf16 v[72:75], v[8:11], v[28:31], 0
    v_mfma_f32_16x16x32_bf16 v[68:71], v[32:35], v[32:35], v[68:71]
    v_mfma_f32_16x16x32_bf16 v[72:75], v[8:11], v[32:35], v[72:75]
    s_waitcnt lgkmcnt(0)
    s_waitcnt vmcnt(18)
    ds_read_b128 v[28:31], v18 offset:16384
    ds_read_b128 v[32:35], v19 offset:16384
    v_mfma_f32_16x16x32_bf16 v[68:71], v[36:39], v[36:39], v[68:71]
    v_mfma_f32_16x16x32_bf16 v[72:75], v[8:11], v[36:39], v[72:75]
    v_mfma_f32_16x16x32_bf16 v[68:71], v[40:43], v[40:43], v[68:71]
    v_mfma_f32_16x16x32_bf16 v[72:75], v[8:11], v[40:43], v[72:75]
    s_waitcnt lgkmcnt(0)
    s_waitcnt vmcnt(15)
    ds_read_b128 v[36:39], v18 offset:24576
    ds_read_b128 v[40:43], v19 offset:24576
    v_mfma_f32_16x16x32_bf16 v[68:71], v[28:31], v[28:31], v[68:71]
    v_mfma_f32_16x16x32_bf16 v[72:75], v[8:11], v[28:31], v[72:75]
    v_mfma_f32_16x16x32_bf16 v[68:71], v[32:35], v[32:35], v[68:71]
    v_mfma_f32_16x16x32_bf16 v[72:75], v[8:11], v[32:35], v[72:75]
    s_waitcnt lgkmcnt(0)
    s_waitcnt vmcnt(13)
    ds_read_b128 v[28:31], v18 offset:32768
    ds_read_b128 v[32:35], v19 offset:32768
    v_mfma_f32_16x16x32_bf16 v[68:71], v[36:39], v[36:39], v[68:71]
    v_mfma_f32_16x16x32_bf16 v[72:75], v[8:11], v[36:39], v[72:75]
    v_mfma_f32_16x16x32_bf16 v[68:71], v[40:43], v[40:43], v[68:71]
    v_mfma_f32_16x16x32_bf16 v[72:75], v[8:11], v[40:43], v[72:75]
    s_waitcnt lgkmcnt(0)
    s_waitcnt vmcnt(10)
    s_barrier
    ds_read_b128 v[36:39], v18 offset:40960
    ds_read_b128 v[40:43], v19 offset:40960
    v_mfma_f32_16x16x32_bf16 v[68:71], v[28:31], v[28:31], v[68:71]
    v_mfma_f32_16x16x32_bf16 v[72:75], v[8:11], v[28:31], v[72:75]
    v_mfma_f32_16x16x32_bf16 v[68:71], v[32:35], v[32:35], v[68:71]
    v_mfma_f32_16x16x32_bf16 v[72:75], v[8:11], v[32:35], v[72:75]
    s_waitcnt lgkmcnt(0)
    s_waitcnt vmcnt(8)
    ds_read_b128 v[28:31], v18 offset:49152
    ds_read_b128 v[32:35], v19 offset:49152
    v_add_u32 v18, 57344, v18
    v_add_u32 v19, 57344, v19
    v_mfma_f32_16x16x32_bf16 v[68:71], v[36:39], v[36:39], v[68:71]
    v_mfma_f32_16x16x32_bf16 v[72:75], v[8:11], v[36:39], v[72:75]
    v_mfma_f32_16x16x32_bf16 v[68:71], v[40:43], v[40:43], v[68:71]
    v_mfma_f32_16x16x32_bf16 v[72:75], v[8:11], v[40:43], v[72:75]
    s_waitcnt lgkmcnt(0)
    s_waitcnt vmcnt(5)
    ds_read_b128 v[36:39], v18 offset:0
    ds_read_b128 v[40:43], v19 offset:0
    v_mfma_f32_16x16x32_bf16 v[68:71], v[28:31], v[28:31], v[68:71]
    v_mfma_f32_16x16x32_bf16 v[72:75], v[8:11], v[28:31], v[72:75]
    v_mfma_f32_16x16x32_bf16 v[68:71], v[32:35], v[32:35], v[68:71]
    v_mfma_f32_16x16x32_bf16 v[72:75], v[8:11], v[32:35], v[72:75]
    global_load_dword v23, v24, s[12:13] sc1
    s_waitcnt lgkmcnt(0)
    s_waitcnt vmcnt(4)
    ds_read_b128 v[28:31], v18 offset:8192
    ds_read_b128 v[32:35], v19 offset:8192
    v_mfma_f32_16x16x32_bf16 v[68:71], v[36:39], v[36:39], v[68:71]
    v_mfma_f32_16x16x32_bf16 v[72:75], v[8:11], v[36:39], v[72:75]
    v_mfma_f32_16x16x32_bf16 v[68:71], v[40:43], v[40:43], v[68:71]
    v_mfma_f32_16x16x32_bf16 v[72:75], v[8:11], v[40:43], v[72:75]
    s_waitcnt lgkmcnt(0)
    s_waitcnt vmcnt(1)
    s_barrier
    ds_read_b128 v[36:39], v18 offset:16384
    ds_read_b128 v[40:43], v19 offset:16384
    v_mfma_f32_16x16x32_bf16 v[68:71], v[28:31], v[28:31], v[68:71]
    v_mfma_f32_16x16x32_bf16 v[72:75], v[8:11], v[28:31], v[72:75]
    v_mfma_f32_16x16x32_bf16 v[68:71], v[32:35], v[32:35], v[68:71]
    v_mfma_f32_16x16x32_bf16 v[72:75], v[8:11], v[32:35], v[72:75]
    s_waitcnt lgkmcnt(0)
    v_mfma_f32_16x16x32_bf16 v[68:71], v[36:39], v[36:39], v[68:71]
    v_mfma_f32_16x16x32_bf16 v[72:75], v[8:11], v[36:39], v[72:75]
    v_mfma_f32_16x16x32_bf16 v[68:71], v[40:43], v[40:43], v[68:71]
    v_mfma_f32_16x16x32_bf16 v[72:75], v[8:11], v[40:43], v[72:75]
    s_setprio 3
    s_nop 5
    v_cndmask_b32 v89, v68, v69, s[62:63]
    v_cndmask_b32 v89, v89, v70, s[64:65]
    v_cndmask_b32 v89, v89, v71, s[66:67]
    v_mul_f32 v88, 0x3acccccd, v72
    v_mul_f32 v89, 0x3acccccd, v89
    v_fma_f32 v89, -v88, v88, v89
    v_max_f32 v89, 0, v89
    v_cvt_pk_bf16_f32 v92, v89, v89
    v_and_b32 v92, 0xffff0000, v92
    v_cvt_pk_bf16_f32 v90, v88, v88
    v_and_b32 v90, 0xffff0000, v90
    v_add_f32 v92, 0x3727c5ac, v92
    v_cvt_pk_bf16_f32 v92, v92, v92
    v_and_b32 v92, 0xffff0000, v92
    v_sqrt_f32 v92, v92
    v_sub_f32 v91, v88, v90
    v_cvt_pk_bf16_f32 v92, v92, v92
    v_and_b32 v92, 0xffff0000, v92
    v_rcp_f32 v84, v92
    s_nop 0
    v_mul_f32 v93, v89, v84
    v_mul_f32 v85, -v90, v84
    v_mul_f32 v93, v93, v84
    v_mul_f32 v91, v91, v84
    v_cvt_pk_bf16_f32 v93, v93, v93
    v_and_b32 v93, 0xffff0000, v93
    v_cvt_pk_bf16_f32 v91, v91, v91
    v_and_b32 v91, 0xffff0000, v91
    v_add_f32 v93, 0x3727c5ac, v93
    v_mul_f32 v86, 0x3ea52b5c, v84
    v_cvt_pk_bf16_f32 v93, v93, v93
    v_and_b32 v93, 0xffff0000, v93
    v_sqrt_f32 v93, v93
    v_mul_f32 v87, 0x3ea52b5c, v85
    v_sub_f32 v96, v85, v91
    v_cvt_pk_bf16_f32 v93, v93, v93
    v_and_b32 v93, 0xffff0000, v93
    v_rcp_f32 v94, v93
    s_mov_b64 exec, s[60:61]
    ds_write_b128 v20, v[84:87]
    v_mul_f32 v95, v84, v94
    v_mul_f32 v96, v96, v94
    ds_write_b32 v21, v95
    ds_write_b32 v21, v96 offset:256
    s_mov_b64 exec, -1
    s_waitcnt lgkmcnt(0)
    s_barrier
    s_setprio 2
    s_barrier
    ds_read_b64_tr_b16 v[44:45], v25 offset:0
    ds_read_b64_tr_b16 v[46:47], v25 offset:512
    ds_read_b64_tr_b16 v[48:49], v27 offset:0
    ds_read_b64_tr_b16 v[50:51], v27 offset:512
    ds_read_b64_tr_b16 v[52:53], v26 offset:0
    ds_read_b64_tr_b16 v[54:55], v26 offset:256
    s_waitcnt lgkmcnt(0)
    s_barrier
    s_add_u32 s44, s18, 5
    s_sub_u32 s43, s44, 10
    s_cselect_b32 s44, s44, s43
    s_mul_i32 s44, s44, 81920
    s_add_u32 m0, s48, 102400
    s_add_u32 s44, s44, s47
    buffer_load_dwordx4 v14, s[24:27], s44 offen offset:0 lds
    buffer_load_dwordx4 v15, s[24:27], s44 offen offset:1024 lds
    s_add_u32 m0, s51, 110592
    s_mov_b32 exec_hi, 0
    buffer_load_dwordx4 v16, s[24:27], s44 offen lds
    s_mov_b32 exec_hi, -1
    ds_read_b64_tr_b16 v[56:57], v25 offset:10240
    ds_read_b64_tr_b16 v[58:59], v25 offset:10752
    ds_read_b64_tr_b16 v[60:61], v27 offset:10240
    ds_read_b64_tr_b16 v[62:63], v27 offset:10752
    ds_read_b64_tr_b16 v[64:65], v26 offset:10240
    ds_read_b64_tr_b16 v[66:67], v26 offset:10496
    v_mfma_f32_16x16x32_bf16 v[76:79], v[8:11], v[44:47], 0
    v_mfma_f32_16x16x32_bf16 v[76:79], v[8:11], v[48:51], v[76:79]
    v_mfma_f32_16x16x32_bf16 v[80:83], v[8:11], v[52:55], 0
    s_waitcnt lgkmcnt(0)
    s_barrier
    s_add_u32 s44, s18, 6
    s_sub_u32 s43, s44, 10
    s_cselect_b32 s44, s44, s43
    s_mul_i32 s44, s44, 81920
    s_add_u32 m0, s48, 112640
    s_add_u32 s44, s44, s47
    buffer_load_dwordx4 v14, s[24:27], s44 offen offset:0 lds
    buffer_load_dwordx4 v15, s[24:27], s44 offen offset:1024 lds
    s_add_u32 m0, s51, 120832
    s_mov_b32 exec_hi, 0
    buffer_load_dwordx4 v16, s[24:27], s44 offen lds
    s_mov_b32 exec_hi, -1
    ds_read_b64_tr_b16 v[44:45], v25 offset:20480
    ds_read_b64_tr_b16 v[46:47], v25 offset:20992
    ds_read_b64_tr_b16 v[48:49], v27 offset:20480
    ds_read_b64_tr_b16 v[50:51], v27 offset:20992
    ds_read_b64_tr_b16 v[52:53], v26 offset:20480
    ds_read_b64_tr_b16 v[54:55], v26 offset:20736
    v_mfma_f32_16x16x32_bf16 v[76:79], v[8:11], v[56:59], v[76:79]
    v_mfma_f32_16x16x32_bf16 v[76:79], v[8:11], v[60:63], v[76:79]
    v_mfma_f32_16x16x32_bf16 v[80:83], v[8:11], v[64:67], v[80:83]
    s_waitcnt lgkmcnt(0)
    s_barrier
    s_add_u32 s44, s18, 7
    s_sub_u32 s43, s44, 10
    s_cselect_b32 s44, s44, s43
    s_mul_i32 s44, s44, 81920
    s_add_u32 m0, s48, 122880
    s_add_u32 s44, s44, s47
    buffer_load_dwordx4 v14, s[24:27], s44 offen offset:0 lds
    buffer_load_dwordx4 v15, s[24:27], s44 offen offset:1024 lds
    s_add_u32 m0, s51, 131072
    s_mov_b32 exec_hi, 0
    buffer_load_dwordx4 v16, s[24:27], s44 offen lds
    s_mov_b32 exec_hi, -1
    s_cmp_lg_u32 s19, 8
    s_cbranch_scc1 K1_lk_np
    s_mov_b32 s53, 0x40000
    s_waitcnt vmcnt(9)
K1_lk_c:
    v_cmp_ne_u32 vcc, 1, v23
    s_cbranch_vccz K1_lk_cx
    global_load_dword v23, v24, s[12:13] sc1
    s_sleep 2
    s_sub_u32 s53, s53, 1
    s_waitcnt vmcnt(0)
    s_cbranch_scc0 K1_lk_c
K1_lk_cx:
    s_lshl_b32 s49, s2, 2
    s_add_u32 s49, s49, 12070912
    v_lshl_add_u32 v1, v0, 10, s49
    v_mov_b32 v2, 1
    s_mov_b32 exec_hi, 0
    global_store_dword v1, v2, s[14:15] sc1
    s_mov_b32 exec_hi, -1
K1_lk_np:
    ds_read_b64_tr_b16 v[56:57], v25 offset:30720
    ds_read_b64_tr_b16 v[58:59], v25 offset:31232
    ds_read_b64_tr_b16 v[60:61], v27 offset:30720
    ds_read_b64_tr_b16 v[62:63], v27 offset:31232
    ds_read_b64_tr_b16 v[64:65], v26 offset:30720
    ds_read_b64_tr_b16 v[66:67], v26 offset:30976
    v_mfma_f32_16x16x32_bf16 v[76:79], v[8:11], v[44:47], v[76:79]
    v_mfma_f32_16x16x32_bf16 v[76:79], v[8:11], v[48:51], v[76:79]
    v_mfma_f32_16x16x32_bf16 v[80:83], v[8:11], v[52:55], v[80:83]
    s_waitcnt lgkmcnt(0)
    s_barrier
    s_add_u32 s44, s18, 8
    s_sub_u32 s43, s44, 10
    s_cselect_b32 s44, s44, s43
    s_mul_i32 s44, s44, 81920
    s_add_u32 m0, s48, 133120
    s_add_u32 s44, s44, s47
    buffer_load_dwordx4 v14, s[24:27], s44 offen offset:0 lds
    buffer_load_dwordx4 v15, s[24:27], s44 offen offset:1024 lds
    s_add_u32 m0, s51, 141312
    s_mov_b32 exec_hi, 0
    buffer_load_dwordx4 v16, s[24:27], s44 offen lds
    s_mov_b32 exec_hi, -1
    ds_read_b64_tr_b16 v[44:45], v25 offset:40960
    ds_read_b64_tr_b16 v[46:47], v25 offset:41472
    ds_read_b64_tr_b16 v[48:49], v27 offset:40960
    ds_read_b64_tr_b16 v[50:51], v27 offset:41472
    ds_read_b64_tr_b16 v[52:53], v26 offset:40960
    ds_read_b64_tr_b16 v[54:55], v26 offset:41216
    v_mfma_f32_16x16x32_bf16 v[76:79], v[8:11], v[56:59], v[76:79]
    v_mfma_f32_16x16x32_bf16 v[76:79], v[8:11], v[60:63], v[76:79]
    v_mfma_f32_16x16x32_bf16 v[80:83], v[8:11], v[64:67], v[80:83]
    s_waitcnt lgkmcnt(0)
    s_waitcnt vmcnt(9)
    s_barrier
    s_add_u32 s44, s18, 9
    s_sub_u32 s43, s44, 10
    s_cselect_b32 s44, s44, s43
    s_mul_i32 s44, s44, 81920
    s_add_u32 m0, s48, 143360
    s_add_u32 s44, s44, s47
    buffer_load_dwordx4 v14, s[24:27], s44 offen offset:0 lds
    buffer_load_dwordx4 v15, s[24:27], s44 offen offset:1024 lds
    s_add_u32 m0, s51, 151552
    s_mov_b32 exec_hi, 0
    buffer_load_dwordx4 v16, s[24:27], s44 offen lds
    s_mov_b32 exec_hi, -1
    v_mul_u32_u24 v1, 205, v0
    v_lshrrev_b32 v1, 10, v1
    v_mul_u32_u24 v2, 5, v1
    v_sub_u32 v2, v0, v2
    v_mul_u32_u24 v1, 3456, v1
    v_lshl_add_u32 v1, v2, 7, v1
    s_and_b32 s49, s2, 7
    s_mul_i32 s49, s49, 27
    s_lshr_b32 s49, s49, 3
    s_lshl_b32 s49, s49, 7
    s_lshr_b32 s50, s2, 3
    s_lshl_b32 s50, s50, 2
    s_add_u32 s50, s50, s52
    s_mul_i32 s50, s50, 13824
    s_add_u32 s49, s49, s50
    s_mov_b32 s28, s68
    s_mov_b32 s29, s69
    s_mov_b32 s30, 7077888
    s_mov_b32 s31, 0x20000
    s_mov_b64 exec, 0xfffff
    buffer_load_dword v28, v1, s[28:31], s49 offen
    s_add_u32 s49, s49, 1769472
    s_mov_b64 exec, -1
    ds_read_b64_tr_b16 v[56:57], v25 offset:0
    ds_read_b64_tr_b16 v[58:59], v25 offset:512
    ds_read_b64_tr_b16 v[60:61], v27 offset:0
    ds_read_b64_tr_b16 v[62:63], v27 offset:512
    ds_read_b64_tr_b16 v[64:65], v26 offset:0
    ds_read_b64_tr_b16 v[66:67], v26 offset:256
    v_mfma_f32_16x16x32_bf16 v[76:79], v[8:11], v[44:47], v[76:79]
    v_mfma_f32_16x16x32_bf16 v[76:79], v[8:11], v[48:51], v[76:79]
    v_mfma_f32_16x16x32_bf16 v[80:83], v[8:11], v[52:55], v[80:83]
    s_waitcnt lgkmcnt(0)
    s_waitcnt vmcnt(10)
    s_barrier
    ds_read_b64_tr_b16 v[44:45], v25 offset:10240
    ds_read_b64_tr_b16 v[46:47], v25 offset:10752
    ds_read_b64_tr_b16 v[48:49], v27 offset:10240
    ds_read_b64_tr_b16 v[50:51], v27 offset:10752
    ds_read_b64_tr_b16 v[52:53], v26 offset:10240
    ds_read_b64_tr_b16 v[54:55], v26 offset:10496
    v_mfma_f32_16x16x32_bf16 v[76:79], v[8:11], v[56:59], v[76:79]
    v_mfma_f32_16x16x32_bf16 v[76:79], v[8:11], v[60:63], v[76:79]
    v_mfma_f32_16x16x32_bf16 v[80:83], v[8:11], v[64:67], v[80:83]
    s_waitcnt lgkmcnt(0)
    s_waitcnt vmcnt(7)
    s_barrier
    ds_read_b64_tr_b16 v[56:57], v25 offset:20480
    ds_read_b64_tr_b16 v[58:59], v25 offset:20992
    ds_read_b64_tr_b16 v[60:61], v27 offset:20480
    ds_read_b64_tr_b16 v[62:63], v27 offset:20992
    ds_read_b64_tr_b16 v[64:65], v26 offset:20480
    ds_read_b64_tr_b16 v[66:67], v26 offset:20736
    v_mfma_f32_16x16x32_bf16 v[76:79], v[8:11], v[44:47], v[76:79]
    v_mfma_f32_16x16x32_bf16 v[76:79], v[8:11], v[48:51], v[76:79]
    v_mfma_f32_16x16x32_bf16 v[80:83], v[8:11], v[52:55], v[80:83]
    s_waitcnt lgkmcnt(0)
    s_waitcnt vmcnt(4)
    s_barrier
    ds_read_b64_tr_b16 v[44:45], v25 offset:30720
    ds_read_b64_tr_b16 v[46:47], v25 offset:31232
    ds_read_b64_tr_b16 v[48:49], v27 offset:30720
    ds_read_b64_tr_b16 v[50:51], v27 offset:31232
    ds_read_b64_tr_b16 v[52:53], v26 offset:30720
    ds_read_b64_tr_b16 v[54:55], v26 offset:30976
    v_mfma_f32_16x16x32_bf16 v[76:79], v[8:11], v[56:59], v[76:79]
    v_mfma_f32_16x16x32_bf16 v[76:79], v[8:11], v[60:63], v[76:79]
    v_mfma_f32_16x16x32_bf16 v[80:83], v[8:11], v[64:67], v[80:83]
    s_waitcnt lgkmcnt(0)
    s_waitcnt vmcnt(1)
    s_barrier
    ds_read_b64_tr_b16 v[56:57], v25 offset:40960
    ds_read_b64_tr_b16 v[58:59], v25 offset:41472
    ds_read_b64_tr_b16 v[60:61], v27 offset:40960
    ds_read_b64_tr_b16 v[62:63], v27 offset:41472
    ds_read_b64_tr_b16 v[64:65], v26 offset:40960
    ds_read_b64_tr_b16 v[66:67], v26 offset:41216
    v_mfma_f32_16x16x32_bf16 v[76:79], v[8:11], v[44:47], v[76:79]
    v_mfma_f32_16x16x32_bf16 v[76:79], v[8:11], v[48:51], v[76:79]
    v_mfma_f32_16x16x32_bf16 v[80:83], v[8:11], v[52:55], v[80:83]
    s_waitcnt lgkmcnt(0)
    v_mfma_f32_16x16x32_bf16 v[76:79], v[8:11], v[56:59], v[76:79]
    v_mfma_f32_16x16x32_bf16 v[76:79], v[8:11], v[60:63], v[76:79]
    v_mfma_f32_16x16x32_bf16 v[80:83], v[8:11], v[64:67], v[80:83]
    s_mov_b64 exec, 0xffff
    s_nop 5
    ds_write_b32 v22, v76
    s_cmp_lt_u32 s52, 2
    s_cselect_b64 exec, exec, 0
    ds_write_b32 v22, v80 offset:256
    s_mov_b64 exec, -1
    s_waitcnt lgkmcnt(0)
    s_barrier
    s_branch P2_entry
K1_lno:
    s_add_u32 s44, s18, 0
    s_sub_u32 s43, s44, 10
    s_cselect_b32 s44, s44, s43
    s_add_u32 m0, s48, 0
    s_lshl_b32 s44, s44, 7
    buffer_load_dwordx4 v12, s[20:23], s44 offen offset:0 lds
    buffer_load_dwordx4 v13, s[20:23], s44 offen offset:1024 lds
    s_add_u32 s44, s18, 1
    s_sub_u32 s43, s44, 10
    s_cselect_b32 s44, s44, s43
    s_add_u32 m0, s48, 8192
    s_lshl_b32 s44, s44, 7
    buffer_load_dwordx4 v12, s[20:23], s44 offen offset:0 lds
    buffer_load_dwordx4 v13, s[20:23], s44 offen offset:1024 lds
    s_add_u32 s44, s18, 2
    s_sub_u32 s43, s44, 10
    s_cselect_b32 s44, s44, s43
    s_add_u32 m0, s48, 16384
    s_lshl_b32 s44, s44, 7
    buffer_load_dwordx4 v12, s[20:23], s44 offen offset:0 lds
    buffer_load_dwordx4 v13, s[20:23], s44 offen offset:1024 lds
    s_add_u32 s44, s18, 3
    s_sub_u32 s43, s44, 10
    s_cselect_b32 s44, s44, s43
    s_add_u32 m0, s48, 24576
    s_lshl_b32 s44, s44, 7
    buffer_load_dwordx4 v12, s[20:23], s44 offen offset:0 lds
    buffer_load_dwordx4 v13, s[20:23], s44 offen offset:1024 lds
    s_add_u32 s44, s18, 4
    s_sub_u32 s43, s44, 10
    s_cselect_b32 s44, s44, s43
    s_add_u32 m0, s48, 32768
    s_lshl_b32 s44, s44, 7
    buffer_load_dwordx4 v12, s[20:23], s44 offen offset:0 lds
    buffer_load_dwordx4 v13, s[20:23], s44 offen offset:1024 lds
    s_add_u32 s44, s18, 5
    s_sub_u32 s43, s44, 10
    s_cselect_b32 s44, s44, s43
    s_add_u32 m0, s48, 40960
    s_lshl_b32 s44, s44, 7
    buffer_load_dwordx4 v12, s[20:23], s44 offen offset:0 lds
    buffer_load_dwordx4 v13, s[20:23], s44 offen offset:1024 lds
    s_add_u32 s44, s18, 6
    s_sub_u32 s43, s44, 10
    s_cselect_b32 s44, s44, s43
    s_add_u32 m0, s48, 49152
    s_lshl_b32 s44, s44, 7
    buffer_load_dwordx4 v12, s[20:23], s44 offen offset:0 lds
    buffer_load_dwordx4 v13, s[20:23], s44 offen offset:1024 lds
    s_add_u32 s44, s18, 7
    s_sub_u32 s43, s44, 10
    s_cselect_b32 s44, s44, s43
    s_add_u32 m0, s48, 57344
    s_lshl_b32 s44, s44, 7
    buffer_load_dwordx4 v12, s[20:23], s44 offen offset:0 lds
    buffer_load_dwordx4 v13, s[20:23], s44 offen offset:1024 lds
    s_add_u32 s44, s18, 8
    s_sub_u32 s43, s44, 10
    s_cselect_b32 s44, s44, s43
    s_add_u32 m0, s48, 65536
    s_lshl_b32 s44, s44, 7
    buffer_load_dwordx4 v12, s[20:23], s44 offen offset:0 lds
    buffer_load_dwordx4 v13, s[20:23], s44 offen offset:1024 lds
    s_add_u32 s44, s18, 9
    s_sub_u32 s43, s44, 10
    s_cselect_b32 s44, s44, s43
    s_add_u32 m0, s48, 73728
    s_lshl_b32 s44, s44, 7
    buffer_load_dwordx4 v12, s[20:23], s44 offen offset:0 lds
    buffer_load_dwordx4 v13, s[20:23], s44 offen offset:1024 lds
    v_lshrrev_b32 v1, 3, v0
    v_and_b32 v2, 7, v0
    v_bfe_u32 v4, v1, 1, 1
    v_lshlrev_b32 v4, 2, v4
    v_xor_b32 v4, v4, v2
    v_mul_u32_u24 v3, 1280, v1
    v_lshl_add_u32 v14, v4, 4, v3
    v_xor_b32 v15, 32, v14
    v_add_u32 v15, 9216, v15
    s_mul_i32 s47, s52, 20480
    s_mul_i32 s49, s17, 160
    s_add_u32 s47, s47, s49
    s_lshl_b32 s51, s52, 9
    s_lshl_b32 s48, s52, 11
    v_bfe_u32 v3, v0, 1, 4
    v_and_b32 v16, 0x13, v3
    v_bfe_u32 v4, v3, 2, 1
    v_lshl_or_b32 v16, v4, 3, v16
    v_bfe_u32 v4, v3, 3, 1
    v_lshl_or_b32 v16, v4, 2, v16
    v_mul_u32_u24 v16, 1280, v16
    v_and_b32 v3, 1, v0
    v_lshl_add_u32 v16, v3, 4, v16
    v_add_u32 v16, 128, v16
    s_mov_b32 s24, s6
    s_mov_b32 s25, s7
    s_mov_b32 s26, 819200
    s_mov_b32 s27, 0x20000
    v_and_b32 v5, 15, v0
    v_lshrrev_b32 v6, 4, v0
    v_lshrrev_b32 v3, 1, v5
    v_xor_b32 v3, v3, v6
    v_lshl_add_u32 v4, v5, 7, s48
    v_lshl_add_u32 v18, v3, 4, v4
    v_xor_b32 v19, 64, v18
    v_and_b32 v24, 3, v0
    v_lshlrev_b32 v24, 2, v24
    v_mov_b32 v8, 0x3f803f80
    v_mov_b32 v9, 0x3f803f80
    v_mov_b32 v10, 0x3f803f80
    v_mov_b32 v11, 0x3f803f80
    s_waitcnt vmcnt(18)
    ds_read_b128 v[28:31], v18 offset:0
    ds_read_b128 v[32:35], v19 offset:0
    v_lshrrev_b32 v1, 2, v5
    v_cmp_eq_u32 s[60:61], v1, v6
    v_and_b32 v2, 3, v5
    v_cmp_eq_u32 s[62:63], 1, v2
    v_cmp_eq_u32 s[64:65], 2, v2
    v_cmp_eq_u32 s[66:67], 3, v2
    s_lshl_b32 s49, s52, 8
    s_add_u32 s49, s49, 160000
    v_lshl_add_u32 v20, v5, 4, s49
    s_lshl_b32 s49, s52, 6
    s_add_u32 s50, s49, 161024
    v_lshl_add_u32 v21, v5, 2, s50
    s_add_u32 s50, s49, 161536
    v_lshl_add_u32 v22, v5, 2, s50
    v_lshl_add_u32 v2, v6, 3, v1
    v_and_b32 v3, 1, v5
    v_lshlrev_b32 v3, 3, v3
    v_lshl_add_u32 v25, v2, 7, v3
    v_bfe_u32 v2, v5, 3, 1
    v_lshlrev_b32 v2, 2, v2
    v_and_b32 v3, 1, v6
    v_lshl_or_b32 v2, v3, 1, v2
    v_bfe_u32 v4, v5, 1, 1
    s_lshl_b32 s49, s52, 1
    v_add_u32 v4, s49, v4
    v_xor_b32 v2, v2, v4
    v_lshl_add_u32 v25, v2, 4, v25
    v_add_u32 v25, 102400, v25
    v_add_u32 v27, 4096, v25
    v_lshl_add_u32 v1, v3, 2, v1
    v_lshrrev_b32 v2, 5, v0
    v_lshl_add_u32 v1, v2, 4, v1
    v_and_b32 v2, 3, v5
    v_lshlrev_b32 v2, 3, v2
    v_lshl_add_u32 v1, v1, 5, v2
    s_and_b32 s49, s52, 1
    s_lshl_b32 s49, s49, 10
    s_add_u32 s49, s49, 110592
    v_add_u32 v26, s49, v1
    s_waitcnt lgkmcnt(0)
    s_waitcnt vmcnt(16)
    ds_read_b128 v[36:39], v18 offset:8192
    ds_read_b128 v[40:43], v19 offset:8192
    v_mfma_f32_16x16x32_bf16 v[68:71], v[28:31], v[28:31], 0
    v_mfma_f32_16x16x32_bf16 v[72:75], v[8:11], v[28:31], 0
    v_mfma_f32_16x16x32_bf16 v[68:71], v[32:35], v[32:35], v[68:71]
    v_mfma_f32_16x16x32_bf16 v[72:75], v[8:11], v[32:35], v[72:75]
    s_waitcnt lgkmcnt(0)
    s_waitcnt vmcnt(14)
    ds_read_b128 v[28:31], v18 offset:16384
    ds_read_b128 v[32:35], v19 offset:16384
    v_mfma_f32_16x16x32_bf16 v[68:71], v[36:39], v[36:39], v[68:71]
    v_mfma_f32_16x16x32_bf16 v[72:75], v[8:11], v[36:39], v[72:75]
    v_mfma_f32_16x16x32_bf16 v[68:71], v[40:43], v[40:43], v[68:71]
    v_mfma_f32_16x16x32_bf16 v[72:75], v[8:11], v[40:43], v[72:75]
    s_waitcnt lgkmcnt(0)
    s_waitcnt vmcnt(12)
    ds_read_b128 v[36:39], v18 offset:24576
    ds_read_b128 v[40:43], v19 offset:24576
    v_mfma_f32_16x16x32_bf16 v[68:71], v[28:31], v[28:31], v[68:71]
    v_mfma_f32_16x16x32_bf16 v[72:75], v[8:11], v[28:31], v[72:75]
    v_mfma_f32_16x16x32_bf16 v[68:71], v[32:35], v[32:35], v[68:71]
    v_mfma_f32_16x16x32_bf16 v[72:75], v[8:11], v[32:35], v[72:75]
    s_waitcnt lgkmcnt(0)
    s_waitcnt vmcnt(10)
    ds_read_b128 v[28:31], v18 offset:32768
    ds_read_b128 v[32:35], v19 offset:32768
    v_mfma_f32_16x16x32_bf16 v[68:71], v[36:39], v[36:39], v[68:71]
    v_mfma_f32_16x16x32_bf16 v[72:75], v[8:11], v[36:39], v[72:75]
    v_mfma_f32_16x16x32_bf16 v[68:71], v[40:43], v[40:43], v[68:71]
    v_mfma_f32_16x16x32_bf16 v[72:75], v[8:11], v[40:43], v[72:75]
    s_waitcnt lgkmcnt(0)
    s_waitcnt vmcnt(8)
    s_barrier
    ds_read_b128 v[36:39], v18 offset:40960
    ds_read_b128 v[40:43], v19 offset:40960
    v_mfma_f32_16x16x32_bf16 v[68:71], v[28:31], v[28:31], v[68:71]
    v_mfma_f32_16x16x32_bf16 v[72:75], v[8:11], v[28:31], v[72:75]
    v_mfma_f32_16x16x32_bf16 v[68:71], v[32:35], v[32:35], v[68:71]
    v_mfma_f32_16x16x32_bf16 v[72:75], v[8:11], v[32:35], v[72:75]
    s_waitcnt lgkmcnt(0)
    s_waitcnt vmcnt(6)
    ds_read_b128 v[28:31], v18 offset:49152
    ds_read_b128 v[32:35], v19 offset:49152
    v_add_u32 v18, 57344, v18
    v_add_u32 v19, 57344, v19
    v_mfma_f32_16x16x32_bf16 v[68:71], v[36:39], v[36:39], v[68:71]
    v_mfma_f32_16x16x32_bf16 v[72:75], v[8:11], v[36:39], v[72:75]
    v_mfma_f32_16x16x32_bf16 v[68:71], v[40:43], v[40:43], v[68:71]
    v_mfma_f32_16x16x32_bf16 v[72:75], v[8:11], v[40:43], v[72:75]
    s_waitcnt lgkmcnt(0)
    s_waitcnt vmcnt(4)
    ds_read_b128 v[36:39], v18 offset:0
    ds_read_b128 v[40:43], v19 offset:0
    v_mfma_f32_16x16x32_bf16 v[68:71], v[28:31], v[28:31], v[68:71]
    v_mfma_f32_16x16x32_bf16 v[72:75], v[8:11], v[28:31], v[72:75]
    v_mfma_f32_16x16x32_bf16 v[68:71], v[32:35], v[32:35], v[68:71]
    v_mfma_f32_16x16x32_bf16 v[72:75], v[8:11], v[32:35], v[72:75]
    global_load_dword v23, v24, s[12:13] sc1
    s_waitcnt lgkmcnt(0)
    s_waitcnt vmcnt(3)
    ds_read_b128 v[28:31], v18 offset:8192
    ds_read_b128 v[32:35], v19 offset:8192
    v_mfma_f32_16x16x32_bf16 v[68:71], v[36:39], v[36:39], v[68:71]
    v_mfma_f32_16x16x32_bf16 v[72:75], v[8:11], v[36:39], v[72:75]
    v_mfma_f32_16x16x32_bf16 v[68:71], v[40:43], v[40:43], v[68:71]
    v_mfma_f32_16x16x32_bf16 v[72:75], v[8:11], v[40:43], v[72:75]
    s_waitcnt lgkmcnt(0)
    s_waitcnt vmcnt(1)
    s_barrier
    ds_read_b128 v[36:39], v18 offset:16384
    ds_read_b128 v[40:43], v19 offset:16384
    v_mfma_f32_16x16x32_bf16 v[68:71], v[28:31], v[28:31], v[68:71]
    v_mfma_f32_16x16x32_bf16 v[72:75], v[8:11], v[28:31], v[72:75]
    v_mfma_f32_16x16x32_bf16 v[68:71], v[32:35], v[32:35], v[68:71]
    v_mfma_f32_16x16x32_bf16 v[72:75], v[8:11], v[32:35], v[72:75]
    s_waitcnt lgkmcnt(0)
    v_mfma_f32_16x16x32_bf16 v[68:71], v[36:39], v[36:39], v[68:71]
    v_mfma_f32_16x16x32_bf16 v[72:75], v[8:11], v[36:39], v[72:75]
    v_mfma_f32_16x16x32_bf16 v[68:71], v[40:43], v[40:43], v[68:71]
    v_mfma_f32_16x16x32_bf16 v[72:75], v[8:11], v[40:43], v[72:75]
    s_setprio 3
    s_nop 5
    v_cndmask_b32 v89, v68, v69, s[62:63]
    v_cndmask_b32 v89, v89, v70, s[64:65]
    v_cndmask_b32 v89, v89, v71, s[66:67]
    v_mul_f32 v88, 0x3acccccd, v72
    v_mul_f32 v89, 0x3acccccd, v89
    v_fma_f32 v89, -v88, v88, v89
    v_max_f32 v89, 0, v89
    v_cvt_pk_bf16_f32 v92, v89, v89
    v_and_b32 v92, 0xffff0000, v92
    v_cvt_pk_bf16_f32 v90, v88, v88
    v_and_b32 v90, 0xffff0000, v90
    v_add_f32 v92, 0x3727c5ac, v92
    v_cvt_pk_bf16_f32 v92, v92, v92
    v_and_b32 v92, 0xffff0000, v92
    v_sqrt_f32 v92, v92
    v_sub_f32 v91, v88, v90
    v_cvt_pk_bf16_f32 v92, v92, v92
    v_and_b32 v92, 0xffff0000, v92
    v_rcp_f32 v84, v92
    s_nop 0
    v_mul_f32 v93, v89, v84
    v_mul_f32 v85, -v90, v84
    v_mul_f32 v93, v93, v84
    v_mul_f32 v91, v91, v84
    v_cvt_pk_bf16_f32 v93, v93, v93
    v_and_b32 v93, 0xffff0000, v93
    v_cvt_pk_bf16_f32 v91, v91, v91
    v_and_b32 v91, 0xffff0000, v91
    v_add_f32 v93, 0x3727c5ac, v93
    v_mul_f32 v86, 0x3ea52b5c, v84
    v_cvt_pk_bf16_f32 v93, v93, v93
    v_and_b32 v93, 0xffff0000, v93
    v_sqrt_f32 v93, v93
    v_mul_f32 v87, 0x3ea52b5c, v85
    v_sub_f32 v96, v85, v91
    v_cvt_pk_bf16_f32 v93, v93, v93
    v_and_b32 v93, 0xffff0000, v93
    v_rcp_f32 v94, v93
    s_mov_b64 exec, s[60:61]
    ds_write_b128 v20, v[84:87]
    v_mul_f32 v95, v84, v94
    v_mul_f32 v96, v96, v94
    ds_write_b32 v21, v95
    ds_write_b32 v21, v96 offset:256
    s_mov_b64 exec, -1
    s_waitcnt lgkmcnt(0)
    s_barrier
    s_setprio 2
    s_barrier
    ds_read_b64_tr_b16 v[44:45], v25 offset:0
    ds_read_b64_tr_b16 v[46:47], v25 offset:512
    ds_read_b64_tr_b16 v[48:49], v27 offset:0
    ds_read_b64_tr_b16 v[50:51], v27 offset:512
    ds_read_b64_tr_b16 v[52:53], v26 offset:0
    ds_read_b64_tr_b16 v[54:55], v26 offset:256
    s_waitcnt lgkmcnt(0)
    s_barrier
    s_add_u32 s44, s18, 5
    s_sub_u32 s43, s44, 10
    s_cselect_b32 s44, s44, s43
    s_mul_i32 s44, s44, 81920
    s_add_u32 m0, s48, 102400
    s_add_u32 s44, s44, s47
    buffer_load_dwordx4 v14, s[24:27], s44 offen offset:0 lds
    buffer_load_dwordx4 v15, s[24:27], s44 offen offset:1024 lds
    s_add_u32 m0, s51, 110592
    s_mov_b32 exec_hi, 0
    buffer_load_dwordx4 v16, s[24:27], s44 offen lds
    s_mov_b32 exec_hi, -1
    ds_read_b64_tr_b16 v[56:57], v25 offset:10240
    ds_read_b64_tr_b16 v[58:59], v25 offset:10752
    ds_read_b64_tr_b16 v[60:61], v27 offset:10240
    ds_read_b64_tr_b16 v[62:63], v27 offset:10752
    ds_read_b64_tr_b16 v[64:65], v26 offset:10240
    ds_read_b64_tr_b16 v[66:67], v26 offset:10496
    v_mfma_f32_16x16x32_bf16 v[76:79], v[8:11], v[44:47], 0
    v_mfma_f32_16x16x32_bf16 v[76:79], v[8:11], v[48:51], v[76:79]
    v_mfma_f32_16x16x32_bf16 v[80:83], v[8:11], v[52:55], 0
    s_waitcnt lgkmcnt(0)
    s_barrier
    s_add_u32 s44, s18, 6
    s_sub_u32 s43, s44, 10
    s_cselect_b32 s44, s44, s43
    s_mul_i32 s44, s44, 81920
    s_add_u32 m0, s48, 112640
    s_add_u32 s44, s44, s47
    buffer_load_dwordx4 v14, s[24:27], s44 offen offset:0 lds
    buffer_load_dwordx4 v15, s[24:27], s44 offen offset:1024 lds
    s_add_u32 m0, s51, 120832
    s_mov_b32 exec_hi, 0
    buffer_load_dwordx4 v16, s[24:27], s44 offen lds
    s_mov_b32 exec_hi, -1
    ds_read_b64_tr_b16 v[44:45], v25 offset:20480
    ds_read_b64_tr_b16 v[46:47], v25 offset:20992
    ds_read_b64_tr_b16 v[48:49], v27 offset:20480
    ds_read_b64_tr_b16 v[50:51], v27 offset:20992
    ds_read_b64_tr_b16 v[52:53], v26 offset:20480
    ds_read_b64_tr_b16 v[54:55], v26 offset:20736
    v_mfma_f32_16x16x32_bf16 v[76:79], v[8:11], v[56:59], v[76:79]
    v_mfma_f32_16x16x32_bf16 v[76:79], v[8:11], v[60:63], v[76:79]
    v_mfma_f32_16x16x32_bf16 v[80:83], v[8:11], v[64:67], v[80:83]
    s_waitcnt lgkmcnt(0)
    s_barrier
    s_add_u32 s44, s18, 7
    s_sub_u32 s43, s44, 10
    s_cselect_b32 s44, s44, s43
    s_mul_i32 s44, s44, 81920
    s_add_u32 m0, s48, 122880
    s_add_u32 s44, s44, s47
    buffer_load_dwordx4 v14, s[24:27], s44 offen offset:0 lds
    buffer_load_dwordx4 v15, s[24:27], s44 offen offset:1024 lds
    s_add_u32 m0, s51, 131072
    s_mov_b32 exec_hi, 0
    buffer_load_dwordx4 v16, s[24:27], s44 offen lds
    s_mov_b32 exec_hi, -1
    s_cmp_lg_u32 s19, 8
    s_cbranch_scc1 K1_ln_np
    s_mov_b32 s53, 0x40000
    s_waitcnt vmcnt(9)
K1_ln_c:
    v_cmp_ne_u32 vcc, 1, v23
    s_cbranch_vccz K1_ln_cx
    global_load_dword v23, v24, s[12:13] sc1
    s_sleep 2
    s_sub_u32 s53, s53, 1
    s_waitcnt vmcnt(0)
    s_cbranch_scc0 K1_ln_c
K1_ln_cx:
    s_lshl_b32 s49, s2, 2
    s_add_u32 s49, s49, 12070912
    v_lshl_add_u32 v1, v0, 10, s49
    v_mov_b32 v2, 1
    s_mov_b32 exec_hi, 0
    global_store_dword v1, v2, s[14:15] sc1
    s_mov_b32 exec_hi, -1
K1_ln_np:
    ds_read_b64_tr_b16 v[56:57], v25 offset:30720
    ds_read_b64_tr_b16 v[58:59], v25 offset:31232
    ds_read_b64_tr_b16 v[60:61], v27 offset:30720
    ds_read_b64_tr_b16 v[62:63], v27 offset:31232
    ds_read_b64_tr_b16 v[64:65], v26 offset:30720
    ds_read_b64_tr_b16 v[66:67], v26 offset:30976
    v_mfma_f32_16x16x32_bf16 v[76:79], v[8:11], v[44:47], v[76:79]
    v_mfma_f32_16x16x32_bf16 v[76:79], v[8:11], v[48:51], v[76:79]
    v_mfma_f32_16x16x32_bf16 v[80:83], v[8:11], v[52:55], v[80:83]
    s_waitcnt lgkmcnt(0)
    s_barrier
    s_add_u32 s44, s18, 8
    s_sub_u32 s43, s44, 10
    s_cselect_b32 s44, s44, s43
    s_mul_i32 s44, s44, 81920
    s_add_u32 m0, s48, 133120
    s_add_u32 s44, s44, s47
    buffer_load_dwordx4 v14, s[24:27], s44 offen offset:0 lds
    buffer_load_dwordx4 v15, s[24:27], s44 offen offset:1024 lds
    s_add_u32 m0, s51, 141312
    s_mov_b32 exec_hi, 0
    buffer_load_dwordx4 v16, s[24:27], s44 offen lds
    s_mov_b32 exec_hi, -1
    ds_read_b64_tr_b16 v[44:45], v25 offset:40960
    ds_read_b64_tr_b16 v[46:47], v25 offset:41472
    ds_read_b64_tr_b16 v[48:49], v27 offset:40960
    ds_read_b64_tr_b16 v[50:51], v27 offset:41472
    ds_read_b64_tr_b16 v[52:53], v26 offset:40960
    ds_read_b64_tr_b16 v[54:55], v26 offset:41216
    v_mfma_f32_16x16x32_bf16 v[76:79], v[8:11], v[56:59], v[76:79]
    v_mfma_f32_16x16x32_bf16 v[76:79], v[8:11], v[60:63], v[76:79]
    v_mfma_f32_16x16x32_bf16 v[80:83], v[8:11], v[64:67], v[80:83]
    s_waitcnt lgkmcnt(0)
    s_waitcnt vmcnt(9)
    s_barrier
    s_add_u32 s44, s18, 9
    s_sub_u32 s43, s44, 10
    s_cselect_b32 s44, s44, s43
    s_mul_i32 s44, s44, 81920
    s_add_u32 m0, s48, 143360
    s_add_u32 s44, s44, s47
    buffer_load_dwordx4 v14, s[24:27], s44 offen offset:0 lds
    buffer_load_dwordx4 v15, s[24:27], s44 offen offset:1024 lds
    s_add_u32 m0, s51, 151552
    s_mov_b32 exec_hi, 0
    buffer_load_dwordx4 v16, s[24:27], s44 offen lds
    s_mov_b32 exec_hi, -1
    v_mul_u32_u24 v1, 205, v0
    v_lshrrev_b32 v1, 10, v1
    v_mul_u32_u24 v2, 5, v1
    v_sub_u32 v2, v0, v2
    v_mul_u32_u24 v1, 3456, v1
    v_lshl_add_u32 v1, v2, 7, v1
    s_and_b32 s49, s2, 7
    s_mul_i32 s49, s49, 27
    s_lshr_b32 s49, s49, 3
    s_lshl_b32 s49, s49, 7
    s_lshr_b32 s50, s2, 3
    s_lshl_b32 s50, s50, 2
    s_add_u32 s50, s50, s52
    s_mul_i32 s50, s50, 13824
    s_add_u32 s49, s49, s50
    s_mov_b32 s28, s68
    s_mov_b32 s29, s69
    s_mov_b32 s30, 7077888
    s_mov_b32 s31, 0x20000
    s_mov_b64 exec, 0xfffff
    buffer_load_dword v28, v1, s[28:31], s49 offen
    s_add_u32 s49, s49, 1769472
    s_mov_b64 exec, -1
    ds_read_b64_tr_b16 v[56:57], v25 offset:0
    ds_read_b64_tr_b16 v[58:59], v25 offset:512
    ds_read_b64_tr_b16 v[60:61], v27 offset:0
    ds_read_b64_tr_b16 v[62:63], v27 offset:512
    ds_read_b64_tr_b16 v[64:65], v26 offset:0
    ds_read_b64_tr_b16 v[66:67], v26 offset:256
    v_mfma_f32_16x16x32_bf16 v[76:79], v[8:11], v[44:47], v[76:79]
    v_mfma_f32_16x16x32_bf16 v[76:79], v[8:11], v[48:51], v[76:79]
    v_mfma_f32_16x16x32_bf16 v[80:83], v[8:11], v[52:55], v[80:83]
    s_waitcnt lgkmcnt(0)
    s_waitcnt vmcnt(10)
    s_barrier
    ds_read_b64_tr_b16 v[44:45], v25 offset:10240
    ds_read_b64_tr_b16 v[46:47], v25 offset:10752
    ds_read_b64_tr_b16 v[48:49], v27 offset:10240
    ds_read_b64_tr_b16 v[50:51], v27 offset:10752
    ds_read_b64_tr_b16 v[52:53], v26 offset:10240
    ds_read_b64_tr_b16 v[54:55], v26 offset:10496
    v_mfma_f32_16x16x32_bf16 v[76:79], v[8:11], v[56:59], v[76:79]
    v_mfma_f32_16x16x32_bf16 v[76:79], v[8:11], v[60:63], v[76:79]
    v_mfma_f32_16x16x32_bf16 v[80:83], v[8:11], v[64:67], v[80:83]
    s_waitcnt lgkmcnt(0)
    s_waitcnt vmcnt(7)
    s_barrier
    ds_read_b64_tr_b16 v[56:57], v25 offset:20480
    ds_read_b64_tr_b16 v[58:59], v25 offset:20992
    ds_read_b64_tr_b16 v[60:61], v27 offset:20480
    ds_read_b64_tr_b16 v[62:63], v27 offset:20992
    ds_read_b64_tr_b16 v[64:65], v26 offset:20480
    ds_read_b64_tr_b16 v[66:67], v26 offset:20736
    v_mfma_f32_16x16x32_bf16 v[76:79], v[8:11], v[44:47], v[76:79]
    v_mfma_f32_16x16x32_bf16 v[76:79], v[8:11], v[48:51], v[76:79]
    v_mfma_f32_16x16x32_bf16 v[80:83], v[8:11], v[52:55], v[80:83]
    s_waitcnt lgkmcnt(0)
    s_waitcnt vmcnt(4)
    s_barrier
    ds_read_b64_tr_b16 v[44:45], v25 offset:30720
    ds_read_b64_tr_b16 v[46:47], v25 offset:31232
    ds_read_b64_tr_b16 v[48:49], v27 offset:30720
    ds_read_b64_tr_b16 v[50:51], v27 offset:31232
    ds_read_b64_tr_b16 v[52:53], v26 offset:30720
    ds_read_b64_tr_b16 v[54:55], v26 offset:30976
    v_mfma_f32_16x16x32_bf16 v[76:79], v[8:11], v[56:59], v[76:79]
    v_mfma_f32_16x16x32_bf16 v[76:79], v[8:11], v[60:63], v[76:79]
    v_mfma_f32_16x16x32_bf16 v[80:83], v[8:11], v[64:67], v[80:83]
    s_waitcnt lgkmcnt(0)
    s_waitcnt vmcnt(1)
    s_barrier
    ds_read_b64_tr_b16 v[56:57], v25 offset:40960
    ds_read_b64_tr_b16 v[58:59], v25 offset:41472
    ds_read_b64_tr_b16 v[60:61], v27 offset:40960
    ds_read_b64_tr_b16 v[62:63], v27 offset:41472
    ds_read_b64_tr_b16 v[64:65], v26 offset:40960
    ds_read_b64_tr_b16 v[66:67], v26 offset:41216
    v_mfma_f32_16x16x32_bf16 v[76:79], v[8:11], v[44:47], v[76:79]
    v_mfma_f32_16x16x32_bf16 v[76:79], v[8:11], v[48:51], v[76:79]
    v_mfma_f32_16x16x32_bf16 v[80:83], v[8:11], v[52:55], v[80:83]
    s_waitcnt lgkmcnt(0)
    v_mfma_f32_16x16x32_bf16 v[76:79], v[8:11], v[56:59], v[76:79]
    v_mfma_f32_16x16x32_bf16 v[76:79], v[8:11], v[60:63], v[76:79]
    v_mfma_f32_16x16x32_bf16 v[80:83], v[8:11], v[64:67], v[80:83]
    s_mov_b64 exec, 0xffff
    s_nop 5
    ds_write_b32 v22, v76
    s_cmp_lt_u32 s52, 2
    s_cselect_b64 exec, exec, 0
    ds_write_b32 v22, v80 offset:256
    s_mov_b64 exec, -1
    s_waitcnt lgkmcnt(0)
    s_barrier
    s_branch P2_entry
K1_comp:
    s_getpc_b64 s[70:71]
K1_pc:
    s_lshr_b32 s72, s2, 3
    s_lshl_b32 s72, s72, 3
    s_add_u32 s72, s72, s19
    s_lshl_b32 s72, s72, 8
    s_min_u32 s72, s72, K2_text_end-parallel_sum__grouped_kv_mqa__mixer_token_mlp__prompt_kernel-256
    s_sub_u32 s70, s70, K1_pc-parallel_sum__grouped_kv_mqa__mixer_token_mlp__prompt_kernel
    s_subb_u32 s71, s71, 0
    s_add_u32 s70, s70, s72
    s_addc_u32 s71, s71, 0
    s_load_dword s72, s[70:71], 0
    s_load_dword s73, s[70:71], 64
    s_load_dword s74, s[70:71], 128
    s_load_dword s75, s[70:71], 192
    v_and_b32 v5, 15, v0
    v_lshrrev_b32 v6, 4, v0
    v_lshrrev_b32 v1, 1, v5
    v_xor_b32 v1, v1, v6
    s_lshl_b32 s49, s52, 11
    v_lshl_add_u32 v2, v5, 7, s49
    v_lshl_add_u32 v12, v1, 4, v2
    v_xor_b32 v13, 64, v12
    v_add_u32 v14, 57344, v12
    v_add_u32 v15, 57344, v13
    v_lshrrev_b32 v1, 2, v5
    v_lshl_add_u32 v2, v6, 3, v1
    v_and_b32 v3, 1, v5
    v_lshlrev_b32 v3, 3, v3
    v_lshl_add_u32 v16, v2, 7, v3
    v_bfe_u32 v2, v5, 3, 1
    v_lshlrev_b32 v2, 2, v2
    v_and_b32 v3, 1, v6
    v_lshl_or_b32 v2, v3, 1, v2
    v_bfe_u32 v4, v5, 1, 1
    v_xor_b32 v2, v2, v4
    v_lshl_add_u32 v16, v2, 4, v16
    v_add_u32 v16, 102400, v16
    v_lshl_add_u32 v1, v3, 2, v1
    v_lshrrev_b32 v2, 5, v0
    v_lshl_add_u32 v1, v2, 4, v1
    v_and_b32 v2, 3, v5
    v_lshlrev_b32 v2, 3, v2
    v_lshl_add_u32 v22, v1, 5, v2
    s_lshl_b32 s49, s52, 8
    s_add_u32 s49, s49, 160000
    v_lshl_add_u32 v19, v5, 4, s49
    v_lshlrev_b32 v20, 4, v6
    v_add_u32 v20, 161536, v20
    s_mul_i32 s49, s52, 2560
    s_add_u32 s49, s49, 135168
    v_mul_u32_u24 v1, 160, v5
    v_lshl_add_u32 v1, v6, 3, v1
    v_add_u32 v21, s49, v1
    s_and_b32 s42, s52, 1
    s_lshl_b32 s49, s42, 6
    v_xor_b32 v112, s49, v12
    v_xor_b32 v113, 2048, v112
    v_add_u32 v114, 57344, v112
    v_add_u32 v115, 57344, v113
    s_lshl_b32 s49, s42, 12
    v_add_u32 v16, s49, v16
    s_mul_i32 s49, s19, 3072
    s_add_u32 s49, s49, 110592
    v_lshl_add_u32 v116, v0, 4, s49
    s_xor_b32 s49, s19, 1
    s_mul_i32 s49, s49, 3072
    s_add_u32 s49, s49, 110592
    v_lshl_add_u32 v117, v0, 4, s49
    v_mov_b32 v8, 0x3f803f80
    v_mov_b32 v9, 0x3f803f80
    v_mov_b32 v10, 0x3f803f80
    v_mov_b32 v11, 0x3f803f80
    s_waitcnt lgkmcnt(0)
    s_mov_b32 s36, s14
    s_mov_b32 s37, s15
    s_mov_b32 s38, 12582912
    s_mov_b32 s39, 0x20000
    s_cmp_ge_u32 s19, 4
    s_cbranch_scc1 K1_hi
    v_xor_b32 v17, 32, v16
    v_xor_b32 v18, 64, v16
    s_cmp_ge_u32 s17, 4
    s_cbranch_scc1 K1_nokv
    v_add_u32 v22, 81920, v22
    s_lshl_b32 s53, s16, 2
    s_add_u32 s53, s53, s52
    s_mul_i32 s54, s16, 6144
    s_add_u32 s54, s54, 5242880
    s_lshr_b32 s55, s52, 1
    s_and_b32 s56, s52, 1
    s_cmp_ge_u32 s17, 2
    s_cbranch_scc1 K1_v
    v_lshrrev_b32 v2, 1, v6
    v_lshl_add_u32 v2, v2, 5, v5
    v_and_b32 v3, 1, v6
    v_lshlrev_b32 v3, 3, v3
    v_lshl_add_u32 v2, v2, 4, v3
    s_lshl_b32 s57, s55, 10
    s_lshl_b32 s58, s56, 8
    s_add_u32 s57, s57, s58
    v_add_u32 v2, s57, v2
    v_lshlrev_b32 v3, 8, v6
    v_lshl_add_u32 v3, v5, 3, v3
    s_lshr_b32 s57, s57, 1
    s_add_u32 s57, s57, 2048
    v_add_u32 v3, s57, v3
    s_mov_b32 s58, -1
    s_cmp_eq_u32 s17, 0
    s_cselect_b64 vcc, -1, 0
    s_cselect_b32 s59, -1, 0
    v_cndmask_b32 v23, v3, v2, vcc
    v_cmp_eq_u32 s[56:57], 1, v6
    s_nop 0
    s_andn2_b64 s[56:57], s[56:57], vcc
    v_mov_b32 v3, 0x3f80
    v_mov_b32 v4, 0
    s_barrier
    ds_read_b128 v[120:123], v12 offset:0
    ds_read_b64_tr_b16 v[124:125], v22 offset:0
    ds_read_b64_tr_b16 v[126:127], v22 offset:256
    ds_read_b128 v[128:131], v13 offset:0
    ds_read_b64_tr_b16 v[132:133], v22 offset:1024
    ds_read_b64_tr_b16 v[134:135], v22 offset:1280
    ds_read_b128 v[136:139], v12 offset:8192
    ds_read_b64_tr_b16 v[140:141], v22 offset:2048
    ds_read_b64_tr_b16 v[142:143], v22 offset:2304
    ds_read_b128 v[144:147], v13 offset:8192
    ds_read_b64_tr_b16 v[148:149], v22 offset:3072
    ds_read_b64_tr_b16 v[150:151], v22 offset:3328
    s_waitcnt lgkmcnt(9)
    v_mfma_f32_16x16x32_bf16 v[52:55], v[124:127], v[120:123], 0
    v_mfma_f32_16x16x32_bf16 v[56:59], v[124:127], v[8:11], 0
    ds_read_b128 v[120:123], v12 offset:16384
    ds_read_b64_tr_b16 v[124:125], v22 offset:4096
    ds_read_b64_tr_b16 v[126:127], v22 offset:4352
    s_waitcnt lgkmcnt(9)
    v_mfma_f32_16x16x32_bf16 v[52:55], v[132:135], v[128:131], v[52:55]
    v_mfma_f32_16x16x32_bf16 v[56:59], v[132:135], v[8:11], v[56:59]
    ds_read_b128 v[128:131], v13 offset:16384
    ds_read_b64_tr_b16 v[132:133], v22 offset:5120
    ds_read_b64_tr_b16 v[134:135], v22 offset:5376
    s_waitcnt lgkmcnt(9)
    v_mfma_f32_16x16x32_bf16 v[52:55], v[140:143], v[136:139], v[52:55]
    v_mfma_f32_16x16x32_bf16 v[56:59], v[140:143], v[8:11], v[56:59]
    ds_read_b128 v[136:139], v12 offset:24576
    ds_read_b64_tr_b16 v[140:141], v22 offset:6144
    ds_read_b64_tr_b16 v[142:143], v22 offset:6400
    s_waitcnt lgkmcnt(9)
    v_mfma_f32_16x16x32_bf16 v[52:55], v[148:151], v[144:147], v[52:55]
    v_mfma_f32_16x16x32_bf16 v[56:59], v[148:151], v[8:11], v[56:59]
    ds_read_b128 v[144:147], v13 offset:24576
    ds_read_b64_tr_b16 v[148:149], v22 offset:7168
    ds_read_b64_tr_b16 v[150:151], v22 offset:7424
    s_waitcnt lgkmcnt(9)
    v_mfma_f32_16x16x32_bf16 v[52:55], v[124:127], v[120:123], v[52:55]
    v_mfma_f32_16x16x32_bf16 v[56:59], v[124:127], v[8:11], v[56:59]
    ds_read_b128 v[120:123], v12 offset:32768
    ds_read_b64_tr_b16 v[124:125], v22 offset:8192
    ds_read_b64_tr_b16 v[126:127], v22 offset:8448
    s_waitcnt lgkmcnt(9)
    v_mfma_f32_16x16x32_bf16 v[52:55], v[132:135], v[128:131], v[52:55]
    v_mfma_f32_16x16x32_bf16 v[56:59], v[132:135], v[8:11], v[56:59]
    ds_read_b128 v[128:131], v13 offset:32768
    ds_read_b64_tr_b16 v[132:133], v22 offset:9216
    ds_read_b64_tr_b16 v[134:135], v22 offset:9472
    s_waitcnt lgkmcnt(9)
    v_mfma_f32_16x16x32_bf16 v[52:55], v[140:143], v[136:139], v[52:55]
    v_mfma_f32_16x16x32_bf16 v[56:59], v[140:143], v[8:11], v[56:59]
    ds_read_b128 v[136:139], v12 offset:40960
    ds_read_b64_tr_b16 v[140:141], v22 offset:10240
    ds_read_b64_tr_b16 v[142:143], v22 offset:10496
    s_waitcnt lgkmcnt(9)
    v_mfma_f32_16x16x32_bf16 v[52:55], v[148:151], v[144:147], v[52:55]
    v_mfma_f32_16x16x32_bf16 v[56:59], v[148:151], v[8:11], v[56:59]
    ds_read_b128 v[144:147], v13 offset:40960
    ds_read_b64_tr_b16 v[148:149], v22 offset:11264
    ds_read_b64_tr_b16 v[150:151], v22 offset:11520
    s_waitcnt lgkmcnt(9)
    v_mfma_f32_16x16x32_bf16 v[52:55], v[124:127], v[120:123], v[52:55]
    v_mfma_f32_16x16x32_bf16 v[56:59], v[124:127], v[8:11], v[56:59]
    s_waitcnt lgkmcnt(6)
    v_mfma_f32_16x16x32_bf16 v[52:55], v[132:135], v[128:131], v[52:55]
    v_mfma_f32_16x16x32_bf16 v[56:59], v[132:135], v[8:11], v[56:59]
    s_waitcnt lgkmcnt(3)
    v_mfma_f32_16x16x32_bf16 v[52:55], v[140:143], v[136:139], v[52:55]
    v_mfma_f32_16x16x32_bf16 v[56:59], v[140:143], v[8:11], v[56:59]
    s_waitcnt lgkmcnt(0)
    v_mfma_f32_16x16x32_bf16 v[52:55], v[148:151], v[144:147], v[52:55]
    v_mfma_f32_16x16x32_bf16 v[56:59], v[148:151], v[8:11], v[56:59]
    s_barrier
    ds_read_b128 v[120:123], v12 offset:49152
    ds_read_b64_tr_b16 v[124:125], v22 offset:12288
    ds_read_b64_tr_b16 v[126:127], v22 offset:12544
    ds_read_b128 v[128:131], v13 offset:49152
    ds_read_b64_tr_b16 v[132:133], v22 offset:13312
    ds_read_b64_tr_b16 v[134:135], v22 offset:13568
    ds_read_b128 v[136:139], v14 offset:0
    ds_read_b64_tr_b16 v[140:141], v22 offset:14336
    ds_read_b64_tr_b16 v[142:143], v22 offset:14592
    ds_read_b128 v[144:147], v15 offset:0
    ds_read_b64_tr_b16 v[148:149], v22 offset:15360
    ds_read_b64_tr_b16 v[150:151], v22 offset:15616
    s_waitcnt lgkmcnt(9)
    v_mfma_f32_16x16x32_bf16 v[52:55], v[124:127], v[120:123], v[52:55]
    v_mfma_f32_16x16x32_bf16 v[56:59], v[124:127], v[8:11], v[56:59]
    ds_read_b128 v[120:123], v14 offset:8192
    ds_read_b64_tr_b16 v[124:125], v22 offset:16384
    ds_read_b64_tr_b16 v[126:127], v22 offset:16640
    s_waitcnt lgkmcnt(9)
    v_mfma_f32_16x16x32_bf16 v[52:55], v[132:135], v[128:131], v[52:55]
    v_mfma_f32_16x16x32_bf16 v[56:59], v[132:135], v[8:11], v[56:59]
    ds_read_b128 v[128:131], v15 offset:8192
    ds_read_b64_tr_b16 v[132:133], v22 offset:17408
    ds_read_b64_tr_b16 v[134:135], v22 offset:17664
    s_waitcnt lgkmcnt(9)
    v_mfma_f32_16x16x32_bf16 v[52:55], v[140:143], v[136:139], v[52:55]
    v_mfma_f32_16x16x32_bf16 v[56:59], v[140:143], v[8:11], v[56:59]
    ds_read_b128 v[136:139], v14 offset:16384
    ds_read_b64_tr_b16 v[140:141], v22 offset:18432
    ds_read_b64_tr_b16 v[142:143], v22 offset:18688
    s_waitcnt lgkmcnt(9)
    v_mfma_f32_16x16x32_bf16 v[52:55], v[148:151], v[144:147], v[52:55]
    v_mfma_f32_16x16x32_bf16 v[56:59], v[148:151], v[8:11], v[56:59]
    ds_read_b128 v[144:147], v15 offset:16384
    ds_read_b64_tr_b16 v[148:149], v22 offset:19456
    ds_read_b64_tr_b16 v[150:151], v22 offset:19712
    s_waitcnt lgkmcnt(9)
    v_mfma_f32_16x16x32_bf16 v[52:55], v[124:127], v[120:123], v[52:55]
    v_mfma_f32_16x16x32_bf16 v[56:59], v[124:127], v[8:11], v[56:59]
    s_waitcnt lgkmcnt(6)
    v_mfma_f32_16x16x32_bf16 v[52:55], v[132:135], v[128:131], v[52:55]
    v_mfma_f32_16x16x32_bf16 v[56:59], v[132:135], v[8:11], v[56:59]
    s_waitcnt lgkmcnt(3)
    v_mfma_f32_16x16x32_bf16 v[52:55], v[140:143], v[136:139], v[52:55]
    v_mfma_f32_16x16x32_bf16 v[56:59], v[140:143], v[8:11], v[56:59]
    s_waitcnt lgkmcnt(0)
    v_mfma_f32_16x16x32_bf16 v[52:55], v[148:151], v[144:147], v[52:55]
    v_mfma_f32_16x16x32_bf16 v[56:59], v[148:151], v[8:11], v[56:59]
    s_barrier
    ds_read_b64 v[120:121], v19
    s_waitcnt lgkmcnt(0)
    s_nop 3
    v_pk_mul_f32 v[52:53], v[52:53], v[120:121] op_sel_hi:[1,0]
    v_pk_mul_f32 v[54:55], v[54:55], v[120:121] op_sel_hi:[1,0]
    v_pk_fma_f32 v[52:53], v[56:57], v[120:121], v[52:53] op_sel:[0,1,0]
    v_pk_fma_f32 v[54:55], v[58:59], v[120:121], v[54:55] op_sel:[0,1,0]
    v_cvt_pk_bf16_f32 v160, v52, v53
    v_cvt_pk_bf16_f32 v161, v54, v55
    v_cndmask_b32 v160, v160, v3, s[56:57]
    v_cndmask_b32 v161, v161, v4, s[56:57]
    s_mov_b64 exec, s[58:59]
    buffer_store_dwordx2 v[160:161], v23, s[36:39], s54 offen sc1
    s_mov_b64 exec, -1
    s_branch K1_lo
K1_v:
    v_lshrrev_b32 v2, 1, v6
    v_mul_u32_u24 v2, 24, v2
    s_sub_u32 s49, s17, 2
    s_lshl_b32 s49, s49, 4
    v_add_u32 v4, s49, v5
    v_add_u32 v2, v2, v4
    v_and_b32 v3, 1, v6
    v_lshlrev_b32 v3, 3, v3
    v_lshl_add_u32 v2, v2, 4, v3
    s_mul_i32 s57, s55, 768
    s_mul_i32 s58, s56, 7680
    s_add_u32 s57, s57, s58
    s_add_u32 s57, s57, 3072
    v_add_u32 v23, s57, v2
    v_cmp_gt_u32 s[58:59], 24, v4
    v_cmp_le_u32 s[56:57], 20, v4
    v_cmp_eq_u32 vcc, 20, v4
    s_nop 1
    v_cndmask_b32 v4, 0, v8, vcc
    s_lshl_b32 s49, s52, 8
    s_add_u32 s49, s49, 160000
    v_lshl_add_u32 v3, v6, 6, s49
    s_barrier
    ds_read_b128 v[120:123], v12 offset:0
    ds_read_b64_tr_b16 v[124:125], v22 offset:0
    ds_read_b64_tr_b16 v[126:127], v22 offset:256
    ds_read_b128 v[128:131], v13 offset:0
    ds_read_b64_tr_b16 v[132:133], v22 offset:1024
    ds_read_b64_tr_b16 v[134:135], v22 offset:1280
    ds_read_b128 v[136:139], v12 offset:8192
    ds_read_b64_tr_b16 v[140:141], v22 offset:2048
    ds_read_b64_tr_b16 v[142:143], v22 offset:2304
    ds_read_b128 v[144:147], v13 offset:8192
    ds_read_b64_tr_b16 v[148:149], v22 offset:3072
    ds_read_b64_tr_b16 v[150:151], v22 offset:3328
    s_waitcnt lgkmcnt(9)
    v_mfma_f32_16x16x32_bf16 v[52:55], v[120:123], v[124:127], 0
    v_mfma_f32_16x16x32_bf16 v[56:59], v[8:11], v[124:127], 0
    ds_read_b128 v[120:123], v12 offset:16384
    ds_read_b64_tr_b16 v[124:125], v22 offset:4096
    ds_read_b64_tr_b16 v[126:127], v22 offset:4352
    s_waitcnt lgkmcnt(9)
    v_mfma_f32_16x16x32_bf16 v[52:55], v[128:131], v[132:135], v[52:55]
    v_mfma_f32_16x16x32_bf16 v[56:59], v[8:11], v[132:135], v[56:59]
    ds_read_b128 v[128:131], v13 offset:16384
    ds_read_b64_tr_b16 v[132:133], v22 offset:5120
    ds_read_b64_tr_b16 v[134:135], v22 offset:5376
    s_waitcnt lgkmcnt(9)
    v_mfma_f32_16x16x32_bf16 v[52:55], v[136:139], v[140:143], v[52:55]
    v_mfma_f32_16x16x32_bf16 v[56:59], v[8:11], v[140:143], v[56:59]
    ds_read_b128 v[136:139], v12 offset:24576
    ds_read_b64_tr_b16 v[140:141], v22 offset:6144
    ds_read_b64_tr_b16 v[142:143], v22 offset:6400
    s_waitcnt lgkmcnt(9)
    v_mfma_f32_16x16x32_bf16 v[52:55], v[144:147], v[148:151], v[52:55]
    v_mfma_f32_16x16x32_bf16 v[56:59], v[8:11], v[148:151], v[56:59]
    ds_read_b128 v[144:147], v13 offset:24576
    ds_read_b64_tr_b16 v[148:149], v22 offset:7168
    ds_read_b64_tr_b16 v[150:151], v22 offset:7424
    s_waitcnt lgkmcnt(9)
    v_mfma_f32_16x16x32_bf16 v[52:55], v[120:123], v[124:127], v[52:55]
    v_mfma_f32_16x16x32_bf16 v[56:59], v[8:11], v[124:127], v[56:59]
    ds_read_b128 v[120:123], v12 offset:32768
    ds_read_b64_tr_b16 v[124:125], v22 offset:8192
    ds_read_b64_tr_b16 v[126:127], v22 offset:8448
    s_waitcnt lgkmcnt(9)
    v_mfma_f32_16x16x32_bf16 v[52:55], v[128:131], v[132:135], v[52:55]
    v_mfma_f32_16x16x32_bf16 v[56:59], v[8:11], v[132:135], v[56:59]
    ds_read_b128 v[128:131], v13 offset:32768
    ds_read_b64_tr_b16 v[132:133], v22 offset:9216
    ds_read_b64_tr_b16 v[134:135], v22 offset:9472
    s_waitcnt lgkmcnt(9)
    v_mfma_f32_16x16x32_bf16 v[52:55], v[136:139], v[140:143], v[52:55]
    v_mfma_f32_16x16x32_bf16 v[56:59], v[8:11], v[140:143], v[56:59]
    ds_read_b128 v[136:139], v12 offset:40960
    ds_read_b64_tr_b16 v[140:141], v22 offset:10240
    ds_read_b64_tr_b16 v[142:143], v22 offset:10496
    s_waitcnt lgkmcnt(9)
    v_mfma_f32_16x16x32_bf16 v[52:55], v[144:147], v[148:151], v[52:55]
    v_mfma_f32_16x16x32_bf16 v[56:59], v[8:11], v[148:151], v[56:59]
    ds_read_b128 v[144:147], v13 offset:40960
    ds_read_b64_tr_b16 v[148:149], v22 offset:11264
    ds_read_b64_tr_b16 v[150:151], v22 offset:11520
    s_waitcnt lgkmcnt(9)
    v_mfma_f32_16x16x32_bf16 v[52:55], v[120:123], v[124:127], v[52:55]
    v_mfma_f32_16x16x32_bf16 v[56:59], v[8:11], v[124:127], v[56:59]
    s_waitcnt lgkmcnt(6)
    v_mfma_f32_16x16x32_bf16 v[52:55], v[128:131], v[132:135], v[52:55]
    v_mfma_f32_16x16x32_bf16 v[56:59], v[8:11], v[132:135], v[56:59]
    s_waitcnt lgkmcnt(3)
    v_mfma_f32_16x16x32_bf16 v[52:55], v[136:139], v[140:143], v[52:55]
    v_mfma_f32_16x16x32_bf16 v[56:59], v[8:11], v[140:143], v[56:59]
    s_waitcnt lgkmcnt(0)
    v_mfma_f32_16x16x32_bf16 v[52:55], v[144:147], v[148:151], v[52:55]
    v_mfma_f32_16x16x32_bf16 v[56:59], v[8:11], v[148:151], v[56:59]
    s_barrier
    ds_read_b128 v[120:123], v12 offset:49152
    ds_read_b64_tr_b16 v[124:125], v22 offset:12288
    ds_read_b64_tr_b16 v[126:127], v22 offset:12544
    ds_read_b128 v[128:131], v13 offset:49152
    ds_read_b64_tr_b16 v[132:133], v22 offset:13312
    ds_read_b64_tr_b16 v[134:135], v22 offset:13568
    ds_read_b128 v[136:139], v14 offset:0
    ds_read_b64_tr_b16 v[140:141], v22 offset:14336
    ds_read_b64_tr_b16 v[142:143], v22 offset:14592
    ds_read_b128 v[144:147], v15 offset:0
    ds_read_b64_tr_b16 v[148:149], v22 offset:15360
    ds_read_b64_tr_b16 v[150:151], v22 offset:15616
    s_waitcnt lgkmcnt(9)
    v_mfma_f32_16x16x32_bf16 v[52:55], v[120:123], v[124:127], v[52:55]
    v_mfma_f32_16x16x32_bf16 v[56:59], v[8:11], v[124:127], v[56:59]
    ds_read_b128 v[120:123], v14 offset:8192
    ds_read_b64_tr_b16 v[124:125], v22 offset:16384
    ds_read_b64_tr_b16 v[126:127], v22 offset:16640
    s_waitcnt lgkmcnt(9)
    v_mfma_f32_16x16x32_bf16 v[52:55], v[128:131], v[132:135], v[52:55]
    v_mfma_f32_16x16x32_bf16 v[56:59], v[8:11], v[132:135], v[56:59]
    ds_read_b128 v[128:131], v15 offset:8192
    ds_read_b64_tr_b16 v[132:133], v22 offset:17408
    ds_read_b64_tr_b16 v[134:135], v22 offset:17664
    s_waitcnt lgkmcnt(9)
    v_mfma_f32_16x16x32_bf16 v[52:55], v[136:139], v[140:143], v[52:55]
    v_mfma_f32_16x16x32_bf16 v[56:59], v[8:11], v[140:143], v[56:59]
    ds_read_b128 v[136:139], v14 offset:16384
    ds_read_b64_tr_b16 v[140:141], v22 offset:18432
    ds_read_b64_tr_b16 v[142:143], v22 offset:18688
    s_waitcnt lgkmcnt(9)
    v_mfma_f32_16x16x32_bf16 v[52:55], v[144:147], v[148:151], v[52:55]
    v_mfma_f32_16x16x32_bf16 v[56:59], v[8:11], v[148:151], v[56:59]
    ds_read_b128 v[144:147], v15 offset:16384
    ds_read_b64_tr_b16 v[148:149], v22 offset:19456
    ds_read_b64_tr_b16 v[150:151], v22 offset:19712
    s_waitcnt lgkmcnt(9)
    v_mfma_f32_16x16x32_bf16 v[52:55], v[120:123], v[124:127], v[52:55]
    v_mfma_f32_16x16x32_bf16 v[56:59], v[8:11], v[124:127], v[56:59]
    s_waitcnt lgkmcnt(6)
    v_mfma_f32_16x16x32_bf16 v[52:55], v[128:131], v[132:135], v[52:55]
    v_mfma_f32_16x16x32_bf16 v[56:59], v[8:11], v[132:135], v[56:59]
    s_waitcnt lgkmcnt(3)
    v_mfma_f32_16x16x32_bf16 v[52:55], v[136:139], v[140:143], v[52:55]
    v_mfma_f32_16x16x32_bf16 v[56:59], v[8:11], v[140:143], v[56:59]
    s_waitcnt lgkmcnt(0)
    v_mfma_f32_16x16x32_bf16 v[52:55], v[144:147], v[148:151], v[52:55]
    v_mfma_f32_16x16x32_bf16 v[56:59], v[8:11], v[148:151], v[56:59]
    s_barrier
    ds_read_b64 v[120:121], v3 offset:0
    ds_read_b64 v[122:123], v3 offset:16
    ds_read_b64 v[124:125], v3 offset:32
    ds_read_b64 v[126:127], v3 offset:48
    s_waitcnt lgkmcnt(0)
    s_nop 0
    v_mul_f32 v52, v52, v120
    v_mul_f32 v53, v53, v122
    v_mul_f32 v54, v54, v124
    v_mul_f32 v55, v55, v126
    v_fmac_f32 v52, v56, v121
    v_fmac_f32 v53, v57, v123
    v_fmac_f32 v54, v58, v125
    v_fmac_f32 v55, v59, v127
    v_cvt_pk_bf16_f32 v160, v52, v53
    v_cvt_pk_bf16_f32 v161, v54, v55
    v_cndmask_b32 v160, v160, v4, s[56:57]
    v_cndmask_b32 v161, v161, v4, s[56:57]
    s_mov_b64 exec, s[58:59]
    buffer_store_dwordx2 v[160:161], v23, s[36:39], s54 offen sc1
    s_mov_b64 exec, -1
    s_branch K1_lo
K1_nokv:
    s_cmp_lg_u32 s2, 255
    s_cbranch_scc1 K1_noclr
    s_lshl_b32 s49, s52, 10
    v_lshl_add_u32 v1, v0, 4, s49
    s_add_u32 s28, s14, 12058624
    s_addc_u32 s29, s15, 0
    s_mov_b32 s30, 45056
    s_mov_b32 s31, 0x20000
    v_mov_b32 v120, 0
    v_mov_b32 v121, 0
    v_mov_b32 v122, 0
    v_mov_b32 v123, 0
    s_mov_b32 s50, 0
    buffer_store_dwordx4 v[120:123], v1, s[28:31], s50 offen sc1
    s_mov_b32 s50, 4096
    buffer_store_dwordx4 v[120:123], v1, s[28:31], s50 offen sc1
    s_mov_b32 s50, 8192
    buffer_store_dwordx4 v[120:123], v1, s[28:31], s50 offen sc1
    s_mov_b32 s50, 12288
    buffer_store_dwordx4 v[120:123], v1, s[28:31], s50 offen sc1
    s_mov_b32 s50, 16384
    buffer_store_dwordx4 v[120:123], v1, s[28:31], s50 offen sc1
    s_mov_b32 s50, 20480
    buffer_store_dwordx4 v[120:123], v1, s[28:31], s50 offen sc1
    s_mov_b32 s50, 24576
    buffer_store_dwordx4 v[120:123], v1, s[28:31], s50 offen sc1
    s_mov_b32 s50, 28672
    buffer_store_dwordx4 v[120:123], v1, s[28:31], s50 offen sc1
    s_mov_b32 s50, 32768
    buffer_store_dwordx4 v[120:123], v1, s[28:31], s50 offen sc1
    s_mov_b32 s50, 36864
    buffer_store_dwordx4 v[120:123], v1, s[28:31], s50 offen sc1
    s_mov_b32 s50, 40960
    buffer_store_dwordx4 v[120:123], v1, s[28:31], s50 offen sc1
    s_lshl_b32 s49, s52, 2
    v_mov_b32 v1, s49
    v_mov_b32 v2, 1
    s_waitcnt vmcnt(0)
    s_mov_b64 exec, 1
    global_store_dword v1, v2, s[12:13] sc1
    s_mov_b64 exec, -1
K1_noclr:
    s_barrier
    s_barrier
    s_barrier
K1_lo:
    s_barrier
    ds_read_b128 v[28:31], v113 offset:0
    ds_read_b128 v[24:27], v112 offset:0
    ds_read_b64_tr_b16 v[40:41], v16 offset:0
    ds_read_b64_tr_b16 v[42:43], v16 offset:512
    ds_read_b64_tr_b16 v[44:45], v17 offset:0
    ds_read_b64_tr_b16 v[46:47], v17 offset:512
    ds_read_b64_tr_b16 v[48:49], v18 offset:0
    ds_read_b64_tr_b16 v[50:51], v18 offset:512
    s_waitcnt lgkmcnt(0)
    s_barrier
    v_mfma_f32_16x16x32_bf16 v[100:103], v[40:43], v[28:31], 0
    ds_read_b128 v[36:39], v113 offset:8192
    ds_read_b128 v[32:35], v112 offset:8192
    v_mfma_f32_16x16x32_bf16 v[104:107], v[44:47], v[28:31], 0
    ds_read_b64_tr_b16 v[64:65], v16 offset:10240
    ds_read_b64_tr_b16 v[66:67], v16 offset:10752
    v_mfma_f32_16x16x32_bf16 v[108:111], v[48:51], v[28:31], 0
    ds_read_b64_tr_b16 v[68:69], v17 offset:10240
    v_mfma_f32_16x16x32_bf16 v[88:91], v[40:43], v[24:27], 0
    ds_read_b64_tr_b16 v[70:71], v17 offset:10752
    v_mfma_f32_16x16x32_bf16 v[92:95], v[44:47], v[24:27], 0
    ds_read_b64_tr_b16 v[72:73], v18 offset:10240
    v_mfma_f32_16x16x32_bf16 v[96:99], v[48:51], v[24:27], 0
    ds_read_b64_tr_b16 v[74:75], v18 offset:10752
    s_waitcnt lgkmcnt(0)
    s_barrier
    v_mfma_f32_16x16x32_bf16 v[100:103], v[64:67], v[36:39], v[100:103]
    ds_read_b128 v[28:31], v113 offset:16384
    ds_read_b128 v[24:27], v112 offset:16384
    v_mfma_f32_16x16x32_bf16 v[104:107], v[68:71], v[36:39], v[104:107]
    ds_read_b64_tr_b16 v[40:41], v16 offset:20480
    ds_read_b64_tr_b16 v[42:43], v16 offset:20992
    v_mfma_f32_16x16x32_bf16 v[108:111], v[72:75], v[36:39], v[108:111]
    ds_read_b64_tr_b16 v[44:45], v17 offset:20480
    v_mfma_f32_16x16x32_bf16 v[88:91], v[64:67], v[32:35], v[88:91]
    ds_read_b64_tr_b16 v[46:47], v17 offset:20992
    v_mfma_f32_16x16x32_bf16 v[92:95], v[68:71], v[32:35], v[92:95]
    ds_read_b64_tr_b16 v[48:49], v18 offset:20480
    v_mfma_f32_16x16x32_bf16 v[96:99], v[72:75], v[32:35], v[96:99]
    ds_read_b64_tr_b16 v[50:51], v18 offset:20992
    s_waitcnt lgkmcnt(0)
    s_waitcnt vmcnt(0)
    s_barrier
    v_mfma_f32_16x16x32_bf16 v[100:103], v[40:43], v[28:31], v[100:103]
    ds_read_b128 v[36:39], v113 offset:24576
    ds_read_b128 v[32:35], v112 offset:24576
    v_mfma_f32_16x16x32_bf16 v[104:107], v[44:47], v[28:31], v[104:107]
    ds_read_b64_tr_b16 v[64:65], v16 offset:30720
    ds_read_b64_tr_b16 v[66:67], v16 offset:31232
    v_mfma_f32_16x16x32_bf16 v[108:111], v[48:51], v[28:31], v[108:111]
    ds_read_b64_tr_b16 v[68:69], v17 offset:30720
    v_mfma_f32_16x16x32_bf16 v[88:91], v[40:43], v[24:27], v[88:91]
    ds_read_b64_tr_b16 v[70:71], v17 offset:31232
    v_mfma_f32_16x16x32_bf16 v[92:95], v[44:47], v[24:27], v[92:95]
    ds_read_b64_tr_b16 v[72:73], v18 offset:30720
    v_mfma_f32_16x16x32_bf16 v[96:99], v[48:51], v[24:27], v[96:99]
    ds_read_b64_tr_b16 v[74:75], v18 offset:31232
    s_waitcnt lgkmcnt(0)
    s_barrier
    v_mfma_f32_16x16x32_bf16 v[100:103], v[64:67], v[36:39], v[100:103]
    ds_read_b128 v[28:31], v113 offset:32768
    ds_read_b128 v[24:27], v112 offset:32768
    v_mfma_f32_16x16x32_bf16 v[104:107], v[68:71], v[36:39], v[104:107]
    ds_read_b64_tr_b16 v[40:41], v16 offset:40960
    ds_read_b64_tr_b16 v[42:43], v16 offset:41472
    v_mfma_f32_16x16x32_bf16 v[108:111], v[72:75], v[36:39], v[108:111]
    ds_read_b64_tr_b16 v[44:45], v17 offset:40960
    v_mfma_f32_16x16x32_bf16 v[88:91], v[64:67], v[32:35], v[88:91]
    ds_read_b64_tr_b16 v[46:47], v17 offset:41472
    v_mfma_f32_16x16x32_bf16 v[92:95], v[68:71], v[32:35], v[92:95]
    ds_read_b64_tr_b16 v[48:49], v18 offset:40960
    v_mfma_f32_16x16x32_bf16 v[96:99], v[72:75], v[32:35], v[96:99]
    ds_read_b64_tr_b16 v[50:51], v18 offset:41472
    s_waitcnt lgkmcnt(0)
    s_barrier
    v_mfma_f32_16x16x32_bf16 v[100:103], v[40:43], v[28:31], v[100:103]
    ds_read_b128 v[36:39], v113 offset:40960
    ds_read_b128 v[32:35], v112 offset:40960
    v_mfma_f32_16x16x32_bf16 v[104:107], v[44:47], v[28:31], v[104:107]
    ds_read_b64_tr_b16 v[64:65], v16 offset:0
    ds_read_b64_tr_b16 v[66:67], v16 offset:512
    v_mfma_f32_16x16x32_bf16 v[108:111], v[48:51], v[28:31], v[108:111]
    ds_read_b64_tr_b16 v[68:69], v17 offset:0
    v_mfma_f32_16x16x32_bf16 v[88:91], v[40:43], v[24:27], v[88:91]
    ds_read_b64_tr_b16 v[70:71], v17 offset:512
    v_mfma_f32_16x16x32_bf16 v[92:95], v[44:47], v[24:27], v[92:95]
    ds_read_b64_tr_b16 v[72:73], v18 offset:0
    v_mfma_f32_16x16x32_bf16 v[96:99], v[48:51], v[24:27], v[96:99]
    ds_read_b64_tr_b16 v[74:75], v18 offset:512
    s_waitcnt lgkmcnt(0)
    s_barrier
    v_mfma_f32_16x16x32_bf16 v[100:103], v[64:67], v[36:39], v[100:103]
    ds_read_b128 v[28:31], v113 offset:49152
    ds_read_b128 v[24:27], v112 offset:49152
    v_mfma_f32_16x16x32_bf16 v[104:107], v[68:71], v[36:39], v[104:107]
    ds_read_b64_tr_b16 v[40:41], v16 offset:10240
    ds_read_b64_tr_b16 v[42:43], v16 offset:10752
    v_mfma_f32_16x16x32_bf16 v[108:111], v[72:75], v[36:39], v[108:111]
    ds_read_b64_tr_b16 v[44:45], v17 offset:10240
    v_mfma_f32_16x16x32_bf16 v[88:91], v[64:67], v[32:35], v[88:91]
    ds_read_b64_tr_b16 v[46:47], v17 offset:10752
    v_mfma_f32_16x16x32_bf16 v[92:95], v[68:71], v[32:35], v[92:95]
    ds_read_b64_tr_b16 v[48:49], v18 offset:10240
    v_mfma_f32_16x16x32_bf16 v[96:99], v[72:75], v[32:35], v[96:99]
    ds_read_b64_tr_b16 v[50:51], v18 offset:10752
    s_waitcnt lgkmcnt(0)
    s_barrier
    v_mfma_f32_16x16x32_bf16 v[100:103], v[40:43], v[28:31], v[100:103]
    ds_read_b128 v[36:39], v115 offset:0
    ds_read_b128 v[32:35], v114 offset:0
    v_mfma_f32_16x16x32_bf16 v[104:107], v[44:47], v[28:31], v[104:107]
    ds_read_b64_tr_b16 v[64:65], v16 offset:20480
    ds_read_b64_tr_b16 v[66:67], v16 offset:20992
    v_mfma_f32_16x16x32_bf16 v[108:111], v[48:51], v[28:31], v[108:111]
    ds_read_b64_tr_b16 v[68:69], v17 offset:20480
    v_mfma_f32_16x16x32_bf16 v[88:91], v[40:43], v[24:27], v[88:91]
    ds_read_b64_tr_b16 v[70:71], v17 offset:20992
    v_mfma_f32_16x16x32_bf16 v[92:95], v[44:47], v[24:27], v[92:95]
    ds_read_b64_tr_b16 v[72:73], v18 offset:20480
    v_mfma_f32_16x16x32_bf16 v[96:99], v[48:51], v[24:27], v[96:99]
    ds_read_b64_tr_b16 v[74:75], v18 offset:20992
    s_waitcnt lgkmcnt(0)
    s_barrier
    v_mfma_f32_16x16x32_bf16 v[100:103], v[64:67], v[36:39], v[100:103]
    ds_read_b128 v[28:31], v115 offset:8192
    ds_read_b128 v[24:27], v114 offset:8192
    v_mfma_f32_16x16x32_bf16 v[104:107], v[68:71], v[36:39], v[104:107]
    ds_read_b64_tr_b16 v[40:41], v16 offset:30720
    ds_read_b64_tr_b16 v[42:43], v16 offset:31232
    v_mfma_f32_16x16x32_bf16 v[108:111], v[72:75], v[36:39], v[108:111]
    ds_read_b64_tr_b16 v[44:45], v17 offset:30720
    v_mfma_f32_16x16x32_bf16 v[88:91], v[64:67], v[32:35], v[88:91]
    ds_read_b64_tr_b16 v[46:47], v17 offset:31232
    v_mfma_f32_16x16x32_bf16 v[92:95], v[68:71], v[32:35], v[92:95]
    ds_read_b64_tr_b16 v[48:49], v18 offset:30720
    v_mfma_f32_16x16x32_bf16 v[96:99], v[72:75], v[32:35], v[96:99]
    ds_read_b64_tr_b16 v[50:51], v18 offset:31232
    s_waitcnt lgkmcnt(0)
    s_barrier
    v_mfma_f32_16x16x32_bf16 v[100:103], v[40:43], v[28:31], v[100:103]
    ds_read_b128 v[36:39], v115 offset:16384
    ds_read_b128 v[32:35], v114 offset:16384
    v_mfma_f32_16x16x32_bf16 v[104:107], v[44:47], v[28:31], v[104:107]
    ds_read_b64_tr_b16 v[64:65], v16 offset:40960
    ds_read_b64_tr_b16 v[66:67], v16 offset:41472
    v_mfma_f32_16x16x32_bf16 v[108:111], v[48:51], v[28:31], v[108:111]
    ds_read_b64_tr_b16 v[68:69], v17 offset:40960
    v_mfma_f32_16x16x32_bf16 v[88:91], v[40:43], v[24:27], v[88:91]
    ds_read_b64_tr_b16 v[70:71], v17 offset:41472
    v_mfma_f32_16x16x32_bf16 v[92:95], v[44:47], v[24:27], v[92:95]
    ds_read_b64_tr_b16 v[72:73], v18 offset:40960
    v_mfma_f32_16x16x32_bf16 v[96:99], v[48:51], v[24:27], v[96:99]
    ds_read_b64_tr_b16 v[74:75], v18 offset:41472
    s_waitcnt lgkmcnt(0)
    v_mfma_f32_16x16x32_bf16 v[100:103], v[64:67], v[36:39], v[100:103]
    v_mfma_f32_16x16x32_bf16 v[104:107], v[68:71], v[36:39], v[104:107]
    v_mfma_f32_16x16x32_bf16 v[108:111], v[72:75], v[36:39], v[108:111]
    v_mfma_f32_16x16x32_bf16 v[88:91], v[64:67], v[32:35], v[88:91]
    v_mfma_f32_16x16x32_bf16 v[92:95], v[68:71], v[32:35], v[92:95]
    v_mfma_f32_16x16x32_bf16 v[96:99], v[72:75], v[32:35], v[96:99]
    s_nop 2
    ds_write_b128 v116, v[100:103] offset:0
    ds_write_b128 v116, v[104:107] offset:1024
    ds_write_b128 v116, v[108:111] offset:2048
    s_waitcnt lgkmcnt(0)
    s_barrier
    ds_read_b128 v[100:103], v117 offset:0
    ds_read_b128 v[104:107], v117 offset:1024
    ds_read_b128 v[108:111], v117 offset:2048
    ds_read_b64 v[120:121], v19 offset:8
    ds_read_b128 v[124:127], v20 offset:0
    ds_read_b128 v[128:131], v20 offset:64
    ds_read_b128 v[132:135], v20 offset:128
    s_waitcnt lgkmcnt(0)
    v_pk_add_f32 v[88:89], v[88:89], v[100:101]
    v_pk_add_f32 v[90:91], v[90:91], v[102:103]
    v_pk_mul_f32 v[88:89], v[88:89], v[120:121] op_sel_hi:[1,0]
    v_pk_mul_f32 v[90:91], v[90:91], v[120:121] op_sel_hi:[1,0]
    v_pk_fma_f32 v[88:89], v[124:125], v[120:121], v[88:89] op_sel:[0,1,0]
    v_pk_fma_f32 v[90:91], v[126:127], v[120:121], v[90:91] op_sel:[0,1,0]
    v_cvt_pk_bf16_f32 v144, v88, v89
    v_cvt_pk_bf16_f32 v145, v90, v91
    ds_write_b64 v21, v[144:145] offset:0
    v_pk_add_f32 v[92:93], v[92:93], v[104:105]
    v_pk_add_f32 v[94:95], v[94:95], v[106:107]
    v_pk_mul_f32 v[92:93], v[92:93], v[120:121] op_sel_hi:[1,0]
    v_pk_mul_f32 v[94:95], v[94:95], v[120:121] op_sel_hi:[1,0]
    v_pk_fma_f32 v[92:93], v[128:129], v[120:121], v[92:93] op_sel:[0,1,0]
    v_pk_fma_f32 v[94:95], v[130:131], v[120:121], v[94:95] op_sel:[0,1,0]
    v_cvt_pk_bf16_f32 v146, v92, v93
    v_cvt_pk_bf16_f32 v147, v94, v95
    ds_write_b64 v21, v[146:147] offset:32
    v_pk_add_f32 v[96:97], v[96:97], v[108:109]
    v_pk_add_f32 v[98:99], v[98:99], v[110:111]
    v_pk_mul_f32 v[96:97], v[96:97], v[120:121] op_sel_hi:[1,0]
    v_pk_mul_f32 v[98:99], v[98:99], v[120:121] op_sel_hi:[1,0]
    v_pk_fma_f32 v[96:97], v[132:133], v[120:121], v[96:97] op_sel:[0,1,0]
    v_pk_fma_f32 v[98:99], v[134:135], v[120:121], v[98:99] op_sel:[0,1,0]
    v_cvt_pk_bf16_f32 v148, v96, v97
    v_cvt_pk_bf16_f32 v149, v98, v99
    ds_write_b64 v21, v[148:149] offset:64
    s_waitcnt lgkmcnt(0)
    s_branch P2_entry
K1_hi:
    v_xor_b32 v16, 96, v16
    s_lshl_b32 s49, s42, 10
    s_add_u32 s49, s49, 110592
    v_add_u32 v17, s49, v22
    v_lshrrev_b32 v1, 3, v5
    v_lshl_add_u32 v1, v6, 2, v1
    v_bfe_u32 v2, v5, 1, 1
    v_and_b32 v164, 7, v1
    v_xor_b32 v164, v164, v2
    v_add_u32 v1, 2, v1
    v_and_b32 v165, 7, v1
    v_xor_b32 v165, v165, v2
    v_lshrrev_b32 v1, 2, v5
    v_lshl_add_u32 v2, v6, 3, v1
    v_and_b32 v3, 1, v5
    v_lshlrev_b32 v3, 3, v3
    v_lshl_add_u32 v166, v2, 7, v3
    v_lshlrev_b32 v167, 4, v0
    s_mul_i32 s53, s52, 3
    s_add_u32 s53, s53, 0
    s_cmp_ge_u32 s53, 5
    s_cselect_b32 s54, 1, 0
    s_mul_i32 s55, s54, 5
    s_sub_u32 s55, s53, s55
    s_mul_i32 s56, s17, 5
    s_add_u32 s56, s56, s55
    s_min_u32 s56, s56, 39
    s_and_b32 s57, s56, 3
    s_lshl_b32 s57, s57, 1
    s_lshr_b32 s56, s56, 2
    s_sub_u32 s56, s56, s18
    s_cselect_b32 s58, 10, 0
    s_add_u32 s56, s56, s58
    s_lshl_b32 s56, s56, 13
    s_lshl_b32 s58, s54, 12
    s_add_u32 s56, s56, s58
    v_xor_b32 v1, s57, v164
    v_lshl_add_u32 v1, v1, 4, v166
    v_add_u32 v52, s56, v1
    v_xor_b32 v1, s57, v165
    v_lshl_add_u32 v1, v1, 4, v166
    v_add_u32 v53, s56, v1
    s_lshl_b32 s58, s54, 7
    s_add_u32 s58, s58, 161024
    v_lshl_add_u32 v58, v6, 5, s58
    s_lshl_b32 s58, s17, 6
    s_lshl_b32 s59, s16, 1
    s_add_u32 s58, s58, s59
    s_add_u32 s58, s58, s54
    s_mul_i32 s58, s58, 5120
    s_lshl_b32 s55, s55, 10
    s_add_u32 s58, s58, s55
    s_add_u32 s58, s58, 2621440
    s_cmp_ge_u32 s53, 10
    s_cselect_b32 s60, 0x40000000, s58
    s_mul_i32 s53, s52, 3
    s_add_u32 s53, s53, 1
    s_cmp_ge_u32 s53, 5
    s_cselect_b32 s54, 1, 0
    s_mul_i32 s55, s54, 5
    s_sub_u32 s55, s53, s55
    s_mul_i32 s56, s17, 5
    s_add_u32 s56, s56, s55
    s_min_u32 s56, s56, 39
    s_and_b32 s57, s56, 3
    s_lshl_b32 s57, s57, 1
    s_lshr_b32 s56, s56, 2
    s_sub_u32 s56, s56, s18
    s_cselect_b32 s58, 10, 0
    s_add_u32 s56, s56, s58
    s_lshl_b32 s56, s56, 13
    s_lshl_b32 s58, s54, 12
    s_add_u32 s56, s56, s58
    v_xor_b32 v1, s57, v164
    v_lshl_add_u32 v1, v1, 4, v166
    v_add_u32 v54, s56, v1
    v_xor_b32 v1, s57, v165
    v_lshl_add_u32 v1, v1, 4, v166
    v_add_u32 v55, s56, v1
    s_lshl_b32 s58, s54, 7
    s_add_u32 s58, s58, 161024
    v_lshl_add_u32 v59, v6, 5, s58
    s_lshl_b32 s58, s17, 6
    s_lshl_b32 s59, s16, 1
    s_add_u32 s58, s58, s59
    s_add_u32 s58, s58, s54
    s_mul_i32 s58, s58, 5120
    s_lshl_b32 s55, s55, 10
    s_add_u32 s58, s58, s55
    s_add_u32 s58, s58, 2621440
    s_cmp_ge_u32 s53, 10
    s_cselect_b32 s61, 0x40000000, s58
    s_mul_i32 s53, s52, 3
    s_add_u32 s53, s53, 2
    s_cmp_ge_u32 s53, 5
    s_cselect_b32 s54, 1, 0
    s_mul_i32 s55, s54, 5
    s_sub_u32 s55, s53, s55
    s_mul_i32 s56, s17, 5
    s_add_u32 s56, s56, s55
    s_min_u32 s56, s56, 39
    s_and_b32 s57, s56, 3
    s_lshl_b32 s57, s57, 1
    s_lshr_b32 s56, s56, 2
    s_sub_u32 s56, s56, s18
    s_cselect_b32 s58, 10, 0
    s_add_u32 s56, s56, s58
    s_lshl_b32 s56, s56, 13
    s_lshl_b32 s58, s54, 12
    s_add_u32 s56, s56, s58
    v_xor_b32 v1, s57, v164
    v_lshl_add_u32 v1, v1, 4, v166
    v_add_u32 v56, s56, v1
    v_xor_b32 v1, s57, v165
    v_lshl_add_u32 v1, v1, 4, v166
    v_add_u32 v57, s56, v1
    s_lshl_b32 s58, s54, 7
    s_add_u32 s58, s58, 161024
    v_lshl_add_u32 v60, v6, 5, s58
    s_lshl_b32 s58, s17, 6
    s_lshl_b32 s59, s16, 1
    s_add_u32 s58, s58, s59
    s_add_u32 s58, s58, s54
    s_mul_i32 s58, s58, 5120
    s_lshl_b32 s55, s55, 10
    s_add_u32 s58, s58, s55
    s_add_u32 s58, s58, 2621440
    s_cmp_ge_u32 s53, 10
    s_cselect_b32 s62, 0x40000000, s58
    v_lshrrev_b32 v1, 3, v0
    v_and_b32 v2, 7, v0
    v_bfe_u32 v4, v1, 1, 1
    v_lshlrev_b32 v4, 2, v4
    v_xor_b32 v4, v4, v2
    v_mul_u32_u24 v3, 1280, v1
    v_lshl_add_u32 v96, v4, 4, v3
    v_xor_b32 v97, 32, v96
    v_add_u32 v97, 9216, v97
    s_mul_i32 s47, s52, 20480
    s_mul_i32 s49, s17, 160
    s_add_u32 s47, s47, s49
    s_lshl_b32 s51, s52, 9
    s_lshl_b32 s48, s52, 11
    v_bfe_u32 v3, v0, 1, 4
    v_and_b32 v98, 0x13, v3
    v_bfe_u32 v4, v3, 2, 1
    v_lshl_or_b32 v98, v4, 3, v98
    v_bfe_u32 v4, v3, 3, 1
    v_lshl_or_b32 v98, v4, 2, v98
    v_mul_u32_u24 v98, 1280, v98
    v_and_b32 v3, 1, v0
    v_lshl_add_u32 v98, v3, 4, v98
    v_add_u32 v98, 128, v98
    s_mov_b32 s24, s6
    s_mov_b32 s25, s7
    s_mov_b32 s26, 819200
    s_mov_b32 s27, 0x20000
    s_add_u32 s44, s18, 0
    s_sub_u32 s43, s44, 10
    s_cselect_b32 s44, s44, s43
    s_mul_i32 s44, s44, 81920
    s_add_u32 m0, s48, 102400
    s_add_u32 s44, s44, s47
    buffer_load_dwordx4 v96, s[24:27], s44 offen offset:0 lds
    buffer_load_dwordx4 v97, s[24:27], s44 offen offset:1024 lds
    s_add_u32 m0, s51, 110592
    s_mov_b32 exec_hi, 0
    buffer_load_dwordx4 v98, s[24:27], s44 offen lds
    s_mov_b32 exec_hi, -1
    s_add_u32 s44, s18, 1
    s_sub_u32 s43, s44, 10
    s_cselect_b32 s44, s44, s43
    s_mul_i32 s44, s44, 81920
    s_add_u32 m0, s48, 112640
    s_add_u32 s44, s44, s47
    buffer_load_dwordx4 v96, s[24:27], s44 offen offset:0 lds
    buffer_load_dwordx4 v97, s[24:27], s44 offen offset:1024 lds
    s_add_u32 m0, s51, 120832
    s_mov_b32 exec_hi, 0
    buffer_load_dwordx4 v98, s[24:27], s44 offen lds
    s_mov_b32 exec_hi, -1
    s_barrier
    s_add_u32 s44, s18, 2
    s_sub_u32 s43, s44, 10
    s_cselect_b32 s44, s44, s43
    s_mul_i32 s44, s44, 81920
    s_add_u32 m0, s48, 122880
    s_add_u32 s44, s44, s47
    buffer_load_dwordx4 v96, s[24:27], s44 offen offset:0 lds
    buffer_load_dwordx4 v97, s[24:27], s44 offen offset:1024 lds
    s_add_u32 m0, s51, 131072
    s_mov_b32 exec_hi, 0
    buffer_load_dwordx4 v98, s[24:27], s44 offen lds
    s_mov_b32 exec_hi, -1
    s_barrier
    ds_read_b64_tr_b16 v[76:77], v52 offset:0
    ds_read_b64_tr_b16 v[78:79], v53 offset:512
    ds_read_b64_tr_b16 v[80:81], v54 offset:0
    ds_read_b64_tr_b16 v[82:83], v55 offset:512
    ds_read_b64_tr_b16 v[84:85], v56 offset:0
    ds_read_b64_tr_b16 v[86:87], v57 offset:512
    s_add_u32 s44, s18, 3
    s_sub_u32 s43, s44, 10
    s_cselect_b32 s44, s44, s43
    s_mul_i32 s44, s44, 81920
    s_add_u32 m0, s48, 133120
    s_add_u32 s44, s44, s47
    buffer_load_dwordx4 v96, s[24:27], s44 offen offset:0 lds
    buffer_load_dwordx4 v97, s[24:27], s44 offen offset:1024 lds
    s_add_u32 m0, s51, 141312
    s_mov_b32 exec_hi, 0
    buffer_load_dwordx4 v98, s[24:27], s44 offen lds
    s_mov_b32 exec_hi, -1
    s_add_u32 s44, s18, 4
    s_sub_u32 s43, s44, 10
    s_cselect_b32 s44, s44, s43
    s_mul_i32 s44, s44, 81920
    s_add_u32 m0, s48, 143360
    s_add_u32 s44, s44, s47
    buffer_load_dwordx4 v96, s[24:27], s44 offen offset:0 lds
    buffer_load_dwordx4 v97, s[24:27], s44 offen offset:1024 lds
    s_add_u32 m0, s51, 151552
    s_mov_b32 exec_hi, 0
    buffer_load_dwordx4 v98, s[24:27], s44 offen lds
    s_mov_b32 exec_hi, -1
    s_waitcnt lgkmcnt(4)
    v_lshlrev_b32 v120, 16, v76
    v_and_b32 v121, 0xffff0000, v76
    v_lshlrev_b32 v122, 16, v77
    v_and_b32 v123, 0xffff0000, v77
    v_lshlrev_b32 v124, 16, v78
    v_and_b32 v125, 0xffff0000, v78
    v_lshlrev_b32 v126, 16, v79
    v_and_b32 v127, 0xffff0000, v79
    s_waitcnt lgkmcnt(2)
    v_lshlrev_b32 v128, 16, v80
    v_and_b32 v129, 0xffff0000, v80
    v_lshlrev_b32 v130, 16, v81
    v_and_b32 v131, 0xffff0000, v81
    v_lshlrev_b32 v132, 16, v82
    v_and_b32 v133, 0xffff0000, v82
    v_lshlrev_b32 v134, 16, v83
    v_and_b32 v135, 0xffff0000, v83
    s_waitcnt lgkmcnt(0)
    v_lshlrev_b32 v136, 16, v84
    v_and_b32 v137, 0xffff0000, v84
    v_lshlrev_b32 v138, 16, v85
    v_and_b32 v139, 0xffff0000, v85
    v_lshlrev_b32 v140, 16, v86
    v_and_b32 v141, 0xffff0000, v86
    v_lshlrev_b32 v142, 16, v87
    v_and_b32 v143, 0xffff0000, v87
    s_barrier
    ds_read_b128 v[144:147], v58 offset:0
    ds_read_b128 v[152:155], v58 offset:256
    ds_read_b128 v[148:151], v58 offset:16
    ds_read_b128 v[156:159], v58 offset:272
    ds_read_b128 v[24:27], v59 offset:0
    ds_read_b128 v[32:35], v59 offset:256
    ds_read_b128 v[28:31], v59 offset:16
    ds_read_b128 v[36:39], v59 offset:272
    s_waitcnt lgkmcnt(4)
    v_pk_fma_f32 v[120:121], v[120:121], v[144:145], v[152:153]
    v_pk_fma_f32 v[122:123], v[122:123], v[146:147], v[154:155]
    v_pk_fma_f32 v[124:125], v[124:125], v[148:149], v[156:157]
    v_pk_fma_f32 v[126:127], v[126:127], v[150:151], v[158:159]
    ds_read_b128 v[144:147], v60 offset:0
    ds_read_b128 v[152:155], v60 offset:256
    ds_read_b128 v[148:151], v60 offset:16
    ds_read_b128 v[156:159], v60 offset:272
    v_cvt_pk_bf16_f32 v76, v120, v121
    v_cvt_pk_bf16_f32 v77, v122, v123
    v_cvt_pk_bf16_f32 v78, v124, v125
    v_cvt_pk_bf16_f32 v79, v126, v127
    buffer_store_dwordx4 v[76:79], v167, s[36:39], s60 offen sc1
    s_waitcnt lgkmcnt(4)
    v_pk_fma_f32 v[128:129], v[128:129], v[24:25], v[32:33]
    v_pk_fma_f32 v[130:131], v[130:131], v[26:27], v[34:35]
    v_pk_fma_f32 v[132:133], v[132:133], v[28:29], v[36:37]
    v_pk_fma_f32 v[134:135], v[134:135], v[30:31], v[38:39]
    v_cvt_pk_bf16_f32 v80, v128, v129
    v_cvt_pk_bf16_f32 v81, v130, v131
    v_cvt_pk_bf16_f32 v82, v132, v133
    v_cvt_pk_bf16_f32 v83, v134, v135
    buffer_store_dwordx4 v[80:83], v167, s[36:39], s61 offen sc1
    s_waitcnt lgkmcnt(0)
    v_pk_fma_f32 v[136:137], v[136:137], v[144:145], v[152:153]
    v_pk_fma_f32 v[138:139], v[138:139], v[146:147], v[154:155]
    v_pk_fma_f32 v[140:141], v[140:141], v[148:149], v[156:157]
    v_pk_fma_f32 v[142:143], v[142:143], v[150:151], v[158:159]
    v_cvt_pk_bf16_f32 v84, v136, v137
    v_cvt_pk_bf16_f32 v85, v138, v139
    v_cvt_pk_bf16_f32 v86, v140, v141
    v_cvt_pk_bf16_f32 v87, v142, v143
    buffer_store_dwordx4 v[84:87], v167, s[36:39], s62 offen sc1
    s_waitcnt vmcnt(15)
    s_barrier
    ds_read_b128 v[28:31], v113 offset:0
    ds_read_b128 v[24:27], v112 offset:0
    ds_read_b64_tr_b16 v[40:41], v16 offset:0
    ds_read_b64_tr_b16 v[42:43], v16 offset:512
    ds_read_b64_tr_b16 v[44:45], v17 offset:0
    ds_read_b64_tr_b16 v[46:47], v17 offset:256
    s_waitcnt lgkmcnt(0)
    s_waitcnt vmcnt(12)
    s_barrier
    v_mfma_f32_16x16x32_bf16 v[100:103], v[40:43], v[28:31], 0
    ds_read_b128 v[36:39], v113 offset:8192
    ds_read_b128 v[32:35], v112 offset:8192
    v_mfma_f32_16x16x32_bf16 v[104:107], v[44:47], v[28:31], 0
    ds_read_b64_tr_b16 v[64:65], v16 offset:10240
    ds_read_b64_tr_b16 v[66:67], v16 offset:10752
    v_mfma_f32_16x16x32_bf16 v[88:91], v[40:43], v[24:27], 0
    ds_read_b64_tr_b16 v[68:69], v17 offset:10240
    v_mfma_f32_16x16x32_bf16 v[92:95], v[44:47], v[24:27], 0
    ds_read_b64_tr_b16 v[70:71], v17 offset:10496
    s_waitcnt lgkmcnt(0)
    s_waitcnt vmcnt(9)
    s_barrier
    v_mfma_f32_16x16x32_bf16 v[100:103], v[64:67], v[36:39], v[100:103]
    ds_read_b128 v[28:31], v113 offset:16384
    ds_read_b128 v[24:27], v112 offset:16384
    v_mfma_f32_16x16x32_bf16 v[104:107], v[68:71], v[36:39], v[104:107]
    ds_read_b64_tr_b16 v[40:41], v16 offset:20480
    ds_read_b64_tr_b16 v[42:43], v16 offset:20992
    v_mfma_f32_16x16x32_bf16 v[88:91], v[64:67], v[32:35], v[88:91]
    ds_read_b64_tr_b16 v[44:45], v17 offset:20480
    v_mfma_f32_16x16x32_bf16 v[92:95], v[68:71], v[32:35], v[92:95]
    ds_read_b64_tr_b16 v[46:47], v17 offset:20736
    s_waitcnt lgkmcnt(0)
    s_waitcnt vmcnt(0)
    s_barrier
    v_mfma_f32_16x16x32_bf16 v[100:103], v[40:43], v[28:31], v[100:103]
    ds_read_b128 v[36:39], v113 offset:24576
    ds_read_b128 v[32:35], v112 offset:24576
    v_mfma_f32_16x16x32_bf16 v[104:107], v[44:47], v[28:31], v[104:107]
    ds_read_b64_tr_b16 v[64:65], v16 offset:30720
    ds_read_b64_tr_b16 v[66:67], v16 offset:31232
    v_mfma_f32_16x16x32_bf16 v[88:91], v[40:43], v[24:27], v[88:91]
    ds_read_b64_tr_b16 v[68:69], v17 offset:30720
    v_mfma_f32_16x16x32_bf16 v[92:95], v[44:47], v[24:27], v[92:95]
    ds_read_b64_tr_b16 v[70:71], v17 offset:30976
    s_waitcnt lgkmcnt(0)
    s_barrier
    v_mfma_f32_16x16x32_bf16 v[100:103], v[64:67], v[36:39], v[100:103]
    ds_read_b128 v[28:31], v113 offset:32768
    ds_read_b128 v[24:27], v112 offset:32768
    v_mfma_f32_16x16x32_bf16 v[104:107], v[68:71], v[36:39], v[104:107]
    ds_read_b64_tr_b16 v[40:41], v16 offset:40960
    ds_read_b64_tr_b16 v[42:43], v16 offset:41472
    v_mfma_f32_16x16x32_bf16 v[88:91], v[64:67], v[32:35], v[88:91]
    ds_read_b64_tr_b16 v[44:45], v17 offset:40960
    v_mfma_f32_16x16x32_bf16 v[92:95], v[68:71], v[32:35], v[92:95]
    ds_read_b64_tr_b16 v[46:47], v17 offset:41216
    s_waitcnt lgkmcnt(0)
    s_barrier
    v_mfma_f32_16x16x32_bf16 v[100:103], v[40:43], v[28:31], v[100:103]
    ds_read_b128 v[36:39], v113 offset:40960
    ds_read_b128 v[32:35], v112 offset:40960
    v_mfma_f32_16x16x32_bf16 v[104:107], v[44:47], v[28:31], v[104:107]
    ds_read_b64_tr_b16 v[64:65], v16 offset:0
    ds_read_b64_tr_b16 v[66:67], v16 offset:512
    v_mfma_f32_16x16x32_bf16 v[88:91], v[40:43], v[24:27], v[88:91]
    ds_read_b64_tr_b16 v[68:69], v17 offset:0
    v_mfma_f32_16x16x32_bf16 v[92:95], v[44:47], v[24:27], v[92:95]
    ds_read_b64_tr_b16 v[70:71], v17 offset:256
    s_waitcnt lgkmcnt(0)
    s_barrier
    v_mfma_f32_16x16x32_bf16 v[100:103], v[64:67], v[36:39], v[100:103]
    ds_read_b128 v[28:31], v113 offset:49152
    ds_read_b128 v[24:27], v112 offset:49152
    v_mfma_f32_16x16x32_bf16 v[104:107], v[68:71], v[36:39], v[104:107]
    ds_read_b64_tr_b16 v[40:41], v16 offset:10240
    ds_read_b64_tr_b16 v[42:43], v16 offset:10752
    v_mfma_f32_16x16x32_bf16 v[88:91], v[64:67], v[32:35], v[88:91]
    ds_read_b64_tr_b16 v[44:45], v17 offset:10240
    v_mfma_f32_16x16x32_bf16 v[92:95], v[68:71], v[32:35], v[92:95]
    ds_read_b64_tr_b16 v[46:47], v17 offset:10496
    s_waitcnt lgkmcnt(0)
    s_barrier
    v_mfma_f32_16x16x32_bf16 v[100:103], v[40:43], v[28:31], v[100:103]
    ds_read_b128 v[36:39], v115 offset:0
    ds_read_b128 v[32:35], v114 offset:0
    v_mfma_f32_16x16x32_bf16 v[104:107], v[44:47], v[28:31], v[104:107]
    ds_read_b64_tr_b16 v[64:65], v16 offset:20480
    ds_read_b64_tr_b16 v[66:67], v16 offset:20992
    v_mfma_f32_16x16x32_bf16 v[88:91], v[40:43], v[24:27], v[88:91]
    ds_read_b64_tr_b16 v[68:69], v17 offset:20480
    v_mfma_f32_16x16x32_bf16 v[92:95], v[44:47], v[24:27], v[92:95]
    ds_read_b64_tr_b16 v[70:71], v17 offset:20736
    s_waitcnt lgkmcnt(0)
    s_barrier
    v_mfma_f32_16x16x32_bf16 v[100:103], v[64:67], v[36:39], v[100:103]
    ds_read_b128 v[28:31], v115 offset:8192
    ds_read_b128 v[24:27], v114 offset:8192
    v_mfma_f32_16x16x32_bf16 v[104:107], v[68:71], v[36:39], v[104:107]
    ds_read_b64_tr_b16 v[40:41], v16 offset:30720
    ds_read_b64_tr_b16 v[42:43], v16 offset:31232
    v_mfma_f32_16x16x32_bf16 v[88:91], v[64:67], v[32:35], v[88:91]
    ds_read_b64_tr_b16 v[44:45], v17 offset:30720
    v_mfma_f32_16x16x32_bf16 v[92:95], v[68:71], v[32:35], v[92:95]
    ds_read_b64_tr_b16 v[46:47], v17 offset:30976
    s_waitcnt lgkmcnt(0)
    s_barrier
    v_mfma_f32_16x16x32_bf16 v[100:103], v[40:43], v[28:31], v[100:103]
    ds_read_b128 v[36:39], v115 offset:16384
    ds_read_b128 v[32:35], v114 offset:16384
    v_mfma_f32_16x16x32_bf16 v[104:107], v[44:47], v[28:31], v[104:107]
    ds_read_b64_tr_b16 v[64:65], v16 offset:40960
    ds_read_b64_tr_b16 v[66:67], v16 offset:41472
    v_mfma_f32_16x16x32_bf16 v[88:91], v[40:43], v[24:27], v[88:91]
    ds_read_b64_tr_b16 v[68:69], v17 offset:40960
    v_mfma_f32_16x16x32_bf16 v[92:95], v[44:47], v[24:27], v[92:95]
    ds_read_b64_tr_b16 v[70:71], v17 offset:41216
    s_waitcnt lgkmcnt(0)
    v_mfma_f32_16x16x32_bf16 v[100:103], v[64:67], v[36:39], v[100:103]
    v_mfma_f32_16x16x32_bf16 v[104:107], v[68:71], v[36:39], v[104:107]
    v_mfma_f32_16x16x32_bf16 v[88:91], v[64:67], v[32:35], v[88:91]
    v_mfma_f32_16x16x32_bf16 v[92:95], v[68:71], v[32:35], v[92:95]
    s_nop 4
    ds_write_b128 v116, v[100:103] offset:0
    ds_write_b128 v116, v[104:107] offset:1024
    s_waitcnt lgkmcnt(0)
    s_barrier
    ds_read_b128 v[100:103], v117 offset:0
    ds_read_b128 v[104:107], v117 offset:1024
    ds_read_b64 v[120:121], v19 offset:8
    ds_read_b128 v[124:127], v20 offset:192
    ds_read_b128 v[128:131], v20 offset:256
    ds_read_b128 v[136:139], v20 offset:320
    s_waitcnt lgkmcnt(0)
    v_pk_add_f32 v[128:129], v[128:129], v[136:137]
    v_pk_add_f32 v[130:131], v[130:131], v[138:139]
    v_pk_add_f32 v[88:89], v[88:89], v[100:101]
    v_pk_add_f32 v[90:91], v[90:91], v[102:103]
    v_pk_mul_f32 v[88:89], v[88:89], v[120:121] op_sel_hi:[1,0]
    v_pk_mul_f32 v[90:91], v[90:91], v[120:121] op_sel_hi:[1,0]
    v_pk_fma_f32 v[88:89], v[124:125], v[120:121], v[88:89] op_sel:[0,1,0]
    v_pk_fma_f32 v[90:91], v[126:127], v[120:121], v[90:91] op_sel:[0,1,0]
    v_cvt_pk_bf16_f32 v144, v88, v89
    v_cvt_pk_bf16_f32 v145, v90, v91
    ds_write_b64 v21, v[144:145] offset:96
    v_pk_add_f32 v[92:93], v[92:93], v[104:105]
    v_pk_add_f32 v[94:95], v[94:95], v[106:107]
    v_pk_mul_f32 v[92:93], v[92:93], v[120:121] op_sel_hi:[1,0]
    v_pk_mul_f32 v[94:95], v[94:95], v[120:121] op_sel_hi:[1,0]
    v_pk_fma_f32 v[92:93], v[128:129], v[120:121], v[92:93] op_sel:[0,1,0]
    v_pk_fma_f32 v[94:95], v[130:131], v[120:121], v[94:95] op_sel:[0,1,0]
    v_cvt_pk_bf16_f32 v146, v92, v93
    v_cvt_pk_bf16_f32 v147, v94, v95
    ds_write_b64 v21, v[146:147] offset:128
    s_waitcnt lgkmcnt(0)
    s_branch P2_entry
K1_end:
    s_endpgm
P2_entry:
    s_waitcnt lgkmcnt(0)
    s_load_dwordx2 s[8:9], s[0:1], 96
    s_load_dwordx4 s[4:7], s[0:1], 48
    s_load_dwordx2 s[10:11], s[0:1], 32
    s_load_dwordx2 s[64:65], s[0:1], 0
    s_load_dwordx4 s[68:71], s[0:1], 64
    s_load_dwordx2 s[66:67], s[0:1], 80
    s_mov_b32 s30, s19
    s_and_b32 s24, s2, 7
    s_lshr_b32 s25, s2, 3
    s_and_b32 s34, s30, 3
    s_and_b32 s31, s25, 3
    s_lshl_b32 s26, s24, 2
    s_add_u32 s26, s26, s31
    s_lshr_b32 s27, s25, 2
    s_cmp_ge_u32 s30, 8
    s_cbranch_scc1 K2_eng
    s_lshr_b32 s33, s30, 2
    v_and_b32 v5, 31, v0
    v_lshrrev_b32 v6, 5, v0
    s_waitcnt lgkmcnt(0)
    s_mov_b32 s16, s8
    s_mov_b32 s17, s9
    s_mov_b32 s18, 12582912
    s_mov_b32 s19, 0x20000
    s_setprio 3
    s_barrier
    v_lshlrev_b32 v24, 4, v0
    s_mul_i32 s36, s30, 768
    s_add_u32 m0, s36, 153600
    s_add_u32 s35, s36, 5242880
    s_mov_b32 exec_hi, 0xffff
    buffer_load_dwordx4 v24, s[16:19], s35 offen lds
    s_mov_b32 exec_hi, -1
    s_lshl_b32 s36, s36, 1
    s_add_u32 s35, s36, 5249024
    s_add_u32 s36, s36, 110592
    s_add_u32 m0, s36, 0
    s_nop 0
    buffer_load_dwordx4 v24, s[16:19], s35 offen lds
    s_mov_b32 exec_hi, 0
    buffer_load_dwordx4 v24, s[16:19], s35 offen offset:1024 lds
    s_mov_b32 exec_hi, -1
    s_add_u32 s35, s35, 12288
    s_add_u32 m0, s36, 12288
    s_nop 0
    buffer_load_dwordx4 v24, s[16:19], s35 offen lds
    s_mov_b32 exec_hi, 0
    buffer_load_dwordx4 v24, s[16:19], s35 offen offset:1024 lds
    s_mov_b32 exec_hi, -1
    s_add_u32 s35, s35, 12288
    s_setprio 0
    v_lshlrev_b32 v12, 4, v0
    v_add_u32 v12, 110592, v12
    v_lshlrev_b32 v13, 3, v0
    v_add_u32 v13, 112640, v13
    s_lshl_b32 s31, s33, 10
    v_add_u32 v7, s31, v12
    s_lshl_b32 s31, s33, 9
    v_add_u32 v8, s31, v13
    v_and_b32 v2, 3, v5
    v_min_u32 v2, 1, v2
    v_add_u32 v2, 20, v2
    v_cmp_le_u32 vcc, 20, v5
    v_mov_b32 v1, 21
    s_nop 0
    v_cndmask_b32 v1, v5, v1, vcc
    v_cmp_le_u32 vcc, 24, v5
    s_nop 1
    v_cndmask_b32 v1, v1, v2, vcc
    v_cmp_le_u32 vcc, 28, v5
    v_xor_b32 v2, 1, v6
    s_nop 0
    v_cndmask_b32 v2, v6, v2, vcc
    v_mad_u32_u24 v1, v2, 24, v1
    v_lshlrev_b32 v10, 4, v1
    v_add_u32 v10, 113664, v10
    s_mul_i32 s31, s33, 768
    v_add_u32 v9, s31, v10
    v_mov_b32 v11, 0xdddddddd
    s_xor_b32 s32, s30, 4
    s_mul_i32 s31, s30, 3072
    s_add_u32 s31, s31, 110592
    v_lshl_add_u32 v14, v0, 4, s31
    s_mul_i32 s31, s32, 3072
    s_add_u32 s31, s31, 110592
    v_lshl_add_u32 v15, v0, 4, s31
    v_mov_b32 v21, v15
    v_lshl_add_u32 v20, v5, 1, s31
    v_lshl_add_u32 v20, v6, 8, v20
    s_lshl_b32 s31, s30, 2
    s_add_u32 s31, s31, 159744
    v_mov_b32 v16, s31
    v_xor_b32 v17, 16, v16
    s_lshl_b32 s31, s30, 8
    s_add_u32 s31, s31, 160000
    v_lshl_add_u32 v18, v0, 2, s31
    s_lshl_b32 s31, s32, 8
    s_add_u32 s31, s31, 160000
    v_lshl_add_u32 v19, v0, 2, s31
    s_mul_i32 s31, s26, 81920
    s_mul_i32 s32, s27, 10240
    s_add_u32 s31, s31, s32
    s_mul_i32 s32, s34, 2560
    s_add_u32 s31, s31, s32
    s_lshl_b32 s32, s33, 6
    s_add_u32 s31, s31, s32
    s_add_u32 s31, s31, 9437184
    v_lshrrev_b32 v1, 2, v0
    v_and_b32 v2, 3, v0
    v_lshl_add_u32 v22, v1, 7, s31
    v_lshl_add_u32 v22, v2, 4, v22
    v_mov_b32 v1, 0
    ds_write_b32 v16, v1
    v_mov_b32 v25, 159840
    v_mov_b32 v26, 1
    v_mov_b32 v104, 0
    v_mov_b32 v120, 0
    v_mov_b32 v105, 0
    v_mov_b32 v121, 0
    v_mov_b32 v106, 0
    v_mov_b32 v122, 0
    v_mov_b32 v107, 0
    v_mov_b32 v123, 0
    v_mov_b32 v108, 0
    v_mov_b32 v124, 0
    v_mov_b32 v109, 0
    v_mov_b32 v125, 0
    v_mov_b32 v110, 0
    v_mov_b32 v126, 0
    v_mov_b32 v111, 0
    v_mov_b32 v127, 0
    v_mov_b32 v112, 0
    v_mov_b32 v128, 0
    v_mov_b32 v113, 0
    v_mov_b32 v129, 0
    v_mov_b32 v114, 0
    v_mov_b32 v130, 0
    v_mov_b32 v115, 0
    v_mov_b32 v131, 0
    v_mov_b32 v116, 0
    v_mov_b32 v132, 0
    v_mov_b32 v117, 0
    v_mov_b32 v133, 0
    v_mov_b32 v118, 0
    v_mov_b32 v134, 0
    v_mov_b32 v119, 0
    v_mov_b32 v135, 0
    v_cmp_le_u32 s[50:51], 32, v0
    s_mul_i32 s31, s33, 5120
    s_mul_i32 s32, s34, 40
    s_add_u32 s32, s32, 135168
    s_add_u32 s31, s31, s32
    v_mul_u32_u24 v3, 160, v5
    v_add_u32 v1, s31, v3
    s_mul_i32 s31, s33, 5120
    s_sub_u32 s31, 5120, s31
    s_add_u32 s31, s31, s32
    v_add_u32 v2, s31, v3
    v_lshl_add_u32 v3, v6, 4, v1
    v_lshl_add_u32 v4, v6, 4, v2
    s_waitcnt vmcnt(4)
    s_waitcnt lgkmcnt(0)
    s_mov_b64 exec, 1
    ds_add_u32 v25, v26 offset:8
    s_mov_b64 exec, -1
    s_mov_b32 s63, 1048576
K2_P:
    ds_read_b32 v27, v25 offset:8
    s_waitcnt lgkmcnt(0)
    v_readfirstlane_b32 s31, v27
    s_nop 0
    s_cmp_ge_u32 s31, 8
    s_cbranch_scc1 K2_P_x
    s_sub_u32 s63, s63, 1
    s_cbranch_scc0 K2_P
K2_P_x:
    ds_read_b64 v[28:29], v3 offset:0
    ds_read_b64 v[30:31], v3 offset:8
    ds_read_b64 v[36:37], v1 offset:32
    ds_read_b64 v[32:33], v4 offset:0
    ds_read_b64 v[34:35], v4 offset:8
    ds_read_b64 v[38:39], v2 offset:32
    ds_read_b128 v[40:43], v12 offset:43008
    ds_read_b64 v[44:45], v13 offset:43008
    ds_read_b128 v[48:51], v9 offset:43008
    s_waitcnt lgkmcnt(1)
    v_mfma_f32_32x32x16_bf16 v[72:87], v[40:43], v[28:31], 0
    v_mfma_f32_32x32x16_bf16 v[88:103], v[40:43], v[32:35], 0
    v_cndmask_b32 v36, v36, 0, s[50:51]
    v_cndmask_b32 v37, v37, 0, s[50:51]
    v_cndmask_b32 v38, v38, 0, s[50:51]
    v_cndmask_b32 v39, v39, 0, s[50:51]
    v_mfma_f32_32x32x8_bf16 v[72:87], v[44:45], v[36:37], v[72:87]
    s_nop 0
    v_mfma_f32_32x32x8_bf16 v[88:103], v[44:45], v[38:39], v[88:103]
    ds_read_b128 v[40:43], v7 offset:43008
    ds_read_b64 v[44:45], v8 offset:43008
    s_nop 7
    v_max3_f32 v1, v72, v73, v74
    s_nop 0
    v_max3_f32 v3, v88, v89, v90
    v_max3_f32 v1, v1, v75, v76
    v_max3_f32 v3, v3, v91, v92
    v_max3_f32 v1, v1, v77, v78
    v_max3_f32 v3, v3, v93, v94
    v_max3_f32 v1, v1, v79, v80
    v_max3_f32 v3, v3, v95, v96
    v_max3_f32 v1, v1, v81, v82
    v_max3_f32 v3, v3, v97, v98
    v_max3_f32 v1, v1, v83, v84
    v_max3_f32 v3, v3, v99, v100
    v_max3_f32 v1, v1, v85, v86
    v_max3_f32 v3, v3, v101, v102
    v_max_f32 v1, v1, v87
    v_max_f32 v3, v3, v103
    v_mov_b32 v2, v1
    v_mov_b32 v4, v3
    s_nop 0
    v_permlane32_swap_b32 v1, v2
    v_permlane32_swap_b32 v3, v4
    v_max_f32 v1, v1, v2
    v_max_f32 v3, v3, v4
    v_cvt_pk_bf16_f32 v1, -v1, 0
    v_cvt_pk_bf16_f32 v3, -v3, 0
    v_cndmask_b32 v36, v36, v1, s[50:51]
    v_cndmask_b32 v38, v38, v3, s[50:51]
    s_waitcnt lgkmcnt(0)
    v_mfma_f32_32x32x16_bf16 v[56:71], v[40:43], v[28:31], 0
    v_mfma_f32_32x32x8_bf16 v[56:71], v[44:45], v[36:37], v[56:71]
    s_waitcnt vmcnt(2)
    s_mov_b64 exec, 1
    ds_add_u32 v25, v26 offset:12
    s_mov_b64 exec, -1
    v_mfma_f32_32x32x16_bf16 v[72:87], v[40:43], v[32:35], 0
    ds_read_b32 v27, v25 offset:12
    s_nop 5
    v_exp_f32 v56, v56
    v_exp_f32 v57, v57
    v_exp_f32 v58, v58
    s_waitcnt vmcnt(0) lgkmcnt(0)
    s_mov_b64 exec, 1
    ds_add_u32 v25, v26 offset:0
    s_mov_b64 exec, -1
    v_readfirstlane_b32 s31, v27
    s_nop 0
    s_cmp_lt_u32 s31, 8
    s_cbranch_scc1 K2_slow0
K2_go0:
    v_exp_f32 v59, v59
    ds_read_b128 v[40:43], v7 offset:0
    v_mfma_f32_32x32x8_bf16 v[72:87], v[44:45], v[38:39], v[72:87]
    ds_read_b64 v[44:45], v8 offset:0
    v_exp_f32 v60, v60
    s_add_u32 m0, s36, 24576
    v_exp_f32 v61, v61
    buffer_load_dwordx4 v24, s[16:19], s35 offen lds
    v_exp_f32 v62, v62
    s_mov_b32 exec_hi, 0
    buffer_load_dwordx4 v24, s[16:19], s35 offen offset:1024 lds
    s_mov_b32 exec_hi, -1
    v_exp_f32 v63, v63
    s_add_u32 s35, s35, 12288
    ds_read_b128 v[52:55], v9 offset:1536
    v_exp_f32 v64, v64
    v_exp_f32 v65, v65
    v_exp_f32 v66, v66
    v_exp_f32 v67, v67
    v_smfmac_f32_32x32x32_bf16 v[104:119], v[48:51], v[56:63], v11
    v_exp_f32 v68, v68
    v_exp_f32 v69, v69
    v_exp_f32 v70, v70
    v_exp_f32 v71, v71
    s_waitcnt lgkmcnt(1)
    v_mfma_f32_32x32x16_bf16 v[88:103], v[40:43], v[28:31], 0
    v_exp_f32 v72, v72
    v_exp_f32 v73, v73
    v_exp_f32 v74, v74
    v_exp_f32 v75, v75
    v_mfma_f32_32x32x8_bf16 v[88:103], v[44:45], v[36:37], v[88:103]
    v_exp_f32 v76, v76
    v_exp_f32 v77, v77
    v_exp_f32 v78, v78
    v_exp_f32 v79, v79
    s_waitcnt lgkmcnt(0)
    v_smfmac_f32_32x32x32_bf16 v[104:119], v[52:55], v[64:71], v11
    v_exp_f32 v80, v80
    v_exp_f32 v81, v81
    v_exp_f32 v82, v82
    v_exp_f32 v83, v83
    v_smfmac_f32_32x32x32_bf16 v[120:135], v[48:51], v[72:79], v11
    ds_read_b128 v[48:51], v9 offset:0
    v_exp_f32 v84, v84
    v_exp_f32 v85, v85
    v_exp_f32 v86, v86
    v_exp_f32 v87, v87
    v_mfma_f32_32x32x16_bf16 v[56:71], v[40:43], v[32:35], 0
    ds_read_b128 v[40:43], v7 offset:6144
    v_exp_f32 v88, v88
    v_exp_f32 v89, v89
    v_exp_f32 v90, v90
    v_exp_f32 v91, v91
    v_mfma_f32_32x32x8_bf16 v[56:71], v[44:45], v[38:39], v[56:71]
    ds_read_b64 v[44:45], v8 offset:6144
    v_exp_f32 v92, v92
    v_exp_f32 v93, v93
    v_exp_f32 v94, v94
    v_exp_f32 v95, v95
    s_waitcnt lgkmcnt(2)
    v_smfmac_f32_32x32x32_bf16 v[120:135], v[52:55], v[80:87], v11
    ds_read_b128 v[52:55], v9 offset:7680
    v_exp_f32 v96, v96
    v_exp_f32 v97, v97
    v_exp_f32 v98, v98
    v_exp_f32 v99, v99
    v_smfmac_f32_32x32x32_bf16 v[104:119], v[48:51], v[88:95], v11
    v_exp_f32 v100, v100
    v_exp_f32 v101, v101
    v_exp_f32 v102, v102
    v_exp_f32 v103, v103
    s_waitcnt lgkmcnt(1)
    v_mfma_f32_32x32x16_bf16 v[72:87], v[40:43], v[28:31], 0
    v_exp_f32 v56, v56
    v_exp_f32 v57, v57
    v_exp_f32 v58, v58
    v_exp_f32 v59, v59
    v_mfma_f32_32x32x8_bf16 v[72:87], v[44:45], v[36:37], v[72:87]
    v_exp_f32 v60, v60
    v_exp_f32 v61, v61
    v_exp_f32 v62, v62
    v_exp_f32 v63, v63
    s_waitcnt lgkmcnt(0)
    v_smfmac_f32_32x32x32_bf16 v[104:119], v[52:55], v[96:103], v11
    v_exp_f32 v64, v64
    v_exp_f32 v65, v65
    v_exp_f32 v66, v66
    v_exp_f32 v67, v67
    v_smfmac_f32_32x32x32_bf16 v[120:135], v[48:51], v[56:63], v11
    ds_read_b128 v[48:51], v9 offset:6144
    v_exp_f32 v68, v68
    v_exp_f32 v69, v69
    v_exp_f32 v70, v70
    v_exp_f32 v71, v71
    v_mfma_f32_32x32x16_bf16 v[88:103], v[40:43], v[32:35], 0
    ds_read_b32 v27, v25 offset:0
    v_exp_f32 v72, v72
    v_exp_f32 v73, v73
    v_exp_f32 v74, v74
    s_waitcnt vmcnt(0) lgkmcnt(0)
    s_mov_b64 exec, 1
    ds_add_u32 v25, v26 offset:4
    s_mov_b64 exec, -1
    v_readfirstlane_b32 s31, v27
    s_nop 0
    s_cmp_lt_u32 s31, 8
    s_cbranch_scc1 K2_slow1
K2_go1:
    v_exp_f32 v75, v75
    ds_read_b128 v[40:43], v7 offset:12288
    v_mfma_f32_32x32x8_bf16 v[88:103], v[44:45], v[38:39], v[88:103]
    ds_read_b64 v[44:45], v8 offset:12288
    v_exp_f32 v76, v76
    s_add_u32 m0, s36, 36864
    v_exp_f32 v77, v77
    buffer_load_dwordx4 v24, s[16:19], s35 offen lds
    v_exp_f32 v78, v78
    s_mov_b32 exec_hi, 0
    buffer_load_dwordx4 v24, s[16:19], s35 offen offset:1024 lds
    s_mov_b32 exec_hi, -1
    v_exp_f32 v79, v79
    s_add_u32 s35, s35, 12288
    v_smfmac_f32_32x32x32_bf16 v[120:135], v[52:55], v[64:71], v11
    ds_read_b128 v[52:55], v9 offset:13824
    v_exp_f32 v80, v80
    v_exp_f32 v81, v81
    v_exp_f32 v82, v82
    v_exp_f32 v83, v83
    v_smfmac_f32_32x32x32_bf16 v[104:119], v[48:51], v[72:79], v11
    v_exp_f32 v84, v84
    v_exp_f32 v85, v85
    v_exp_f32 v86, v86
    v_exp_f32 v87, v87
    s_waitcnt lgkmcnt(1)
    v_mfma_f32_32x32x16_bf16 v[56:71], v[40:43], v[28:31], 0
    v_exp_f32 v88, v88
    v_exp_f32 v89, v89
    v_exp_f32 v90, v90
    v_exp_f32 v91, v91
    v_mfma_f32_32x32x8_bf16 v[56:71], v[44:45], v[36:37], v[56:71]
    v_exp_f32 v92, v92
    v_exp_f32 v93, v93
    v_exp_f32 v94, v94
    v_exp_f32 v95, v95
    s_waitcnt lgkmcnt(0)
    v_smfmac_f32_32x32x32_bf16 v[104:119], v[52:55], v[80:87], v11
    v_exp_f32 v96, v96
    v_exp_f32 v97, v97
    v_exp_f32 v98, v98
    v_exp_f32 v99, v99
    v_smfmac_f32_32x32x32_bf16 v[120:135], v[48:51], v[88:95], v11
    ds_read_b128 v[48:51], v9 offset:12288
    v_exp_f32 v100, v100
    v_exp_f32 v101, v101
    v_exp_f32 v102, v102
    v_exp_f32 v103, v103
    v_mfma_f32_32x32x16_bf16 v[72:87], v[40:43], v[32:35], 0
    ds_read_b128 v[40:43], v7 offset:18432
    v_exp_f32 v56, v56
    v_exp_f32 v57, v57
    v_exp_f32 v58, v58
    v_exp_f32 v59, v59
    v_mfma_f32_32x32x8_bf16 v[72:87], v[44:45], v[38:39], v[72:87]
    ds_read_b64 v[44:45], v8 offset:18432
    v_exp_f32 v60, v60
    v_exp_f32 v61, v61
    v_exp_f32 v62, v62
    v_exp_f32 v63, v63
    s_waitcnt lgkmcnt(2)
    v_smfmac_f32_32x32x32_bf16 v[120:135], v[52:55], v[96:103], v11
    ds_read_b128 v[52:55], v9 offset:19968
    v_exp_f32 v64, v64
    v_exp_f32 v65, v65
    v_exp_f32 v66, v66
    v_exp_f32 v67, v67
    v_smfmac_f32_32x32x32_bf16 v[104:119], v[48:51], v[56:63], v11
    v_exp_f32 v68, v68
    v_exp_f32 v69, v69
    v_exp_f32 v70, v70
    v_exp_f32 v71, v71
    s_waitcnt lgkmcnt(1)
    v_mfma_f32_32x32x16_bf16 v[88:103], v[40:43], v[28:31], 0
    v_exp_f32 v72, v72
    v_exp_f32 v73, v73
    v_exp_f32 v74, v74
    v_exp_f32 v75, v75
    v_mfma_f32_32x32x8_bf16 v[88:103], v[44:45], v[36:37], v[88:103]
    v_exp_f32 v76, v76
    v_exp_f32 v77, v77
    v_exp_f32 v78, v78
    v_exp_f32 v79, v79
    s_waitcnt lgkmcnt(0)
    v_smfmac_f32_32x32x32_bf16 v[104:119], v[52:55], v[64:71], v11
    v_exp_f32 v80, v80
    v_exp_f32 v81, v81
    v_exp_f32 v82, v82
    v_exp_f32 v83, v83
    v_smfmac_f32_32x32x32_bf16 v[120:135], v[48:51], v[72:79], v11
    ds_read_b128 v[48:51], v9 offset:18432
    v_exp_f32 v84, v84
    v_exp_f32 v85, v85
    v_exp_f32 v86, v86
    v_exp_f32 v87, v87
    v_mfma_f32_32x32x16_bf16 v[56:71], v[40:43], v[32:35], 0
    ds_read_b32 v27, v25 offset:4
    v_exp_f32 v88, v88
    v_exp_f32 v89, v89
    v_exp_f32 v90, v90
    s_waitcnt vmcnt(0) lgkmcnt(0)
    s_mov_b64 exec, 1
    ds_add_u32 v25, v26 offset:0
    s_mov_b64 exec, -1
    v_readfirstlane_b32 s31, v27
    s_nop 0
    s_cmp_lt_u32 s31, 8
    s_cbranch_scc1 K2_slow2
K2_go2:
    v_exp_f32 v91, v91
    ds_read_b128 v[40:43], v7 offset:24576
    v_mfma_f32_32x32x8_bf16 v[56:71], v[44:45], v[38:39], v[56:71]
    ds_read_b64 v[44:45], v8 offset:24576
    v_exp_f32 v92, v92
    s_add_u32 m0, s36, 0
    v_exp_f32 v93, v93
    buffer_load_dwordx4 v24, s[16:19], s35 offen lds
    v_exp_f32 v94, v94
    s_mov_b32 exec_hi, 0
    buffer_load_dwordx4 v24, s[16:19], s35 offen offset:1024 lds
    s_mov_b32 exec_hi, -1
    v_exp_f32 v95, v95
    s_add_u32 s35, s35, 12288
    v_smfmac_f32_32x32x32_bf16 v[120:135], v[52:55], v[80:87], v11
    ds_read_b128 v[52:55], v9 offset:26112
    v_exp_f32 v96, v96
    v_exp_f32 v97, v97
    v_exp_f32 v98, v98
    v_exp_f32 v99, v99
    v_smfmac_f32_32x32x32_bf16 v[104:119], v[48:51], v[88:95], v11
    v_exp_f32 v100, v100
    v_exp_f32 v101, v101
    v_exp_f32 v102, v102
    v_exp_f32 v103, v103
    s_waitcnt lgkmcnt(1)
    v_mfma_f32_32x32x16_bf16 v[72:87], v[40:43], v[28:31], 0
    v_exp_f32 v56, v56
    v_exp_f32 v57, v57
    v_exp_f32 v58, v58
    v_exp_f32 v59, v59
    v_mfma_f32_32x32x8_bf16 v[72:87], v[44:45], v[36:37], v[72:87]
    v_exp_f32 v60, v60
    v_exp_f32 v61, v61
    v_exp_f32 v62, v62
    v_exp_f32 v63, v63
    s_waitcnt lgkmcnt(0)
    v_smfmac_f32_32x32x32_bf16 v[104:119], v[52:55], v[96:103], v11
    v_exp_f32 v64, v64
    v_exp_f32 v65, v65
    v_exp_f32 v66, v66
    v_exp_f32 v67, v67
    v_smfmac_f32_32x32x32_bf16 v[120:135], v[48:51], v[56:63], v11
    ds_read_b128 v[48:51], v9 offset:24576
    v_exp_f32 v68, v68
    v_exp_f32 v69, v69
    v_exp_f32 v70, v70
    v_exp_f32 v71, v71
    v_mfma_f32_32x32x16_bf16 v[88:103], v[40:43], v[32:35], 0
    ds_read_b128 v[40:43], v7 offset:30720
    v_exp_f32 v72, v72
    v_exp_f32 v73, v73
    v_exp_f32 v74, v74
    v_exp_f32 v75, v75
    v_mfma_f32_32x32x8_bf16 v[88:103], v[44:45], v[38:39], v[88:103]
    ds_read_b64 v[44:45], v8 offset:30720
    v_exp_f32 v76, v76
    v_exp_f32 v77, v77
    v_exp_f32 v78, v78
    v_exp_f32 v79, v79
    s_waitcnt lgkmcnt(2)
    v_smfmac_f32_32x32x32_bf16 v[120:135], v[52:55], v[64:71], v11
    ds_read_b128 v[52:55], v9 offset:32256
    v_exp_f32 v80, v80
    v_exp_f32 v81, v81
    v_exp_f32 v82, v82
    v_exp_f32 v83, v83
    v_smfmac_f32_32x32x32_bf16 v[104:119], v[48:51], v[72:79], v11
    v_exp_f32 v84, v84
    v_exp_f32 v85, v85
    v_exp_f32 v86, v86
    v_exp_f32 v87, v87
    s_waitcnt lgkmcnt(1)
    v_mfma_f32_32x32x16_bf16 v[56:71], v[40:43], v[28:31], 0
    v_exp_f32 v88, v88
    v_exp_f32 v89, v89
    v_exp_f32 v90, v90
    v_exp_f32 v91, v91
    v_mfma_f32_32x32x8_bf16 v[56:71], v[44:45], v[36:37], v[56:71]
    v_exp_f32 v92, v92
    v_exp_f32 v93, v93
    v_exp_f32 v94, v94
    v_exp_f32 v95, v95
    s_waitcnt lgkmcnt(0)
    v_smfmac_f32_32x32x32_bf16 v[104:119], v[52:55], v[80:87], v11
    v_exp_f32 v96, v96
    v_exp_f32 v97, v97
    v_exp_f32 v98, v98
    v_exp_f32 v99, v99
    v_smfmac_f32_32x32x32_bf16 v[120:135], v[48:51], v[88:95], v11
    ds_read_b128 v[48:51], v9 offset:30720
    v_exp_f32 v100, v100
    v_exp_f32 v101, v101
    v_exp_f32 v102, v102
    v_exp_f32 v103, v103
    v_mfma_f32_32x32x16_bf16 v[72:87], v[40:43], v[32:35], 0
    ds_read_b32 v27, v25 offset:0
    v_exp_f32 v56, v56
    v_exp_f32 v57, v57
    v_exp_f32 v58, v58
    s_waitcnt vmcnt(0) lgkmcnt(0)
    s_mov_b64 exec, 1
    ds_add_u32 v25, v26 offset:4
    s_mov_b64 exec, -1
    v_readfirstlane_b32 s31, v27
    s_nop 0
    s_cmp_lt_u32 s31, 16
    s_cbranch_scc1 K2_slow3
K2_go3:
    v_exp_f32 v59, v59
    ds_read_b128 v[40:43], v7 offset:36864
    v_mfma_f32_32x32x8_bf16 v[72:87], v[44:45], v[38:39], v[72:87]
    ds_read_b64 v[44:45], v8 offset:36864
    v_exp_f32 v60, v60
    s_add_u32 m0, s36, 12288
    v_exp_f32 v61, v61
    buffer_load_dwordx4 v24, s[16:19], s35 offen lds
    v_exp_f32 v62, v62
    s_mov_b32 exec_hi, 0
    buffer_load_dwordx4 v24, s[16:19], s35 offen offset:1024 lds
    s_mov_b32 exec_hi, -1
    v_exp_f32 v63, v63
    s_add_u32 s35, s35, 12288
    v_smfmac_f32_32x32x32_bf16 v[120:135], v[52:55], v[96:103], v11
    ds_read_b128 v[52:55], v9 offset:38400
    v_exp_f32 v64, v64
    v_exp_f32 v65, v65
    v_exp_f32 v66, v66
    v_exp_f32 v67, v67
    v_smfmac_f32_32x32x32_bf16 v[104:119], v[48:51], v[56:63], v11
    v_exp_f32 v68, v68
    v_exp_f32 v69, v69
    v_exp_f32 v70, v70
    v_exp_f32 v71, v71
    s_waitcnt lgkmcnt(1)
    v_mfma_f32_32x32x16_bf16 v[88:103], v[40:43], v[28:31], 0
    v_exp_f32 v72, v72
    v_exp_f32 v73, v73
    v_exp_f32 v74, v74
    v_exp_f32 v75, v75
    v_mfma_f32_32x32x8_bf16 v[88:103], v[44:45], v[36:37], v[88:103]
    v_exp_f32 v76, v76
    v_exp_f32 v77, v77
    v_exp_f32 v78, v78
    v_exp_f32 v79, v79
    s_waitcnt lgkmcnt(0)
    v_smfmac_f32_32x32x32_bf16 v[104:119], v[52:55], v[64:71], v11
    v_exp_f32 v80, v80
    v_exp_f32 v81, v81
    v_exp_f32 v82, v82
    v_exp_f32 v83, v83
    v_smfmac_f32_32x32x32_bf16 v[120:135], v[48:51], v[72:79], v11
    ds_read_b128 v[48:51], v9 offset:36864
    v_exp_f32 v84, v84
    v_exp_f32 v85, v85
    v_exp_f32 v86, v86
    v_exp_f32 v87, v87
    v_mfma_f32_32x32x16_bf16 v[56:71], v[40:43], v[32:35], 0
    ds_read_b128 v[40:43], v7 offset:43008
    v_exp_f32 v88, v88
    v_exp_f32 v89, v89
    v_exp_f32 v90, v90
    v_exp_f32 v91, v91
    v_mfma_f32_32x32x8_bf16 v[56:71], v[44:45], v[38:39], v[56:71]
    ds_read_b64 v[44:45], v8 offset:43008
    v_exp_f32 v92, v92
    v_exp_f32 v93, v93
    v_exp_f32 v94, v94
    v_exp_f32 v95, v95
    s_waitcnt lgkmcnt(2)
    v_smfmac_f32_32x32x32_bf16 v[120:135], v[52:55], v[80:87], v11
    ds_read_b128 v[52:55], v9 offset:44544
    v_exp_f32 v96, v96
    v_exp_f32 v97, v97
    v_exp_f32 v98, v98
    v_exp_f32 v99, v99
    v_smfmac_f32_32x32x32_bf16 v[104:119], v[48:51], v[88:95], v11
    v_exp_f32 v100, v100
    v_exp_f32 v101, v101
    v_exp_f32 v102, v102
    v_exp_f32 v103, v103
    s_waitcnt lgkmcnt(1)
    v_mfma_f32_32x32x16_bf16 v[72:87], v[40:43], v[28:31], 0
    v_exp_f32 v56, v56
    v_exp_f32 v57, v57
    v_exp_f32 v58, v58
    v_exp_f32 v59, v59
    v_mfma_f32_32x32x8_bf16 v[72:87], v[44:45], v[36:37], v[72:87]
    v_exp_f32 v60, v60
    v_exp_f32 v61, v61
    v_exp_f32 v62, v62
    v_exp_f32 v63, v63
    s_waitcnt lgkmcnt(0)
    v_smfmac_f32_32x32x32_bf16 v[104:119], v[52:55], v[96:103], v11
    v_exp_f32 v64, v64
    v_exp_f32 v65, v65
    v_exp_f32 v66, v66
    v_exp_f32 v67, v67
    v_smfmac_f32_32x32x32_bf16 v[120:135], v[48:51], v[56:63], v11
    ds_read_b128 v[48:51], v9 offset:43008
    v_exp_f32 v68, v68
    v_exp_f32 v69, v69
    v_exp_f32 v70, v70
    v_exp_f32 v71, v71
    v_mfma_f32_32x32x16_bf16 v[88:103], v[40:43], v[32:35], 0
    ds_read_b32 v27, v25 offset:4
    v_exp_f32 v72, v72
    v_exp_f32 v73, v73
    v_exp_f32 v74, v74
    s_waitcnt vmcnt(0) lgkmcnt(0)
    s_mov_b64 exec, 1
    ds_add_u32 v25, v26 offset:0
    s_mov_b64 exec, -1
    v_readfirstlane_b32 s31, v27
    s_nop 0
    s_cmp_lt_u32 s31, 16
    s_cbranch_scc1 K2_slow4
K2_go4:
    v_exp_f32 v75, v75
    ds_read_b128 v[40:43], v7 offset:0
    v_mfma_f32_32x32x8_bf16 v[88:103], v[44:45], v[38:39], v[88:103]
    ds_read_b64 v[44:45], v8 offset:0
    v_exp_f32 v76, v76
    s_add_u32 m0, s36, 24576
    v_exp_f32 v77, v77
    buffer_load_dwordx4 v24, s[16:19], s35 offen lds
    v_exp_f32 v78, v78
    s_mov_b32 exec_hi, 0
    buffer_load_dwordx4 v24, s[16:19], s35 offen offset:1024 lds
    s_mov_b32 exec_hi, -1
    v_exp_f32 v79, v79
    s_add_u32 s35, s35, 12288
    v_smfmac_f32_32x32x32_bf16 v[120:135], v[52:55], v[64:71], v11
    ds_read_b128 v[52:55], v9 offset:1536
    v_exp_f32 v80, v80
    v_exp_f32 v81, v81
    v_exp_f32 v82, v82
    v_exp_f32 v83, v83
    v_smfmac_f32_32x32x32_bf16 v[104:119], v[48:51], v[72:79], v11
    v_exp_f32 v84, v84
    v_exp_f32 v85, v85
    v_exp_f32 v86, v86
    v_exp_f32 v87, v87
    s_waitcnt lgkmcnt(1)
    v_mfma_f32_32x32x16_bf16 v[56:71], v[40:43], v[28:31], 0
    v_exp_f32 v88, v88
    v_exp_f32 v89, v89
    v_exp_f32 v90, v90
    v_exp_f32 v91, v91
    v_mfma_f32_32x32x8_bf16 v[56:71], v[44:45], v[36:37], v[56:71]
    v_exp_f32 v92, v92
    v_exp_f32 v93, v93
    v_exp_f32 v94, v94
    v_exp_f32 v95, v95
    s_waitcnt lgkmcnt(0)
    v_smfmac_f32_32x32x32_bf16 v[104:119], v[52:55], v[80:87], v11
    v_exp_f32 v96, v96
    v_exp_f32 v97, v97
    v_exp_f32 v98, v98
    v_exp_f32 v99, v99
    v_smfmac_f32_32x32x32_bf16 v[120:135], v[48:51], v[88:95], v11
    ds_read_b128 v[48:51], v9 offset:0
    v_exp_f32 v100, v100
    v_exp_f32 v101, v101
    v_exp_f32 v102, v102
    v_exp_f32 v103, v103
    v_mfma_f32_32x32x16_bf16 v[72:87], v[40:43], v[32:35], 0
    ds_read_b128 v[40:43], v7 offset:6144
    v_exp_f32 v56, v56
    v_exp_f32 v57, v57
    v_exp_f32 v58, v58
    v_exp_f32 v59, v59
    v_mfma_f32_32x32x8_bf16 v[72:87], v[44:45], v[38:39], v[72:87]
    ds_read_b64 v[44:45], v8 offset:6144
    v_exp_f32 v60, v60
    v_exp_f32 v61, v61
    v_exp_f32 v62, v62
    v_exp_f32 v63, v63
    s_waitcnt lgkmcnt(2)
    v_smfmac_f32_32x32x32_bf16 v[120:135], v[52:55], v[96:103], v11
    ds_read_b128 v[52:55], v9 offset:7680
    v_exp_f32 v64, v64
    v_exp_f32 v65, v65
    v_exp_f32 v66, v66
    v_exp_f32 v67, v67
    v_smfmac_f32_32x32x32_bf16 v[104:119], v[48:51], v[56:63], v11
    v_exp_f32 v68, v68
    v_exp_f32 v69, v69
    v_exp_f32 v70, v70
    v_exp_f32 v71, v71
    s_waitcnt lgkmcnt(1)
    v_mfma_f32_32x32x16_bf16 v[88:103], v[40:43], v[28:31], 0
    v_exp_f32 v72, v72
    v_exp_f32 v73, v73
    v_exp_f32 v74, v74
    v_exp_f32 v75, v75
    v_mfma_f32_32x32x8_bf16 v[88:103], v[44:45], v[36:37], v[88:103]
    v_exp_f32 v76, v76
    v_exp_f32 v77, v77
    v_exp_f32 v78, v78
    v_exp_f32 v79, v79
    s_waitcnt lgkmcnt(0)
    v_smfmac_f32_32x32x32_bf16 v[104:119], v[52:55], v[64:71], v11
    v_exp_f32 v80, v80
    v_exp_f32 v81, v81
    v_exp_f32 v82, v82
    v_exp_f32 v83, v83
    v_smfmac_f32_32x32x32_bf16 v[120:135], v[48:51], v[72:79], v11
    ds_read_b128 v[48:51], v9 offset:6144
    v_exp_f32 v84, v84
    v_exp_f32 v85, v85
    v_exp_f32 v86, v86
    v_exp_f32 v87, v87
    v_mfma_f32_32x32x16_bf16 v[56:71], v[40:43], v[32:35], 0
    ds_read_b32 v27, v25 offset:0
    v_exp_f32 v88, v88
    v_exp_f32 v89, v89
    v_exp_f32 v90, v90
    s_waitcnt vmcnt(0) lgkmcnt(0)
    s_mov_b64 exec, 1
    ds_add_u32 v25, v26 offset:4
    s_mov_b64 exec, -1
    v_readfirstlane_b32 s31, v27
    s_nop 0
    s_cmp_lt_u32 s31, 24
    s_cbranch_scc1 K2_slow5
K2_go5:
    v_exp_f32 v91, v91
    ds_read_b128 v[40:43], v7 offset:12288
    v_mfma_f32_32x32x8_bf16 v[56:71], v[44:45], v[38:39], v[56:71]
    ds_read_b64 v[44:45], v8 offset:12288
    v_exp_f32 v92, v92
    s_add_u32 m0, s36, 36864
    v_exp_f32 v93, v93
    buffer_load_dwordx4 v24, s[16:19], s35 offen lds
    v_exp_f32 v94, v94
    s_mov_b32 exec_hi, 0
    buffer_load_dwordx4 v24, s[16:19], s35 offen offset:1024 lds
    s_mov_b32 exec_hi, -1
    v_exp_f32 v95, v95
    s_add_u32 s35, s35, 12288
    v_smfmac_f32_32x32x32_bf16 v[120:135], v[52:55], v[80:87], v11
    ds_read_b128 v[52:55], v9 offset:13824
    v_exp_f32 v96, v96
    v_exp_f32 v97, v97
    v_exp_f32 v98, v98
    v_exp_f32 v99, v99
    v_smfmac_f32_32x32x32_bf16 v[104:119], v[48:51], v[88:95], v11
    v_exp_f32 v100, v100
    v_exp_f32 v101, v101
    v_exp_f32 v102, v102
    v_exp_f32 v103, v103
    s_waitcnt lgkmcnt(1)
    v_mfma_f32_32x32x16_bf16 v[72:87], v[40:43], v[28:31], 0
    v_exp_f32 v56, v56
    v_exp_f32 v57, v57
    v_exp_f32 v58, v58
    v_exp_f32 v59, v59
    v_mfma_f32_32x32x8_bf16 v[72:87], v[44:45], v[36:37], v[72:87]
    v_exp_f32 v60, v60
    v_exp_f32 v61, v61
    v_exp_f32 v62, v62
    v_exp_f32 v63, v63
    s_waitcnt lgkmcnt(0)
    v_smfmac_f32_32x32x32_bf16 v[104:119], v[52:55], v[96:103], v11
    v_exp_f32 v64, v64
    v_exp_f32 v65, v65
    v_exp_f32 v66, v66
    v_exp_f32 v67, v67
    v_smfmac_f32_32x32x32_bf16 v[120:135], v[48:51], v[56:63], v11
    ds_read_b128 v[48:51], v9 offset:12288
    v_exp_f32 v68, v68
    v_exp_f32 v69, v69
    v_exp_f32 v70, v70
    v_exp_f32 v71, v71
    v_mfma_f32_32x32x16_bf16 v[88:103], v[40:43], v[32:35], 0
    ds_read_b128 v[40:43], v7 offset:18432
    v_exp_f32 v72, v72
    v_exp_f32 v73, v73
    v_exp_f32 v74, v74
    v_exp_f32 v75, v75
    v_mfma_f32_32x32x8_bf16 v[88:103], v[44:45], v[38:39], v[88:103]
    ds_read_b64 v[44:45], v8 offset:18432
    v_exp_f32 v76, v76
    v_exp_f32 v77, v77
    v_exp_f32 v78, v78
    v_exp_f32 v79, v79
    s_waitcnt lgkmcnt(2)
    v_smfmac_f32_32x32x32_bf16 v[120:135], v[52:55], v[64:71], v11
    ds_read_b128 v[52:55], v9 offset:19968
    v_exp_f32 v80, v80
    v_exp_f32 v81, v81
    v_exp_f32 v82, v82
    v_exp_f32 v83, v83
    v_smfmac_f32_32x32x32_bf16 v[104:119], v[48:51], v[72:79], v11
    v_exp_f32 v84, v84
    v_exp_f32 v85, v85
    v_exp_f32 v86, v86
    v_exp_f32 v87, v87
    s_waitcnt lgkmcnt(1)
    v_mfma_f32_32x32x16_bf16 v[56:71], v[40:43], v[28:31], 0
    v_exp_f32 v88, v88
    v_exp_f32 v89, v89
    v_exp_f32 v90, v90
    v_exp_f32 v91, v91
    v_mfma_f32_32x32x8_bf16 v[56:71], v[44:45], v[36:37], v[56:71]
    v_exp_f32 v92, v92
    v_exp_f32 v93, v93
    v_exp_f32 v94, v94
    v_exp_f32 v95, v95
    s_waitcnt lgkmcnt(0)
    v_smfmac_f32_32x32x32_bf16 v[104:119], v[52:55], v[80:87], v11
    v_exp_f32 v96, v96
    v_exp_f32 v97, v97
    v_exp_f32 v98, v98
    v_exp_f32 v99, v99
    v_smfmac_f32_32x32x32_bf16 v[120:135], v[48:51], v[88:95], v11
    ds_read_b128 v[48:51], v9 offset:18432
    v_exp_f32 v100, v100
    v_exp_f32 v101, v101
    v_exp_f32 v102, v102
    v_exp_f32 v103, v103
    v_mfma_f32_32x32x16_bf16 v[72:87], v[40:43], v[32:35], 0
    ds_read_b32 v27, v25 offset:4
    v_exp_f32 v56, v56
    v_exp_f32 v57, v57
    v_exp_f32 v58, v58
    s_waitcnt vmcnt(0) lgkmcnt(0)
    s_mov_b64 exec, 1
    ds_add_u32 v25, v26 offset:0
    s_mov_b64 exec, -1
    v_readfirstlane_b32 s31, v27
    s_nop 0
    s_cmp_lt_u32 s31, 24
    s_cbranch_scc1 K2_slow6
K2_go6:
    v_exp_f32 v59, v59
    ds_read_b128 v[40:43], v7 offset:24576
    v_mfma_f32_32x32x8_bf16 v[72:87], v[44:45], v[38:39], v[72:87]
    ds_read_b64 v[44:45], v8 offset:24576
    v_exp_f32 v60, v60
    s_add_u32 m0, s36, 0
    v_exp_f32 v61, v61
    buffer_load_dwordx4 v24, s[16:19], s35 offen lds
    v_exp_f32 v62, v62
    s_mov_b32 exec_hi, 0
    buffer_load_dwordx4 v24, s[16:19], s35 offen offset:1024 lds
    s_mov_b32 exec_hi, -1
    v_exp_f32 v63, v63
    s_add_u32 s35, s35, 12288
    v_smfmac_f32_32x32x32_bf16 v[120:135], v[52:55], v[96:103], v11
    ds_read_b128 v[52:55], v9 offset:26112
    v_exp_f32 v64, v64
    v_exp_f32 v65, v65
    v_exp_f32 v66, v66
    v_exp_f32 v67, v67
    v_smfmac_f32_32x32x32_bf16 v[104:119], v[48:51], v[56:63], v11
    v_exp_f32 v68, v68
    v_exp_f32 v69, v69
    v_exp_f32 v70, v70
    v_exp_f32 v71, v71
    s_waitcnt lgkmcnt(1)
    v_mfma_f32_32x32x16_bf16 v[88:103], v[40:43], v[28:31], 0
    v_exp_f32 v72, v72
    v_exp_f32 v73, v73
    v_exp_f32 v74, v74
    v_exp_f32 v75, v75
    v_mfma_f32_32x32x8_bf16 v[88:103], v[44:45], v[36:37], v[88:103]
    v_exp_f32 v76, v76
    v_exp_f32 v77, v77
    v_exp_f32 v78, v78
    v_exp_f32 v79, v79
    s_waitcnt lgkmcnt(0)
    v_smfmac_f32_32x32x32_bf16 v[104:119], v[52:55], v[64:71], v11
    v_exp_f32 v80, v80
    v_exp_f32 v81, v81
    v_exp_f32 v82, v82
    v_exp_f32 v83, v83
    v_smfmac_f32_32x32x32_bf16 v[120:135], v[48:51], v[72:79], v11
    ds_read_b128 v[48:51], v9 offset:24576
    v_exp_f32 v84, v84
    v_exp_f32 v85, v85
    v_exp_f32 v86, v86
    v_exp_f32 v87, v87
    v_mfma_f32_32x32x16_bf16 v[56:71], v[40:43], v[32:35], 0
    ds_read_b128 v[40:43], v7 offset:30720
    v_exp_f32 v88, v88
    v_exp_f32 v89, v89
    v_exp_f32 v90, v90
    v_exp_f32 v91, v91
    v_mfma_f32_32x32x8_bf16 v[56:71], v[44:45], v[38:39], v[56:71]
    ds_read_b64 v[44:45], v8 offset:30720
    v_exp_f32 v92, v92
    v_exp_f32 v93, v93
    v_exp_f32 v94, v94
    v_exp_f32 v95, v95
    s_waitcnt lgkmcnt(2)
    v_smfmac_f32_32x32x32_bf16 v[120:135], v[52:55], v[80:87], v11
    ds_read_b128 v[52:55], v9 offset:32256
    v_exp_f32 v96, v96
    v_exp_f32 v97, v97
    v_exp_f32 v98, v98
    v_exp_f32 v99, v99
    v_smfmac_f32_32x32x32_bf16 v[104:119], v[48:51], v[88:95], v11
    v_exp_f32 v100, v100
    v_exp_f32 v101, v101
    v_exp_f32 v102, v102
    v_exp_f32 v103, v103
    s_waitcnt lgkmcnt(1)
    v_mfma_f32_32x32x16_bf16 v[72:87], v[40:43], v[28:31], 0
    v_exp_f32 v56, v56
    v_exp_f32 v57, v57
    v_exp_f32 v58, v58
    v_exp_f32 v59, v59
    v_mfma_f32_32x32x8_bf16 v[72:87], v[44:45], v[36:37], v[72:87]
    v_exp_f32 v60, v60
    v_exp_f32 v61, v61
    v_exp_f32 v62, v62
    v_exp_f32 v63, v63
    s_waitcnt lgkmcnt(0)
    v_smfmac_f32_32x32x32_bf16 v[104:119], v[52:55], v[96:103], v11
    v_exp_f32 v64, v64
    v_exp_f32 v65, v65
    v_exp_f32 v66, v66
    v_exp_f32 v67, v67
    v_smfmac_f32_32x32x32_bf16 v[120:135], v[48:51], v[56:63], v11
    ds_read_b128 v[48:51], v9 offset:30720
    v_exp_f32 v68, v68
    v_exp_f32 v69, v69
    v_exp_f32 v70, v70
    v_exp_f32 v71, v71
    v_mfma_f32_32x32x16_bf16 v[88:103], v[40:43], v[32:35], 0
    ds_read_b32 v27, v25 offset:0
    v_exp_f32 v72, v72
    v_exp_f32 v73, v73
    v_exp_f32 v74, v74
    s_waitcnt vmcnt(0) lgkmcnt(0)
    s_mov_b64 exec, 1
    ds_add_u32 v25, v26 offset:4
    s_mov_b64 exec, -1
    v_readfirstlane_b32 s31, v27
    s_nop 0
    s_cmp_lt_u32 s31, 32
    s_cbranch_scc1 K2_slow7
K2_go7:
    v_exp_f32 v75, v75
    ds_read_b128 v[40:43], v7 offset:36864
    v_mfma_f32_32x32x8_bf16 v[88:103], v[44:45], v[38:39], v[88:103]
    ds_read_b64 v[44:45], v8 offset:36864
    v_exp_f32 v76, v76
    s_add_u32 m0, s36, 12288
    v_exp_f32 v77, v77
    buffer_load_dwordx4 v24, s[16:19], s35 offen lds
    v_exp_f32 v78, v78
    s_mov_b32 exec_hi, 0
    buffer_load_dwordx4 v24, s[16:19], s35 offen offset:1024 lds
    s_mov_b32 exec_hi, -1
    v_exp_f32 v79, v79
    s_add_u32 s35, s35, 12288
    v_smfmac_f32_32x32x32_bf16 v[120:135], v[52:55], v[64:71], v11
    ds_read_b128 v[52:55], v9 offset:38400
    v_exp_f32 v80, v80
    v_exp_f32 v81, v81
    v_exp_f32 v82, v82
    v_exp_f32 v83, v83
    v_smfmac_f32_32x32x32_bf16 v[104:119], v[48:51], v[72:79], v11
    v_exp_f32 v84, v84
    v_exp_f32 v85, v85
    v_exp_f32 v86, v86
    v_exp_f32 v87, v87
    s_waitcnt lgkmcnt(1)
    v_mfma_f32_32x32x16_bf16 v[56:71], v[40:43], v[28:31], 0
    v_exp_f32 v88, v88
    v_exp_f32 v89, v89
    v_exp_f32 v90, v90
    v_exp_f32 v91, v91
    v_mfma_f32_32x32x8_bf16 v[56:71], v[44:45], v[36:37], v[56:71]
    v_exp_f32 v92, v92
    v_exp_f32 v93, v93
    v_exp_f32 v94, v94
    v_exp_f32 v95, v95
    s_waitcnt lgkmcnt(0)
    v_smfmac_f32_32x32x32_bf16 v[104:119], v[52:55], v[80:87], v11
    v_exp_f32 v96, v96
    v_exp_f32 v97, v97
    v_exp_f32 v98, v98
    v_exp_f32 v99, v99
    v_smfmac_f32_32x32x32_bf16 v[120:135], v[48:51], v[88:95], v11
    ds_read_b128 v[48:51], v9 offset:36864
    v_exp_f32 v100, v100
    v_exp_f32 v101, v101
    v_exp_f32 v102, v102
    v_exp_f32 v103, v103
    v_mfma_f32_32x32x16_bf16 v[72:87], v[40:43], v[32:35], 0
    ds_read_b128 v[40:43], v7 offset:43008
    v_exp_f32 v56, v56
    v_exp_f32 v57, v57
    v_exp_f32 v58, v58
    v_exp_f32 v59, v59
    v_mfma_f32_32x32x8_bf16 v[72:87], v[44:45], v[38:39], v[72:87]
    ds_read_b64 v[44:45], v8 offset:43008
    v_exp_f32 v60, v60
    v_exp_f32 v61, v61
    v_exp_f32 v62, v62
    v_exp_f32 v63, v63
    s_waitcnt lgkmcnt(2)
    v_smfmac_f32_32x32x32_bf16 v[120:135], v[52:55], v[96:103], v11
    ds_read_b128 v[52:55], v9 offset:44544
    v_exp_f32 v64, v64
    v_exp_f32 v65, v65
    v_exp_f32 v66, v66
    v_exp_f32 v67, v67
    v_smfmac_f32_32x32x32_bf16 v[104:119], v[48:51], v[56:63], v11
    v_exp_f32 v68, v68
    v_exp_f32 v69, v69
    v_exp_f32 v70, v70
    v_exp_f32 v71, v71
    s_waitcnt lgkmcnt(1)
    v_mfma_f32_32x32x16_bf16 v[88:103], v[40:43], v[28:31], 0
    v_exp_f32 v72, v72
    v_exp_f32 v73, v73
    v_exp_f32 v74, v74
    v_exp_f32 v75, v75
    v_mfma_f32_32x32x8_bf16 v[88:103], v[44:45], v[36:37], v[88:103]
    v_exp_f32 v76, v76
    v_exp_f32 v77, v77
    v_exp_f32 v78, v78
    v_exp_f32 v79, v79
    s_waitcnt lgkmcnt(0)
    v_smfmac_f32_32x32x32_bf16 v[104:119], v[52:55], v[64:71], v11
    v_exp_f32 v80, v80
    v_exp_f32 v81, v81
    v_exp_f32 v82, v82
    v_exp_f32 v83, v83
    v_smfmac_f32_32x32x32_bf16 v[120:135], v[48:51], v[72:79], v11
    ds_read_b128 v[48:51], v9 offset:43008
    v_exp_f32 v84, v84
    v_exp_f32 v85, v85
    v_exp_f32 v86, v86
    v_exp_f32 v87, v87
    v_mfma_f32_32x32x16_bf16 v[56:71], v[40:43], v[32:35], 0
    ds_read_b32 v27, v25 offset:4
    v_exp_f32 v88, v88
    v_exp_f32 v89, v89
    v_exp_f32 v90, v90
    s_waitcnt vmcnt(0) lgkmcnt(0)
    s_mov_b64 exec, 1
    ds_add_u32 v25, v26 offset:0
    s_mov_b64 exec, -1
    v_readfirstlane_b32 s31, v27
    s_nop 0
    s_cmp_lt_u32 s31, 32
    s_cbranch_scc1 K2_slow8
K2_go8:
    v_exp_f32 v91, v91
    ds_read_b128 v[40:43], v7 offset:0
    v_mfma_f32_32x32x8_bf16 v[56:71], v[44:45], v[38:39], v[56:71]
    ds_read_b64 v[44:45], v8 offset:0
    v_exp_f32 v92, v92
    s_add_u32 m0, s36, 24576
    v_exp_f32 v93, v93
    buffer_load_dwordx4 v24, s[16:19], s35 offen lds
    v_exp_f32 v94, v94
    s_mov_b32 exec_hi, 0
    buffer_load_dwordx4 v24, s[16:19], s35 offen offset:1024 lds
    s_mov_b32 exec_hi, -1
    v_exp_f32 v95, v95
    s_add_u32 s35, s35, 12288
    v_smfmac_f32_32x32x32_bf16 v[120:135], v[52:55], v[80:87], v11
    ds_read_b128 v[52:55], v9 offset:1536
    v_exp_f32 v96, v96
    v_exp_f32 v97, v97
    v_exp_f32 v98, v98
    v_exp_f32 v99, v99
    v_smfmac_f32_32x32x32_bf16 v[104:119], v[48:51], v[88:95], v11
    v_exp_f32 v100, v100
    v_exp_f32 v101, v101
    v_exp_f32 v102, v102
    v_exp_f32 v103, v103
    s_waitcnt lgkmcnt(1)
    v_mfma_f32_32x32x16_bf16 v[72:87], v[40:43], v[28:31], 0
    v_exp_f32 v56, v56
    v_exp_f32 v57, v57
    v_exp_f32 v58, v58
    v_exp_f32 v59, v59
    v_mfma_f32_32x32x8_bf16 v[72:87], v[44:45], v[36:37], v[72:87]
    v_exp_f32 v60, v60
    v_exp_f32 v61, v61
    v_exp_f32 v62, v62
    v_exp_f32 v63, v63
    s_waitcnt lgkmcnt(0)
    v_smfmac_f32_32x32x32_bf16 v[104:119], v[52:55], v[96:103], v11
    v_exp_f32 v64, v64
    v_exp_f32 v65, v65
    v_exp_f32 v66, v66
    v_exp_f32 v67, v67
    v_smfmac_f32_32x32x32_bf16 v[120:135], v[48:51], v[56:63], v11
    ds_read_b128 v[48:51], v9 offset:0
    v_exp_f32 v68, v68
    v_exp_f32 v69, v69
    v_exp_f32 v70, v70
    v_exp_f32 v71, v71
    v_mfma_f32_32x32x16_bf16 v[88:103], v[40:43], v[32:35], 0
    ds_read_b128 v[40:43], v7 offset:6144
    v_exp_f32 v72, v72
    v_exp_f32 v73, v73
    v_exp_f32 v74, v74
    v_exp_f32 v75, v75
    v_mfma_f32_32x32x8_bf16 v[88:103], v[44:45], v[38:39], v[88:103]
    ds_read_b64 v[44:45], v8 offset:6144
    v_exp_f32 v76, v76
    v_exp_f32 v77, v77
    v_exp_f32 v78, v78
    v_exp_f32 v79, v79
    s_waitcnt lgkmcnt(2)
    v_smfmac_f32_32x32x32_bf16 v[120:135], v[52:55], v[64:71], v11
    ds_read_b128 v[52:55], v9 offset:7680
    v_exp_f32 v80, v80
    v_exp_f32 v81, v81
    v_exp_f32 v82, v82
    v_exp_f32 v83, v83
    v_smfmac_f32_32x32x32_bf16 v[104:119], v[48:51], v[72:79], v11
    v_exp_f32 v84, v84
    v_exp_f32 v85, v85
    v_exp_f32 v86, v86
    v_exp_f32 v87, v87
    s_waitcnt lgkmcnt(1)
    v_mfma_f32_32x32x16_bf16 v[56:71], v[40:43], v[28:31], 0
    v_exp_f32 v88, v88
    v_exp_f32 v89, v89
    v_exp_f32 v90, v90
    v_exp_f32 v91, v91
    v_mfma_f32_32x32x8_bf16 v[56:71], v[44:45], v[36:37], v[56:71]
    v_exp_f32 v92, v92
    v_exp_f32 v93, v93
    v_exp_f32 v94, v94
    v_exp_f32 v95, v95
    s_waitcnt lgkmcnt(0)
    v_smfmac_f32_32x32x32_bf16 v[104:119], v[52:55], v[80:87], v11
    v_exp_f32 v96, v96
    v_exp_f32 v97, v97
    v_exp_f32 v98, v98
    v_exp_f32 v99, v99
    v_smfmac_f32_32x32x32_bf16 v[120:135], v[48:51], v[88:95], v11
    ds_read_b128 v[48:51], v9 offset:6144
    v_exp_f32 v100, v100
    v_exp_f32 v101, v101
    v_exp_f32 v102, v102
    v_exp_f32 v103, v103
    v_mfma_f32_32x32x16_bf16 v[72:87], v[40:43], v[32:35], 0
    ds_read_b32 v27, v25 offset:0
    v_exp_f32 v56, v56
    v_exp_f32 v57, v57
    v_exp_f32 v58, v58
    s_waitcnt vmcnt(0) lgkmcnt(0)
    s_mov_b64 exec, 1
    ds_add_u32 v25, v26 offset:4
    s_mov_b64 exec, -1
    v_readfirstlane_b32 s31, v27
    s_nop 0
    s_cmp_lt_u32 s31, 40
    s_cbranch_scc1 K2_slow9
K2_go9:
    v_exp_f32 v59, v59
    ds_read_b128 v[40:43], v7 offset:12288
    v_mfma_f32_32x32x8_bf16 v[72:87], v[44:45], v[38:39], v[72:87]
    ds_read_b64 v[44:45], v8 offset:12288
    v_exp_f32 v60, v60
    s_add_u32 m0, s36, 36864
    v_exp_f32 v61, v61
    buffer_load_dwordx4 v24, s[16:19], s35 offen lds
    v_exp_f32 v62, v62
    s_mov_b32 exec_hi, 0
    buffer_load_dwordx4 v24, s[16:19], s35 offen offset:1024 lds
    s_mov_b32 exec_hi, -1
    v_exp_f32 v63, v63
    s_add_u32 s35, s35, 12288
    v_smfmac_f32_32x32x32_bf16 v[120:135], v[52:55], v[96:103], v11
    ds_read_b128 v[52:55], v9 offset:13824
    v_exp_f32 v64, v64
    v_exp_f32 v65, v65
    v_exp_f32 v66, v66
    v_exp_f32 v67, v67
    v_smfmac_f32_32x32x32_bf16 v[104:119], v[48:51], v[56:63], v11
    v_exp_f32 v68, v68
    v_exp_f32 v69, v69
    v_exp_f32 v70, v70
    v_exp_f32 v71, v71
    s_waitcnt lgkmcnt(1)
    v_mfma_f32_32x32x16_bf16 v[88:103], v[40:43], v[28:31], 0
    v_exp_f32 v72, v72
    v_exp_f32 v73, v73
    v_exp_f32 v74, v74
    v_exp_f32 v75, v75
    v_mfma_f32_32x32x8_bf16 v[88:103], v[44:45], v[36:37], v[88:103]
    v_exp_f32 v76, v76
    v_exp_f32 v77, v77
    v_exp_f32 v78, v78
    v_exp_f32 v79, v79
    s_waitcnt lgkmcnt(0)
    v_smfmac_f32_32x32x32_bf16 v[104:119], v[52:55], v[64:71], v11
    v_exp_f32 v80, v80
    v_exp_f32 v81, v81
    v_exp_f32 v82, v82
    v_exp_f32 v83, v83
    v_smfmac_f32_32x32x32_bf16 v[120:135], v[48:51], v[72:79], v11
    ds_read_b128 v[48:51], v9 offset:12288
    v_exp_f32 v84, v84
    v_exp_f32 v85, v85
    v_exp_f32 v86, v86
    v_exp_f32 v87, v87
    v_mfma_f32_32x32x16_bf16 v[56:71], v[40:43], v[32:35], 0
    ds_read_b128 v[40:43], v7 offset:18432
    v_exp_f32 v88, v88
    v_exp_f32 v89, v89
    v_exp_f32 v90, v90
    v_exp_f32 v91, v91
    v_mfma_f32_32x32x8_bf16 v[56:71], v[44:45], v[38:39], v[56:71]
    ds_read_b64 v[44:45], v8 offset:18432
    v_exp_f32 v92, v92
    v_exp_f32 v93, v93
    v_exp_f32 v94, v94
    v_exp_f32 v95, v95
    s_waitcnt lgkmcnt(2)
    v_smfmac_f32_32x32x32_bf16 v[120:135], v[52:55], v[80:87], v11
    ds_read_b128 v[52:55], v9 offset:19968
    v_exp_f32 v96, v96
    v_exp_f32 v97, v97
    v_exp_f32 v98, v98
    v_exp_f32 v99, v99
    v_smfmac_f32_32x32x32_bf16 v[104:119], v[48:51], v[88:95], v11
    v_exp_f32 v100, v100
    v_exp_f32 v101, v101
    v_exp_f32 v102, v102
    v_exp_f32 v103, v103
    s_waitcnt lgkmcnt(1)
    v_mfma_f32_32x32x16_bf16 v[72:87], v[40:43], v[28:31], 0
    v_exp_f32 v56, v56
    v_exp_f32 v57, v57
    v_exp_f32 v58, v58
    v_exp_f32 v59, v59
    v_mfma_f32_32x32x8_bf16 v[72:87], v[44:45], v[36:37], v[72:87]
    v_exp_f32 v60, v60
    v_exp_f32 v61, v61
    v_exp_f32 v62, v62
    v_exp_f32 v63, v63
    s_waitcnt lgkmcnt(0)
    v_smfmac_f32_32x32x32_bf16 v[104:119], v[52:55], v[96:103], v11
    v_exp_f32 v64, v64
    v_exp_f32 v65, v65
    v_exp_f32 v66, v66
    v_exp_f32 v67, v67
    v_smfmac_f32_32x32x32_bf16 v[120:135], v[48:51], v[56:63], v11
    ds_read_b128 v[48:51], v9 offset:18432
    v_exp_f32 v68, v68
    v_exp_f32 v69, v69
    v_exp_f32 v70, v70
    v_exp_f32 v71, v71
    v_mfma_f32_32x32x16_bf16 v[88:103], v[40:43], v[32:35], 0
    ds_read_b32 v27, v25 offset:4
    v_exp_f32 v72, v72
    v_exp_f32 v73, v73
    v_exp_f32 v74, v74
    s_waitcnt vmcnt(0) lgkmcnt(0)
    s_mov_b64 exec, 1
    ds_add_u32 v25, v26 offset:0
    s_mov_b64 exec, -1
    v_readfirstlane_b32 s31, v27
    s_nop 0
    s_cmp_lt_u32 s31, 40
    s_cbranch_scc1 K2_slow10
K2_go10:
    v_exp_f32 v75, v75
    ds_read_b128 v[40:43], v7 offset:24576
    v_mfma_f32_32x32x8_bf16 v[88:103], v[44:45], v[38:39], v[88:103]
    ds_read_b64 v[44:45], v8 offset:24576
    v_exp_f32 v76, v76
    s_add_u32 m0, s36, 0
    v_exp_f32 v77, v77
    buffer_load_dwordx4 v24, s[16:19], s35 offen lds
    v_exp_f32 v78, v78
    s_mov_b32 exec_hi, 0
    buffer_load_dwordx4 v24, s[16:19], s35 offen offset:1024 lds
    s_mov_b32 exec_hi, -1
    v_exp_f32 v79, v79
    s_add_u32 s35, s35, 12288
    v_smfmac_f32_32x32x32_bf16 v[120:135], v[52:55], v[64:71], v11
    ds_read_b128 v[52:55], v9 offset:26112
    v_exp_f32 v80, v80
    v_exp_f32 v81, v81
    v_exp_f32 v82, v82
    v_exp_f32 v83, v83
    v_smfmac_f32_32x32x32_bf16 v[104:119], v[48:51], v[72:79], v11
    v_exp_f32 v84, v84
    v_exp_f32 v85, v85
    v_exp_f32 v86, v86
    v_exp_f32 v87, v87
    s_waitcnt lgkmcnt(1)
    v_mfma_f32_32x32x16_bf16 v[56:71], v[40:43], v[28:31], 0
    v_exp_f32 v88, v88
    v_exp_f32 v89, v89
    v_exp_f32 v90, v90
    v_exp_f32 v91, v91
    v_mfma_f32_32x32x8_bf16 v[56:71], v[44:45], v[36:37], v[56:71]
    v_exp_f32 v92, v92
    v_exp_f32 v93, v93
    v_exp_f32 v94, v94
    v_exp_f32 v95, v95
    s_waitcnt lgkmcnt(0)
    v_smfmac_f32_32x32x32_bf16 v[104:119], v[52:55], v[80:87], v11
    v_exp_f32 v96, v96
    v_exp_f32 v97, v97
    v_exp_f32 v98, v98
    v_exp_f32 v99, v99
    v_smfmac_f32_32x32x32_bf16 v[120:135], v[48:51], v[88:95], v11
    ds_read_b128 v[48:51], v9 offset:24576
    v_exp_f32 v100, v100
    v_exp_f32 v101, v101
    v_exp_f32 v102, v102
    v_exp_f32 v103, v103
    v_mfma_f32_32x32x16_bf16 v[72:87], v[40:43], v[32:35], 0
    ds_read_b128 v[40:43], v7 offset:30720
    v_exp_f32 v56, v56
    v_exp_f32 v57, v57
    v_exp_f32 v58, v58
    v_exp_f32 v59, v59
    v_mfma_f32_32x32x8_bf16 v[72:87], v[44:45], v[38:39], v[72:87]
    ds_read_b64 v[44:45], v8 offset:30720
    v_exp_f32 v60, v60
    v_exp_f32 v61, v61
    v_exp_f32 v62, v62
    v_exp_f32 v63, v63
    s_waitcnt lgkmcnt(2)
    v_smfmac_f32_32x32x32_bf16 v[120:135], v[52:55], v[96:103], v11
    ds_read_b128 v[52:55], v9 offset:32256
    v_exp_f32 v64, v64
    v_exp_f32 v65, v65
    v_exp_f32 v66, v66
    v_exp_f32 v67, v67
    v_smfmac_f32_32x32x32_bf16 v[104:119], v[48:51], v[56:63], v11
    v_exp_f32 v68, v68
    v_exp_f32 v69, v69
    v_exp_f32 v70, v70
    v_exp_f32 v71, v71
    s_waitcnt lgkmcnt(1)
    v_mfma_f32_32x32x16_bf16 v[88:103], v[40:43], v[28:31], 0
    v_exp_f32 v72, v72
    v_exp_f32 v73, v73
    v_exp_f32 v74, v74
    v_exp_f32 v75, v75
    v_mfma_f32_32x32x8_bf16 v[88:103], v[44:45], v[36:37], v[88:103]
    v_exp_f32 v76, v76
    v_exp_f32 v77, v77
    v_exp_f32 v78, v78
    v_exp_f32 v79, v79
    s_waitcnt lgkmcnt(0)
    v_smfmac_f32_32x32x32_bf16 v[104:119], v[52:55], v[64:71], v11
    v_exp_f32 v80, v80
    v_exp_f32 v81, v81
    v_exp_f32 v82, v82
    v_exp_f32 v83, v83
    v_smfmac_f32_32x32x32_bf16 v[120:135], v[48:51], v[72:79], v11
    ds_read_b128 v[48:51], v9 offset:30720
    v_exp_f32 v84, v84
    v_exp_f32 v85, v85
    v_exp_f32 v86, v86
    v_exp_f32 v87, v87
    v_mfma_f32_32x32x16_bf16 v[56:71], v[40:43], v[32:35], 0
    ds_read_b32 v27, v25 offset:0
    v_exp_f32 v88, v88
    v_exp_f32 v89, v89
    v_exp_f32 v90, v90
    s_waitcnt vmcnt(0) lgkmcnt(0)
    s_mov_b64 exec, 1
    ds_add_u32 v25, v26 offset:4
    s_mov_b64 exec, -1
    v_readfirstlane_b32 s31, v27
    s_nop 0
    s_cmp_lt_u32 s31, 48
    s_cbranch_scc1 K2_slow11
K2_go11:
    v_exp_f32 v91, v91
    ds_read_b128 v[40:43], v7 offset:36864
    v_mfma_f32_32x32x8_bf16 v[56:71], v[44:45], v[38:39], v[56:71]
    ds_read_b64 v[44:45], v8 offset:36864
    v_exp_f32 v92, v92
    s_add_u32 m0, s36, 12288
    v_exp_f32 v93, v93
    buffer_load_dwordx4 v24, s[16:19], s35 offen lds
    v_exp_f32 v94, v94
    s_mov_b32 exec_hi, 0
    buffer_load_dwordx4 v24, s[16:19], s35 offen offset:1024 lds
    s_mov_b32 exec_hi, -1
    v_exp_f32 v95, v95
    s_add_u32 s35, s35, 12288
    v_smfmac_f32_32x32x32_bf16 v[120:135], v[52:55], v[80:87], v11
    ds_read_b128 v[52:55], v9 offset:38400
    v_exp_f32 v96, v96
    v_exp_f32 v97, v97
    v_exp_f32 v98, v98
    v_exp_f32 v99, v99
    v_smfmac_f32_32x32x32_bf16 v[104:119], v[48:51], v[88:95], v11
    v_exp_f32 v100, v100
    v_exp_f32 v101, v101
    v_exp_f32 v102, v102
    v_exp_f32 v103, v103
    s_waitcnt lgkmcnt(1)
    v_mfma_f32_32x32x16_bf16 v[72:87], v[40:43], v[28:31], 0
    v_exp_f32 v56, v56
    v_exp_f32 v57, v57
    v_exp_f32 v58, v58
    v_exp_f32 v59, v59
    v_mfma_f32_32x32x8_bf16 v[72:87], v[44:45], v[36:37], v[72:87]
    v_exp_f32 v60, v60
    v_exp_f32 v61, v61
    v_exp_f32 v62, v62
    v_exp_f32 v63, v63
    s_waitcnt lgkmcnt(0)
    v_smfmac_f32_32x32x32_bf16 v[104:119], v[52:55], v[96:103], v11
    v_exp_f32 v64, v64
    v_exp_f32 v65, v65
    v_exp_f32 v66, v66
    v_exp_f32 v67, v67
    v_smfmac_f32_32x32x32_bf16 v[120:135], v[48:51], v[56:63], v11
    ds_read_b128 v[48:51], v9 offset:36864
    v_exp_f32 v68, v68
    v_exp_f32 v69, v69
    v_exp_f32 v70, v70
    v_exp_f32 v71, v71
    v_mfma_f32_32x32x16_bf16 v[88:103], v[40:43], v[32:35], 0
    ds_read_b128 v[40:43], v7 offset:43008
    v_exp_f32 v72, v72
    v_exp_f32 v73, v73
    v_exp_f32 v74, v74
    v_exp_f32 v75, v75
    v_mfma_f32_32x32x8_bf16 v[88:103], v[44:45], v[38:39], v[88:103]
    ds_read_b64 v[44:45], v8 offset:43008
    v_exp_f32 v76, v76
    v_exp_f32 v77, v77
    v_exp_f32 v78, v78
    v_exp_f32 v79, v79
    s_waitcnt lgkmcnt(2)
    v_smfmac_f32_32x32x32_bf16 v[120:135], v[52:55], v[64:71], v11
    ds_read_b128 v[52:55], v9 offset:44544
    v_exp_f32 v80, v80
    v_exp_f32 v81, v81
    v_exp_f32 v82, v82
    v_exp_f32 v83, v83
    v_smfmac_f32_32x32x32_bf16 v[104:119], v[48:51], v[72:79], v11
    v_exp_f32 v84, v84
    v_exp_f32 v85, v85
    v_exp_f32 v86, v86
    v_exp_f32 v87, v87
    s_waitcnt lgkmcnt(1)
    v_mfma_f32_32x32x16_bf16 v[56:71], v[40:43], v[28:31], 0
    v_exp_f32 v88, v88
    v_exp_f32 v89, v89
    v_exp_f32 v90, v90
    v_exp_f32 v91, v91
    v_mfma_f32_32x32x8_bf16 v[56:71], v[44:45], v[36:37], v[56:71]
    v_exp_f32 v92, v92
    v_exp_f32 v93, v93
    v_exp_f32 v94, v94
    v_exp_f32 v95, v95
    s_waitcnt lgkmcnt(0)
    v_smfmac_f32_32x32x32_bf16 v[104:119], v[52:55], v[80:87], v11
    v_exp_f32 v96, v96
    v_exp_f32 v97, v97
    v_exp_f32 v98, v98
    v_exp_f32 v99, v99
    v_smfmac_f32_32x32x32_bf16 v[120:135], v[48:51], v[88:95], v11
    ds_read_b128 v[48:51], v9 offset:43008
    v_exp_f32 v100, v100
    v_exp_f32 v101, v101
    v_exp_f32 v102, v102
    v_exp_f32 v103, v103
    v_mfma_f32_32x32x16_bf16 v[72:87], v[40:43], v[32:35], 0
    ds_read_b32 v27, v25 offset:4
    v_exp_f32 v56, v56
    v_exp_f32 v57, v57
    v_exp_f32 v58, v58
    s_waitcnt vmcnt(0) lgkmcnt(0)
    s_mov_b64 exec, 1
    ds_add_u32 v25, v26 offset:0
    s_mov_b64 exec, -1
    v_readfirstlane_b32 s31, v27
    s_nop 0
    s_cmp_lt_u32 s31, 48
    s_cbranch_scc1 K2_slow12
K2_go12:
    v_exp_f32 v59, v59
    ds_read_b128 v[40:43], v7 offset:0
    v_mfma_f32_32x32x8_bf16 v[72:87], v[44:45], v[38:39], v[72:87]
    ds_read_b64 v[44:45], v8 offset:0
    v_exp_f32 v60, v60
    s_add_u32 m0, s36, 24576
    v_exp_f32 v61, v61
    buffer_load_dwordx4 v24, s[16:19], s35 offen lds
    v_exp_f32 v62, v62
    s_mov_b32 exec_hi, 0
    buffer_load_dwordx4 v24, s[16:19], s35 offen offset:1024 lds
    s_mov_b32 exec_hi, -1
    v_exp_f32 v63, v63
    s_add_u32 s35, s35, 12288
    v_smfmac_f32_32x32x32_bf16 v[120:135], v[52:55], v[96:103], v11
    ds_read_b128 v[52:55], v9 offset:1536
    v_exp_f32 v64, v64
    v_exp_f32 v65, v65
    v_exp_f32 v66, v66
    v_exp_f32 v67, v67
    v_smfmac_f32_32x32x32_bf16 v[104:119], v[48:51], v[56:63], v11
    v_exp_f32 v68, v68
    v_exp_f32 v69, v69
    v_exp_f32 v70, v70
    v_exp_f32 v71, v71
    s_waitcnt lgkmcnt(1)
    v_mfma_f32_32x32x16_bf16 v[88:103], v[40:43], v[28:31], 0
    v_exp_f32 v72, v72
    v_exp_f32 v73, v73
    v_exp_f32 v74, v74
    v_exp_f32 v75, v75
    v_mfma_f32_32x32x8_bf16 v[88:103], v[44:45], v[36:37], v[88:103]
    v_exp_f32 v76, v76
    v_exp_f32 v77, v77
    v_exp_f32 v78, v78
    v_exp_f32 v79, v79
    s_waitcnt lgkmcnt(0)
    v_smfmac_f32_32x32x32_bf16 v[104:119], v[52:55], v[64:71], v11
    v_exp_f32 v80, v80
    v_exp_f32 v81, v81
    v_exp_f32 v82, v82
    v_exp_f32 v83, v83
    v_smfmac_f32_32x32x32_bf16 v[120:135], v[48:51], v[72:79], v11
    ds_read_b128 v[48:51], v9 offset:0
    v_exp_f32 v84, v84
    v_exp_f32 v85, v85
    v_exp_f32 v86, v86
    v_exp_f32 v87, v87
    v_mfma_f32_32x32x16_bf16 v[56:71], v[40:43], v[32:35], 0
    ds_read_b128 v[40:43], v7 offset:6144
    v_exp_f32 v88, v88
    v_exp_f32 v89, v89
    v_exp_f32 v90, v90
    v_exp_f32 v91, v91
    v_mfma_f32_32x32x8_bf16 v[56:71], v[44:45], v[38:39], v[56:71]
    ds_read_b64 v[44:45], v8 offset:6144
    v_exp_f32 v92, v92
    v_exp_f32 v93, v93
    v_exp_f32 v94, v94
    v_exp_f32 v95, v95
    s_waitcnt lgkmcnt(2)
    v_smfmac_f32_32x32x32_bf16 v[120:135], v[52:55], v[80:87], v11
    ds_read_b128 v[52:55], v9 offset:7680
    v_exp_f32 v96, v96
    v_exp_f32 v97, v97
    v_exp_f32 v98, v98
    v_exp_f32 v99, v99
    v_smfmac_f32_32x32x32_bf16 v[104:119], v[48:51], v[88:95], v11
    v_exp_f32 v100, v100
    v_exp_f32 v101, v101
    v_exp_f32 v102, v102
    v_exp_f32 v103, v103
    s_waitcnt lgkmcnt(1)
    v_mfma_f32_32x32x16_bf16 v[72:87], v[40:43], v[28:31], 0
    v_exp_f32 v56, v56
    v_exp_f32 v57, v57
    v_exp_f32 v58, v58
    v_exp_f32 v59, v59
    v_mfma_f32_32x32x8_bf16 v[72:87], v[44:45], v[36:37], v[72:87]
    v_exp_f32 v60, v60
    v_exp_f32 v61, v61
    v_exp_f32 v62, v62
    v_exp_f32 v63, v63
    s_waitcnt lgkmcnt(0)
    v_smfmac_f32_32x32x32_bf16 v[104:119], v[52:55], v[96:103], v11
    v_exp_f32 v64, v64
    v_exp_f32 v65, v65
    v_exp_f32 v66, v66
    v_exp_f32 v67, v67
    v_smfmac_f32_32x32x32_bf16 v[120:135], v[48:51], v[56:63], v11
    ds_read_b128 v[48:51], v9 offset:6144
    v_exp_f32 v68, v68
    v_exp_f32 v69, v69
    v_exp_f32 v70, v70
    v_exp_f32 v71, v71
    v_mfma_f32_32x32x16_bf16 v[88:103], v[40:43], v[32:35], 0
    ds_read_b32 v27, v25 offset:0
    v_exp_f32 v72, v72
    v_exp_f32 v73, v73
    v_exp_f32 v74, v74
    s_waitcnt vmcnt(0) lgkmcnt(0)
    s_mov_b64 exec, 1
    ds_add_u32 v25, v26 offset:4
    s_mov_b64 exec, -1
    v_readfirstlane_b32 s31, v27
    s_nop 0
    s_cmp_lt_u32 s31, 56
    s_cbranch_scc1 K2_slow13
K2_go13:
    v_exp_f32 v75, v75
    ds_read_b128 v[40:43], v7 offset:12288
    v_mfma_f32_32x32x8_bf16 v[88:103], v[44:45], v[38:39], v[88:103]
    ds_read_b64 v[44:45], v8 offset:12288
    v_exp_f32 v76, v76
    s_add_u32 m0, s36, 36864
    v_exp_f32 v77, v77
    buffer_load_dwordx4 v24, s[16:19], s35 offen lds
    v_exp_f32 v78, v78
    s_mov_b32 exec_hi, 0
    buffer_load_dwordx4 v24, s[16:19], s35 offen offset:1024 lds
    s_mov_b32 exec_hi, -1
    v_exp_f32 v79, v79
    s_add_u32 s35, s35, 12288
    v_smfmac_f32_32x32x32_bf16 v[120:135], v[52:55], v[64:71], v11
    ds_read_b128 v[52:55], v9 offset:13824
    v_exp_f32 v80, v80
    v_exp_f32 v81, v81
    v_exp_f32 v82, v82
    v_exp_f32 v83, v83
    v_smfmac_f32_32x32x32_bf16 v[104:119], v[48:51], v[72:79], v11
    v_exp_f32 v84, v84
    v_exp_f32 v85, v85
    v_exp_f32 v86, v86
    v_exp_f32 v87, v87
    s_waitcnt lgkmcnt(1)
    v_mfma_f32_32x32x16_bf16 v[56:71], v[40:43], v[28:31], 0
    v_exp_f32 v88, v88
    v_exp_f32 v89, v89
    v_exp_f32 v90, v90
    v_exp_f32 v91, v91
    v_mfma_f32_32x32x8_bf16 v[56:71], v[44:45], v[36:37], v[56:71]
    v_exp_f32 v92, v92
    v_exp_f32 v93, v93
    v_exp_f32 v94, v94
    v_exp_f32 v95, v95
    s_waitcnt lgkmcnt(0)
    v_smfmac_f32_32x32x32_bf16 v[104:119], v[52:55], v[80:87], v11
    v_exp_f32 v96, v96
    v_exp_f32 v97, v97
    v_exp_f32 v98, v98
    v_exp_f32 v99, v99
    v_smfmac_f32_32x32x32_bf16 v[120:135], v[48:51], v[88:95], v11
    ds_read_b128 v[48:51], v9 offset:12288
    v_exp_f32 v100, v100
    v_exp_f32 v101, v101
    v_exp_f32 v102, v102
    v_exp_f32 v103, v103
    v_mfma_f32_32x32x16_bf16 v[72:87], v[40:43], v[32:35], 0
    ds_read_b128 v[40:43], v7 offset:18432
    v_exp_f32 v56, v56
    v_exp_f32 v57, v57
    v_exp_f32 v58, v58
    v_exp_f32 v59, v59
    v_mfma_f32_32x32x8_bf16 v[72:87], v[44:45], v[38:39], v[72:87]
    ds_read_b64 v[44:45], v8 offset:18432
    v_exp_f32 v60, v60
    v_exp_f32 v61, v61
    v_exp_f32 v62, v62
    v_exp_f32 v63, v63
    s_waitcnt lgkmcnt(2)
    v_smfmac_f32_32x32x32_bf16 v[120:135], v[52:55], v[96:103], v11
    ds_read_b128 v[52:55], v9 offset:19968
    v_exp_f32 v64, v64
    v_exp_f32 v65, v65
    v_exp_f32 v66, v66
    v_exp_f32 v67, v67
    v_smfmac_f32_32x32x32_bf16 v[104:119], v[48:51], v[56:63], v11
    v_exp_f32 v68, v68
    v_exp_f32 v69, v69
    v_exp_f32 v70, v70
    v_exp_f32 v71, v71
    s_waitcnt lgkmcnt(1)
    v_mfma_f32_32x32x16_bf16 v[88:103], v[40:43], v[28:31], 0
    v_exp_f32 v72, v72
    v_exp_f32 v73, v73
    v_exp_f32 v74, v74
    v_exp_f32 v75, v75
    v_mfma_f32_32x32x8_bf16 v[88:103], v[44:45], v[36:37], v[88:103]
    v_exp_f32 v76, v76
    v_exp_f32 v77, v77
    v_exp_f32 v78, v78
    v_exp_f32 v79, v79
    s_waitcnt lgkmcnt(0)
    v_smfmac_f32_32x32x32_bf16 v[104:119], v[52:55], v[64:71], v11
    v_exp_f32 v80, v80
    v_exp_f32 v81, v81
    v_exp_f32 v82, v82
    v_exp_f32 v83, v83
    v_smfmac_f32_32x32x32_bf16 v[120:135], v[48:51], v[72:79], v11
    ds_read_b128 v[48:51], v9 offset:18432
    v_exp_f32 v84, v84
    v_exp_f32 v85, v85
    v_exp_f32 v86, v86
    v_exp_f32 v87, v87
    v_mfma_f32_32x32x16_bf16 v[56:71], v[40:43], v[32:35], 0
    ds_read_b32 v27, v25 offset:4
    v_exp_f32 v88, v88
    v_exp_f32 v89, v89
    v_exp_f32 v90, v90
    s_waitcnt vmcnt(0) lgkmcnt(0)
    s_mov_b64 exec, 1
    ds_add_u32 v25, v26 offset:0
    s_mov_b64 exec, -1
    v_readfirstlane_b32 s31, v27
    s_nop 0
    s_cmp_lt_u32 s31, 56
    s_cbranch_scc1 K2_slow14
K2_go14:
    v_exp_f32 v91, v91
    ds_read_b128 v[40:43], v7 offset:24576
    v_mfma_f32_32x32x8_bf16 v[56:71], v[44:45], v[38:39], v[56:71]
    ds_read_b64 v[44:45], v8 offset:24576
    v_exp_f32 v92, v92
    v_exp_f32 v93, v93
    v_exp_f32 v94, v94
    v_exp_f32 v95, v95
    v_smfmac_f32_32x32x32_bf16 v[120:135], v[52:55], v[80:87], v11
    ds_read_b128 v[52:55], v9 offset:26112
    v_exp_f32 v96, v96
    v_exp_f32 v97, v97
    v_exp_f32 v98, v98
    v_exp_f32 v99, v99
    v_smfmac_f32_32x32x32_bf16 v[104:119], v[48:51], v[88:95], v11
    v_exp_f32 v100, v100
    v_exp_f32 v101, v101
    v_exp_f32 v102, v102
    v_exp_f32 v103, v103
    s_waitcnt lgkmcnt(1)
    v_mfma_f32_32x32x16_bf16 v[72:87], v[40:43], v[28:31], 0
    v_exp_f32 v56, v56
    v_exp_f32 v57, v57
    v_exp_f32 v58, v58
    v_exp_f32 v59, v59
    v_mfma_f32_32x32x8_bf16 v[72:87], v[44:45], v[36:37], v[72:87]
    v_exp_f32 v60, v60
    v_exp_f32 v61, v61
    v_exp_f32 v62, v62
    v_exp_f32 v63, v63
    s_waitcnt lgkmcnt(0)
    v_smfmac_f32_32x32x32_bf16 v[104:119], v[52:55], v[96:103], v11
    v_exp_f32 v64, v64
    v_exp_f32 v65, v65
    v_exp_f32 v66, v66
    v_exp_f32 v67, v67
    v_smfmac_f32_32x32x32_bf16 v[120:135], v[48:51], v[56:63], v11
    ds_read_b128 v[48:51], v9 offset:24576
    v_exp_f32 v68, v68
    v_exp_f32 v69, v69
    v_exp_f32 v70, v70
    v_exp_f32 v71, v71
    s_cmp_lt_u32 s30, 4
    s_cbranch_scc1 K2_catch
    s_setprio 1
K2_catch:
    v_mfma_f32_32x32x16_bf16 v[88:103], v[40:43], v[32:35], 0
    ds_read_b128 v[40:43], v7 offset:30720
    v_exp_f32 v72, v72
    v_exp_f32 v73, v73
    v_exp_f32 v74, v74
    v_exp_f32 v75, v75
    v_mfma_f32_32x32x8_bf16 v[88:103], v[44:45], v[38:39], v[88:103]
    ds_read_b64 v[44:45], v8 offset:30720
    v_exp_f32 v76, v76
    v_exp_f32 v77, v77
    v_exp_f32 v78, v78
    v_exp_f32 v79, v79
    s_waitcnt lgkmcnt(2)
    v_smfmac_f32_32x32x32_bf16 v[120:135], v[52:55], v[64:71], v11
    ds_read_b128 v[52:55], v9 offset:32256
    v_exp_f32 v80, v80
    v_exp_f32 v81, v81
    v_exp_f32 v82, v82
    v_exp_f32 v83, v83
    v_smfmac_f32_32x32x32_bf16 v[104:119], v[48:51], v[72:79], v11
    v_exp_f32 v84, v84
    v_exp_f32 v85, v85
    v_exp_f32 v86, v86
    v_exp_f32 v87, v87
    s_waitcnt lgkmcnt(1)
    v_mfma_f32_32x32x16_bf16 v[56:71], v[40:43], v[28:31], 0
    v_exp_f32 v88, v88
    v_exp_f32 v89, v89
    v_exp_f32 v90, v90
    v_exp_f32 v91, v91
    v_mfma_f32_32x32x8_bf16 v[56:71], v[44:45], v[36:37], v[56:71]
    v_exp_f32 v92, v92
    v_exp_f32 v93, v93
    v_exp_f32 v94, v94
    v_exp_f32 v95, v95
    s_waitcnt lgkmcnt(0)
    v_smfmac_f32_32x32x32_bf16 v[104:119], v[52:55], v[80:87], v11
    v_exp_f32 v96, v96
    v_exp_f32 v97, v97
    v_exp_f32 v98, v98
    v_exp_f32 v99, v99
    v_smfmac_f32_32x32x32_bf16 v[120:135], v[48:51], v[88:95], v11
    ds_read_b128 v[48:51], v9 offset:30720
    v_exp_f32 v100, v100
    v_exp_f32 v101, v101
    v_exp_f32 v102, v102
    v_exp_f32 v103, v103
    v_mfma_f32_32x32x16_bf16 v[72:87], v[40:43], v[32:35], 0
    ds_read_b32 v27, v25 offset:0
    v_exp_f32 v56, v56
    v_exp_f32 v57, v57
    v_exp_f32 v58, v58
    s_waitcnt vmcnt(0) lgkmcnt(0)
    v_readfirstlane_b32 s31, v27
    s_nop 0
    s_cmp_lt_u32 s31, 64
    s_cbranch_scc1 K2_slow15
K2_go15:
    v_exp_f32 v59, v59
    ds_read_b128 v[40:43], v7 offset:36864
    v_mfma_f32_32x32x8_bf16 v[72:87], v[44:45], v[38:39], v[72:87]
    ds_read_b64 v[44:45], v8 offset:36864
    v_exp_f32 v60, v60
    v_exp_f32 v61, v61
    v_exp_f32 v62, v62
    v_exp_f32 v63, v63
    v_smfmac_f32_32x32x32_bf16 v[120:135], v[52:55], v[96:103], v11
    ds_read_b128 v[52:55], v9 offset:38400
    v_exp_f32 v64, v64
    v_exp_f32 v65, v65
    v_exp_f32 v66, v66
    v_exp_f32 v67, v67
    v_smfmac_f32_32x32x32_bf16 v[104:119], v[48:51], v[56:63], v11
    v_exp_f32 v68, v68
    v_exp_f32 v69, v69
    v_exp_f32 v70, v70
    v_exp_f32 v71, v71
    s_waitcnt lgkmcnt(1)
    v_mfma_f32_32x32x16_bf16 v[88:103], v[40:43], v[28:31], 0
    v_exp_f32 v72, v72
    v_exp_f32 v73, v73
    v_exp_f32 v74, v74
    v_exp_f32 v75, v75
    v_mfma_f32_32x32x8_bf16 v[88:103], v[44:45], v[36:37], v[88:103]
    v_exp_f32 v76, v76
    v_exp_f32 v77, v77
    v_exp_f32 v78, v78
    v_exp_f32 v79, v79
    s_waitcnt lgkmcnt(0)
    v_smfmac_f32_32x32x32_bf16 v[104:119], v[52:55], v[64:71], v11
    v_exp_f32 v80, v80
    v_exp_f32 v81, v81
    v_exp_f32 v82, v82
    v_exp_f32 v83, v83
    v_smfmac_f32_32x32x32_bf16 v[120:135], v[48:51], v[72:79], v11
    ds_read_b128 v[48:51], v9 offset:36864
    v_exp_f32 v84, v84
    v_exp_f32 v85, v85
    v_exp_f32 v86, v86
    v_exp_f32 v87, v87
    v_mfma_f32_32x32x16_bf16 v[56:71], v[40:43], v[32:35], 0
    v_exp_f32 v88, v88
    v_exp_f32 v89, v89
    v_exp_f32 v90, v90
    v_exp_f32 v91, v91
    v_mfma_f32_32x32x8_bf16 v[56:71], v[44:45], v[38:39], v[56:71]
    v_exp_f32 v92, v92
    v_exp_f32 v93, v93
    v_exp_f32 v94, v94
    v_exp_f32 v95, v95
    s_waitcnt lgkmcnt(0)
    v_smfmac_f32_32x32x32_bf16 v[120:135], v[52:55], v[80:87], v11
    ds_read_b128 v[52:55], v9 offset:44544
    v_exp_f32 v96, v96
    v_exp_f32 v97, v97
    v_exp_f32 v98, v98
    v_exp_f32 v99, v99
    v_smfmac_f32_32x32x32_bf16 v[104:119], v[48:51], v[88:95], v11
    v_exp_f32 v100, v100
    v_exp_f32 v101, v101
    v_exp_f32 v102, v102
    v_exp_f32 v103, v103
    v_exp_f32 v56, v56
    v_exp_f32 v57, v57
    v_exp_f32 v58, v58
    v_exp_f32 v59, v59
    v_exp_f32 v60, v60
    v_exp_f32 v61, v61
    v_exp_f32 v62, v62
    v_exp_f32 v63, v63
    s_waitcnt lgkmcnt(0)
    v_smfmac_f32_32x32x32_bf16 v[104:119], v[52:55], v[96:103], v11
    v_exp_f32 v64, v64
    v_exp_f32 v65, v65
    v_exp_f32 v66, v66
    v_exp_f32 v67, v67
    v_smfmac_f32_32x32x32_bf16 v[120:135], v[48:51], v[56:63], v11
    v_exp_f32 v68, v68
    v_exp_f32 v69, v69
    v_exp_f32 v70, v70
    v_exp_f32 v71, v71
    s_nop 1
    v_smfmac_f32_32x32x32_bf16 v[120:135], v[52:55], v[64:71], v11
    s_mov_b64 s[60:61], -1
    s_nop 10
    ds_write_b128 v14, v[120:123] offset:0
    ds_write_b128 v14, v[124:127] offset:1024
    ds_write_b128 v14, v[128:131] offset:2048
    ds_write_b32 v18, v132
    s_waitcnt lgkmcnt(0)
    ds_write_b32 v16, v26
    s_mov_b32 s63, 1048576
K2_spinA:
    ds_read_b32 v2, v17 offset:0
    s_waitcnt lgkmcnt(0)
    v_readfirstlane_b32 s31, v2
    s_nop 0
    s_cmp_ge_u32 s31, 1
    s_cbranch_scc1 K2_spinA_x
    s_sub_u32 s63, s63, 1
    s_cbranch_scc0 K2_spinA
K2_spinA_x:
    ds_read_b128 v[120:123], v15 offset:0
    ds_read_b128 v[124:127], v15 offset:1024
    ds_read_b128 v[128:131], v15 offset:2048
    ds_read_b32 v132, v19
    s_waitcnt lgkmcnt(3)
    v_add_f32 v104, v104, v120
    v_add_f32 v105, v105, v121
    v_add_f32 v106, v106, v122
    v_add_f32 v107, v107, v123
    s_waitcnt lgkmcnt(2)
    v_add_f32 v108, v108, v124
    v_add_f32 v109, v109, v125
    v_add_f32 v110, v110, v126
    v_add_f32 v111, v111, v127
    s_waitcnt lgkmcnt(1)
    v_add_f32 v112, v112, v128
    v_add_f32 v113, v113, v129
    v_add_f32 v114, v114, v130
    v_add_f32 v115, v115, v131
    s_waitcnt lgkmcnt(0)
    v_add_f32 v116, v116, v132
K2_norm:
    v_rcp_f32 v3, v116
    s_nop 0
    v_mul_f32 v88, v104, v3
    v_mul_f32 v89, v105, v3
    v_cvt_pk_bf16_f32 v56, v88, v89
    ds_write_b16 v20, v56 offset:0
    ds_write_b16_d16_hi v20, v56 offset:64
    v_mul_f32 v90, v106, v3
    v_mul_f32 v91, v107, v3
    v_cvt_pk_bf16_f32 v57, v90, v91
    ds_write_b16 v20, v57 offset:128
    ds_write_b16_d16_hi v20, v57 offset:192
    v_mul_f32 v92, v108, v3
    v_mul_f32 v93, v109, v3
    v_cvt_pk_bf16_f32 v58, v92, v93
    ds_write_b16 v20, v58 offset:512
    ds_write_b16_d16_hi v20, v58 offset:576
    v_mul_f32 v94, v110, v3
    v_mul_f32 v95, v111, v3
    v_cvt_pk_bf16_f32 v59, v94, v95
    ds_write_b16 v20, v59 offset:640
    ds_write_b16_d16_hi v20, v59 offset:704
    s_mov_b32 exec_hi, 0
    v_mul_f32 v96, v112, v3
    v_mul_f32 v97, v113, v3
    v_cvt_pk_bf16_f32 v60, v96, v97
    ds_write_b16 v20, v60 offset:1024
    ds_write_b16_d16_hi v20, v60 offset:1088
    v_mul_f32 v98, v114, v3
    v_mul_f32 v99, v115, v3
    v_cvt_pk_bf16_f32 v61, v98, v99
    ds_write_b16 v20, v61 offset:1152
    ds_write_b16_d16_hi v20, v61 offset:1216
    s_mov_b32 exec_hi, -1
    s_waitcnt lgkmcnt(0)
    ds_read_b128 v[72:75], v21
    ds_read_b128 v[76:79], v21 offset:1024
    s_waitcnt lgkmcnt(1)
    buffer_store_dwordx4 v[72:75], v22, s[16:19], 0 offen sc1
    s_waitcnt lgkmcnt(0)
    s_mov_b64 exec, 0xffff
    buffer_store_dwordx4 v[76:79], v22, s[16:19], 0 offen offset:2048 sc1
    s_mov_b64 exec, -1
    v_add_f32 v3, |v104|, |v105|
    v_add_f32 v4, |v106|, |v107|
    v_add_f32 v3, v3, |v108|
    v_add_f32 v4, v4, |v109|
    v_add_f32 v3, v3, |v110|
    v_add_f32 v4, v4, |v111|
    v_add_f32 v3, v3, |v112|
    v_add_f32 v4, v4, |v113|
    v_add_f32 v3, v3, |v114|
    v_add_f32 v4, v4, |v115|
    v_add_f32 v3, v3, v4
    v_cmp_nge_f32 vcc, 0x7b800000, v3
    s_nop 0
    s_mov_b64 s[52:53], vcc
    v_cmp_nge_f32 vcc, 0x5f800000, v116
    s_nop 0
    s_or_b64 s[52:53], s[52:53], vcc
    v_cmp_nle_f32 vcc, 0x1f800000, v116
    s_nop 0
    s_or_b64 vcc, vcc, s[52:53]
    s_and_b64 vcc, vcc, s[60:61]
    s_cbranch_vccnz K2_fallback
    s_mov_b64 exec, 1
    v_mov_b32 v1, 159812
    v_mov_b32 v2, 1
    s_lshl_b32 s31, s26, 5
    s_add_u32 s31, s31, s27
    s_lshl_b32 s31, s31, 2
    s_add_u32 s31, s31, 12058624
    v_mov_b32 v4, s31
    s_waitcnt vmcnt(0)
    ds_add_rtn_u32 v3, v1, v2
    s_waitcnt lgkmcnt(0)
    v_cmp_eq_u32 vcc, 7, v3
    s_nop 0
    s_and_b64 exec, exec, vcc
    s_cbranch_execz K2_nopub
    buffer_store_dword v2, v4, s[16:19], 0 offen sc1
    s_mov_b64 exec, 0xff
    s_lshl_b32 s31, s26, 7
    s_add_u32 s31, s31, 12058624
    v_lshl_add_u32 v4, v0, 2, s31
    s_mov_b32 s63, 0x40000
K2_pollO:
    s_load_dwordx8 s[40:47], s[8:9], s31 glc
    s_waitcnt lgkmcnt(0)
    s_and_b32 s40, s40, s41
    s_and_b32 s42, s42, s43
    s_and_b32 s44, s44, s45
    s_and_b32 s46, s46, s47
    s_and_b32 s40, s40, s42
    s_and_b32 s44, s44, s46
    s_and_b32 s40, s40, s44
    s_cmp_eq_u32 s40, 1
    s_cbranch_scc1 K2_pollO_ok
    s_sleep 2
    s_sub_u32 s63, s63, 1
    s_cbranch_scc0 K2_pollO
K2_pollO_ok:
    v_mov_b32 v1, 159820
    s_waitcnt vmcnt(0)
    ds_write_b32 v1, v26
K2_nopub:
    s_mov_b64 exec, -1
    s_mov_b32 s40, s64
    s_mov_b32 s41, s65
    s_mov_b32 s42, 2621440
    s_mov_b32 s43, 0x20000
    s_mov_b32 s44, s70
    s_mov_b32 s45, s71
    s_mov_b32 s46, 4096
    s_mov_b32 s47, 0x20000
    s_mov_b32 s52, s66
    s_mov_b32 s53, s67
    s_mov_b32 s54, 2621440
    s_mov_b32 s55, 0x20000
    s_mul_i32 s48, s26, 81920
    s_mul_i32 s49, s27, 160
    s_add_u32 s48, s48, s49
    s_lshl_b32 s49, s26, 7
    s_lshl_b32 s56, s30, 6
    v_add_u32 v56, s56, v0
    v_mul_u32_u24 v57, 205, v56
    v_lshrrev_b32 v57, 11, v57
    v_mul_u32_u24 v58, 10, v57
    v_sub_u32 v58, v56, v58
    v_mul_u32_u24 v59, 336, v57
    v_lshl_add_u32 v59, v58, 5, v59
    v_mul_u32_u24 v60, 1280, v57
    v_lshl_add_u32 v60, v58, 4, v60
    v_lshlrev_b32 v57, 1, v57
    buffer_load_dwordx4 v[64:67], v60, s[40:43], s48 offen
    buffer_load_ushort v61, v57, s[44:47], s49 offen
    v_add_u32 v56, 55296, v59
    s_barrier
    s_cmp_ge_u32 s30, 10
    s_cbranch_scc1 K2_end
    ds_read_b128 v[72:75], v59 offset:0
    ds_read_b128 v[76:79], v59 offset:16
    ds_read_b128 v[80:83], v59 offset:27648
    ds_read_b128 v[84:87], v59 offset:27664
    ds_read_b128 v[88:91], v56 offset:0
    ds_read_b128 v[92:95], v56 offset:16
    ds_read_b128 v[96:99], v56 offset:27648
    ds_read_b128 v[100:103], v56 offset:27664
    s_waitcnt vmcnt(0)
    v_lshlrev_b32 v61, 16, v61
    v_lshlrev_b32 v104, 16, v64
    v_and_b32 v105, 0xffff0000, v64
    v_lshlrev_b32 v106, 16, v65
    v_and_b32 v107, 0xffff0000, v65
    v_lshlrev_b32 v108, 16, v66
    v_and_b32 v109, 0xffff0000, v66
    v_lshlrev_b32 v110, 16, v67
    v_and_b32 v111, 0xffff0000, v67
    v_add_f32 v104, v104, v61
    v_add_f32 v105, v105, v61
    v_add_f32 v106, v106, v61
    v_add_f32 v107, v107, v61
    v_add_f32 v108, v108, v61
    v_add_f32 v109, v109, v61
    v_add_f32 v110, v110, v61
    v_add_f32 v111, v111, v61
    s_waitcnt lgkmcnt(6)
    v_pk_add_f32 v[104:105], v[104:105], v[72:73]
    v_pk_add_f32 v[106:107], v[106:107], v[74:75]
    v_pk_add_f32 v[108:109], v[108:109], v[76:77]
    v_pk_add_f32 v[110:111], v[110:111], v[78:79]
    s_waitcnt lgkmcnt(4)
    v_pk_add_f32 v[104:105], v[104:105], v[80:81]
    v_pk_add_f32 v[106:107], v[106:107], v[82:83]
    v_pk_add_f32 v[108:109], v[108:109], v[84:85]
    v_pk_add_f32 v[110:111], v[110:111], v[86:87]
    s_waitcnt lgkmcnt(2)
    v_pk_add_f32 v[104:105], v[104:105], v[88:89]
    v_pk_add_f32 v[106:107], v[106:107], v[90:91]
    v_pk_add_f32 v[108:109], v[108:109], v[92:93]
    v_pk_add_f32 v[110:111], v[110:111], v[94:95]
    s_waitcnt lgkmcnt(0)
    v_pk_add_f32 v[104:105], v[104:105], v[96:97]
    v_pk_add_f32 v[106:107], v[106:107], v[98:99]
    v_pk_add_f32 v[108:109], v[108:109], v[100:101]
    v_pk_add_f32 v[110:111], v[110:111], v[102:103]
    v_cvt_pk_bf16_f32 v64, v104, v105
    v_cvt_pk_bf16_f32 v65, v106, v107
    v_cvt_pk_bf16_f32 v66, v108, v109
    v_cvt_pk_bf16_f32 v67, v110, v111
    buffer_store_dwordx4 v[64:67], v60, s[52:55], s48 offen
    s_endpgm
K2_slow0:
    s_mov_b32 s63, 1048576
K2_sp0:
    ds_read_b32 v27, v25 offset:12
    s_waitcnt lgkmcnt(0)
    v_readfirstlane_b32 s31, v27
    s_nop 0
    s_cmp_ge_u32 s31, 8
    s_cbranch_scc1 K2_sp0_x
    s_sleep 1
    s_sub_u32 s63, s63, 1
    s_cbranch_scc0 K2_sp0
K2_sp0_x:
    s_branch K2_go0
K2_slow1:
    s_mov_b32 s63, 1048576
K2_sp1:
    ds_read_b32 v27, v25 offset:0
    s_waitcnt lgkmcnt(0)
    v_readfirstlane_b32 s31, v27
    s_nop 0
    s_cmp_ge_u32 s31, 8
    s_cbranch_scc1 K2_sp1_x
    s_sleep 1
    s_sub_u32 s63, s63, 1
    s_cbranch_scc0 K2_sp1
K2_sp1_x:
    s_branch K2_go1
K2_slow2:
    s_mov_b32 s63, 1048576
K2_sp2:
    ds_read_b32 v27, v25 offset:4
    s_waitcnt lgkmcnt(0)
    v_readfirstlane_b32 s31, v27
    s_nop 0
    s_cmp_ge_u32 s31, 8
    s_cbranch_scc1 K2_sp2_x
    s_sleep 1
    s_sub_u32 s63, s63, 1
    s_cbranch_scc0 K2_sp2
K2_sp2_x:
    s_branch K2_go2
K2_slow3:
    s_mov_b32 s63, 1048576
K2_sp3:
    ds_read_b32 v27, v25 offset:0
    s_waitcnt lgkmcnt(0)
    v_readfirstlane_b32 s31, v27
    s_nop 0
    s_cmp_ge_u32 s31, 16
    s_cbranch_scc1 K2_sp3_x
    s_sleep 1
    s_sub_u32 s63, s63, 1
    s_cbranch_scc0 K2_sp3
K2_sp3_x:
    s_branch K2_go3
K2_slow4:
    s_mov_b32 s63, 1048576
K2_sp4:
    ds_read_b32 v27, v25 offset:4
    s_waitcnt lgkmcnt(0)
    v_readfirstlane_b32 s31, v27
    s_nop 0
    s_cmp_ge_u32 s31, 16
    s_cbranch_scc1 K2_sp4_x
    s_sleep 1
    s_sub_u32 s63, s63, 1
    s_cbranch_scc0 K2_sp4
K2_sp4_x:
    s_branch K2_go4
K2_slow5:
    s_mov_b32 s63, 1048576
K2_sp5:
    ds_read_b32 v27, v25 offset:0
    s_waitcnt lgkmcnt(0)
    v_readfirstlane_b32 s31, v27
    s_nop 0
    s_cmp_ge_u32 s31, 24
    s_cbranch_scc1 K2_sp5_x
    s_sleep 1
    s_sub_u32 s63, s63, 1
    s_cbranch_scc0 K2_sp5
K2_sp5_x:
    s_branch K2_go5
K2_slow6:
    s_mov_b32 s63, 1048576
K2_sp6:
    ds_read_b32 v27, v25 offset:4
    s_waitcnt lgkmcnt(0)
    v_readfirstlane_b32 s31, v27
    s_nop 0
    s_cmp_ge_u32 s31, 24
    s_cbranch_scc1 K2_sp6_x
    s_sleep 1
    s_sub_u32 s63, s63, 1
    s_cbranch_scc0 K2_sp6
K2_sp6_x:
    s_branch K2_go6
K2_slow7:
    s_mov_b32 s63, 1048576
K2_sp7:
    ds_read_b32 v27, v25 offset:0
    s_waitcnt lgkmcnt(0)
    v_readfirstlane_b32 s31, v27
    s_nop 0
    s_cmp_ge_u32 s31, 32
    s_cbranch_scc1 K2_sp7_x
    s_sleep 1
    s_sub_u32 s63, s63, 1
    s_cbranch_scc0 K2_sp7
K2_sp7_x:
    s_branch K2_go7
K2_slow8:
    s_mov_b32 s63, 1048576
K2_sp8:
    ds_read_b32 v27, v25 offset:4
    s_waitcnt lgkmcnt(0)
    v_readfirstlane_b32 s31, v27
    s_nop 0
    s_cmp_ge_u32 s31, 32
    s_cbranch_scc1 K2_sp8_x
    s_sleep 1
    s_sub_u32 s63, s63, 1
    s_cbranch_scc0 K2_sp8
K2_sp8_x:
    s_branch K2_go8
K2_slow9:
    s_mov_b32 s63, 1048576
K2_sp9:
    ds_read_b32 v27, v25 offset:0
    s_waitcnt lgkmcnt(0)
    v_readfirstlane_b32 s31, v27
    s_nop 0
    s_cmp_ge_u32 s31, 40
    s_cbranch_scc1 K2_sp9_x
    s_sleep 1
    s_sub_u32 s63, s63, 1
    s_cbranch_scc0 K2_sp9
K2_sp9_x:
    s_branch K2_go9
K2_slow10:
    s_mov_b32 s63, 1048576
K2_sp10:
    ds_read_b32 v27, v25 offset:4
    s_waitcnt lgkmcnt(0)
    v_readfirstlane_b32 s31, v27
    s_nop 0
    s_cmp_ge_u32 s31, 40
    s_cbranch_scc1 K2_sp10_x
    s_sleep 1
    s_sub_u32 s63, s63, 1
    s_cbranch_scc0 K2_sp10
K2_sp10_x:
    s_branch K2_go10
K2_slow11:
    s_mov_b32 s63, 1048576
K2_sp11:
    ds_read_b32 v27, v25 offset:0
    s_waitcnt lgkmcnt(0)
    v_readfirstlane_b32 s31, v27
    s_nop 0
    s_cmp_ge_u32 s31, 48
    s_cbranch_scc1 K2_sp11_x
    s_sleep 1
    s_sub_u32 s63, s63, 1
    s_cbranch_scc0 K2_sp11
K2_sp11_x:
    s_branch K2_go11
K2_slow12:
    s_mov_b32 s63, 1048576
K2_sp12:
    ds_read_b32 v27, v25 offset:4
    s_waitcnt lgkmcnt(0)
    v_readfirstlane_b32 s31, v27
    s_nop 0
    s_cmp_ge_u32 s31, 48
    s_cbranch_scc1 K2_sp12_x
    s_sleep 1
    s_sub_u32 s63, s63, 1
    s_cbranch_scc0 K2_sp12
K2_sp12_x:
    s_branch K2_go12
K2_slow13:
    s_mov_b32 s63, 1048576
K2_sp13:
    ds_read_b32 v27, v25 offset:0
    s_waitcnt lgkmcnt(0)
    v_readfirstlane_b32 s31, v27
    s_nop 0
    s_cmp_ge_u32 s31, 56
    s_cbranch_scc1 K2_sp13_x
    s_sleep 1
    s_sub_u32 s63, s63, 1
    s_cbranch_scc0 K2_sp13
K2_sp13_x:
    s_branch K2_go13
K2_slow14:
    s_mov_b32 s63, 1048576
K2_sp14:
    ds_read_b32 v27, v25 offset:4
    s_waitcnt lgkmcnt(0)
    v_readfirstlane_b32 s31, v27
    s_nop 0
    s_cmp_ge_u32 s31, 56
    s_cbranch_scc1 K2_sp14_x
    s_sleep 1
    s_sub_u32 s63, s63, 1
    s_cbranch_scc0 K2_sp14
K2_sp14_x:
    s_branch K2_go14
K2_slow15:
    s_mov_b32 s63, 1048576
K2_sp15:
    ds_read_b32 v27, v25 offset:0
    s_waitcnt lgkmcnt(0)
    v_readfirstlane_b32 s31, v27
    s_nop 0
    s_cmp_ge_u32 s31, 64
    s_cbranch_scc1 K2_sp15_x
    s_sleep 1
    s_sub_u32 s63, s63, 1
    s_cbranch_scc0 K2_sp15
K2_sp15_x:
    s_branch K2_go15
K2_fallback:
    s_nop 7
    s_mov_b64 s[60:61], 0
    s_waitcnt vmcnt(0)
    v_cndmask_b32 v36, v36, 0, s[50:51]
    v_add_u32 v120, 5132288, v12
    v_add_u32 v121, 5132288, v13
    v_add_u32 v122, 5132288, v10
    v_mov_b32 v3, 0xff800000
    s_mov_b32 s57, 0
    v_mov_b32 v104, 0
    v_mov_b32 v105, 0
    v_mov_b32 v106, 0
    v_mov_b32 v107, 0
    v_mov_b32 v108, 0
    v_mov_b32 v109, 0
    v_mov_b32 v110, 0
    v_mov_b32 v111, 0
    v_mov_b32 v112, 0
    v_mov_b32 v113, 0
    v_mov_b32 v114, 0
    v_mov_b32 v115, 0
    v_mov_b32 v116, 0
    v_mov_b32 v117, 0
    v_mov_b32 v118, 0
    v_mov_b32 v119, 0
K2_fb1:
    buffer_load_dwordx4 v[40:43], v120, s[16:19], s57 offen offset:0
    buffer_load_dwordx2 v[44:45], v121, s[16:19], s57 offen offset:0
    s_waitcnt vmcnt(0)
    v_mfma_f32_32x32x16_bf16 v[56:71], v[40:43], v[28:31], 0
    v_mfma_f32_32x32x8_bf16 v[56:71], v[44:45], v[36:37], v[56:71]
    s_nop 11
    v_max3_f32 v4, v56, v57, v58
    v_max3_f32 v4, v4, v59, v60
    v_max3_f32 v4, v4, v61, v62
    v_max3_f32 v4, v4, v63, v64
    v_max3_f32 v4, v4, v65, v66
    v_max3_f32 v4, v4, v67, v68
    v_max3_f32 v4, v4, v69, v70
    v_max_f32 v4, v4, v71
    v_max_f32 v3, v3, v4
    buffer_load_dwordx4 v[40:43], v120, s[16:19], s57 offen offset:1024
    buffer_load_dwordx2 v[44:45], v121, s[16:19], s57 offen offset:512
    s_waitcnt vmcnt(0)
    v_mfma_f32_32x32x16_bf16 v[56:71], v[40:43], v[28:31], 0
    v_mfma_f32_32x32x8_bf16 v[56:71], v[44:45], v[36:37], v[56:71]
    s_nop 11
    v_max3_f32 v4, v56, v57, v58
    v_max3_f32 v4, v4, v59, v60
    v_max3_f32 v4, v4, v61, v62
    v_max3_f32 v4, v4, v63, v64
    v_max3_f32 v4, v4, v65, v66
    v_max3_f32 v4, v4, v67, v68
    v_max3_f32 v4, v4, v69, v70
    v_max_f32 v4, v4, v71
    v_max_f32 v3, v3, v4
    s_add_u32 s57, s57, 6144
    s_cmp_lt_u32 s57, 196608
    s_cbranch_scc1 K2_fb1
    v_mov_b32 v4, v3
    s_nop 1
    v_permlane32_swap_b32 v3, v4
    v_max_f32 v3, v3, v4
    s_mov_b32 s57, 0
K2_fb2:
    s_add_u32 s58, s57, 7680
    buffer_load_dwordx4 v[40:43], v120, s[16:19], s57 offen offset:0
    buffer_load_dwordx2 v[44:45], v121, s[16:19], s57 offen offset:0
    buffer_load_dwordx4 v[48:51], v122, s[16:19], s57 offen offset:0
    buffer_load_dwordx4 v[52:55], v122, s[16:19], s58 offen offset:0
    s_waitcnt vmcnt(0)
    v_mfma_f32_32x32x16_bf16 v[56:71], v[40:43], v[28:31], 0
    v_mfma_f32_32x32x8_bf16 v[56:71], v[44:45], v[36:37], v[56:71]
    s_nop 11
    v_sub_f32 v56, v56, v3
    v_sub_f32 v57, v57, v3
    v_sub_f32 v58, v58, v3
    v_sub_f32 v59, v59, v3
    v_sub_f32 v60, v60, v3
    v_sub_f32 v61, v61, v3
    v_sub_f32 v62, v62, v3
    v_sub_f32 v63, v63, v3
    v_sub_f32 v64, v64, v3
    v_sub_f32 v65, v65, v3
    v_sub_f32 v66, v66, v3
    v_sub_f32 v67, v67, v3
    v_sub_f32 v68, v68, v3
    v_sub_f32 v69, v69, v3
    v_sub_f32 v70, v70, v3
    v_sub_f32 v71, v71, v3
    v_exp_f32 v56, v56
    v_exp_f32 v57, v57
    v_exp_f32 v58, v58
    v_exp_f32 v59, v59
    v_exp_f32 v60, v60
    v_exp_f32 v61, v61
    v_exp_f32 v62, v62
    v_exp_f32 v63, v63
    v_exp_f32 v64, v64
    v_exp_f32 v65, v65
    v_exp_f32 v66, v66
    v_exp_f32 v67, v67
    v_exp_f32 v68, v68
    v_exp_f32 v69, v69
    v_exp_f32 v70, v70
    v_exp_f32 v71, v71
    v_smfmac_f32_32x32x32_bf16 v[104:119], v[48:51], v[56:63], v11
    s_nop 0
    v_smfmac_f32_32x32x32_bf16 v[104:119], v[52:55], v[64:71], v11
    s_nop 7
    buffer_load_dwordx4 v[40:43], v120, s[16:19], s57 offen offset:1024
    buffer_load_dwordx2 v[44:45], v121, s[16:19], s57 offen offset:512
    buffer_load_dwordx4 v[48:51], v122, s[16:19], s57 offen offset:768
    buffer_load_dwordx4 v[52:55], v122, s[16:19], s58 offen offset:768
    s_waitcnt vmcnt(0)
    v_mfma_f32_32x32x16_bf16 v[56:71], v[40:43], v[28:31], 0
    v_mfma_f32_32x32x8_bf16 v[56:71], v[44:45], v[36:37], v[56:71]
    s_nop 11
    v_sub_f32 v56, v56, v3
    v_sub_f32 v57, v57, v3
    v_sub_f32 v58, v58, v3
    v_sub_f32 v59, v59, v3
    v_sub_f32 v60, v60, v3
    v_sub_f32 v61, v61, v3
    v_sub_f32 v62, v62, v3
    v_sub_f32 v63, v63, v3
    v_sub_f32 v64, v64, v3
    v_sub_f32 v65, v65, v3
    v_sub_f32 v66, v66, v3
    v_sub_f32 v67, v67, v3
    v_sub_f32 v68, v68, v3
    v_sub_f32 v69, v69, v3
    v_sub_f32 v70, v70, v3
    v_sub_f32 v71, v71, v3
    v_exp_f32 v56, v56
    v_exp_f32 v57, v57
    v_exp_f32 v58, v58
    v_exp_f32 v59, v59
    v_exp_f32 v60, v60
    v_exp_f32 v61, v61
    v_exp_f32 v62, v62
    v_exp_f32 v63, v63
    v_exp_f32 v64, v64
    v_exp_f32 v65, v65
    v_exp_f32 v66, v66
    v_exp_f32 v67, v67
    v_exp_f32 v68, v68
    v_exp_f32 v69, v69
    v_exp_f32 v70, v70
    v_exp_f32 v71, v71
    v_smfmac_f32_32x32x32_bf16 v[104:119], v[48:51], v[56:63], v11
    s_nop 0
    v_smfmac_f32_32x32x32_bf16 v[104:119], v[52:55], v[64:71], v11
    s_nop 7
    s_add_u32 s57, s57, 6144
    s_cmp_lt_u32 s57, 196608
    s_cbranch_scc1 K2_fb2
    s_nop 15
    s_branch K2_norm
K2_eng:
    v_lshlrev_b32 v5, 4, v0
    v_lshlrev_b32 v11, 2, v0
    v_add_u32 v11, 159808, v11
    v_mov_b32 v15, 159808
    v_mov_b32 v10, 0
    s_mul_i32 s35, s34, 27648
    s_mov_b64 exec, 0xffff
    ds_write_b32 v11, v10
    s_mov_b64 exec, -1
    s_cmp_ge_u32 s25, 27
    s_cbranch_scc1 K2_wot
    s_mul_i32 s31, s24, 27
    s_add_u32 s31, s31, s25
    s_lshr_b32 s28, s31, 3
    s_and_b32 s29, s31, 7
    s_lshl_b32 s32, s28, 7
    v_lshrrev_b32 v10, 3, v0
    v_and_b32 v11, 7, v0
    v_bfe_u32 v12, v10, 1, 1
    v_lshlrev_b32 v12, 2, v12
    v_xor_b32 v11, v11, v12
    v_mul_u32_u24 v10, 3456, v10
    v_lshl_add_u32 v10, v11, 4, v10
    v_add_u32 v1, s32, v10
    v_xor_b32 v2, 32, v1
    v_add_u32 v2, 26624, v2
    v_add_u32 v3, 53248, v1
    v_add_u32 v4, 53248, v2
    s_mul_i32 s36, s34, 110592
    s_lshl_b32 s37, s29, 6
    s_add_u32 s37, s37, s34
    s_mul_i32 s37, s37, 5120
    s_add_u32 s37, s37, 2621440
    s_waitcnt lgkmcnt(0)
    s_mov_b32 s16, s8
    s_mov_b32 s17, s9
    s_mov_b32 s18, 12582912
    s_mov_b32 s19, 0x20000
    s_mov_b32 s12, s4
    s_mov_b32 s13, s5
    s_mov_b32 s14, 7077888
    s_mov_b32 s15, 0x20000
    s_cmp_lg_u32 s34, 0
    s_cbranch_scc1 K2_pollA_w
    s_lshl_b32 s57, s26, 10
    s_add_u32 s57, s57, 12070912
    v_add_u32 v10, s57, v5
    s_mov_b32 s63, 0x40000
K2_pollA:
    buffer_load_dwordx4 v[16:19], v10, s[16:19], 0 offen sc1
    s_waitcnt vmcnt(0)
    v_and_b32 v16, v16, v17
    v_and_b32 v18, v18, v19
    v_and_b32 v16, v16, v18
    v_cmp_ne_u32 vcc, 1, v16
    s_cbranch_vccz K2_pollA_ok
    s_sleep 4
    s_sub_u32 s63, s63, 1
    s_cbranch_scc0 K2_pollA
K2_pollA_ok:
    s_waitcnt vmcnt(0)
K2_pollA_w:
    s_setprio 0
    s_barrier
    s_add_u32 m0, s35, 0
    s_nop 0
    buffer_load_dwordx4 v1, s[12:15], s36 offen offset:0  lds
    buffer_load_dwordx4 v2, s[12:15], s36 offen offset:1024  lds
    buffer_load_dwordx4 v3, s[12:15], s36 offen offset:2048  lds
    buffer_load_dwordx4 v4, s[12:15], s36 offen offset:3072  lds
    s_add_u32 s36, s36, 442368
    buffer_load_dwordx4 v[128:131], v5, s[16:19], s37 offen offset:0
    buffer_load_dwordx4 v[132:135], v5, s[16:19], s37 offen offset:1024
    buffer_load_dwordx4 v[136:139], v5, s[16:19], s37 offen offset:2048
    buffer_load_dwordx4 v[140:143], v5, s[16:19], s37 offen offset:3072
    s_add_u32 s37, s37, 4096
    buffer_load_dwordx4 v[144:147], v5, s[16:19], s37 offen offset:0
    s_add_u32 s37, s37, 16384
    s_add_u32 m0, s35, 4096
    s_nop 0
    buffer_load_dwordx4 v1, s[12:15], s36 offen offset:0  lds
    buffer_load_dwordx4 v2, s[12:15], s36 offen offset:1024  lds
    buffer_load_dwordx4 v3, s[12:15], s36 offen offset:2048  lds
    buffer_load_dwordx4 v4, s[12:15], s36 offen offset:3072  lds
    s_add_u32 s36, s36, 442368
    buffer_load_dwordx4 v[148:151], v5, s[16:19], s37 offen offset:0
    buffer_load_dwordx4 v[152:155], v5, s[16:19], s37 offen offset:1024
    buffer_load_dwordx4 v[156:159], v5, s[16:19], s37 offen offset:2048
    buffer_load_dwordx4 v[160:163], v5, s[16:19], s37 offen offset:3072
    s_add_u32 s37, s37, 4096
    buffer_load_dwordx4 v[164:167], v5, s[16:19], s37 offen offset:0
    s_add_u32 s37, s37, 16384
    s_add_u32 m0, s35, 8192
    s_nop 0
    buffer_load_dwordx4 v1, s[12:15], s36 offen offset:0  lds
    buffer_load_dwordx4 v2, s[12:15], s36 offen offset:1024  lds
    buffer_load_dwordx4 v3, s[12:15], s36 offen offset:2048  lds
    buffer_load_dwordx4 v4, s[12:15], s36 offen offset:3072  lds
    s_add_u32 s36, s36, 442368
    v_and_b32 v96, 15, v0
    v_lshrrev_b32 v97, 4, v0
    v_lshrrev_b32 v10, 2, v96
    v_and_b32 v13, 1, v96
    v_lshl_add_u32 v13, v13, 3, s35
    v_lshl_add_u32 v11, v97, 3, v10
    v_lshl_add_u32 v6, v11, 7, v13
    v_bfe_u32 v11, v96, 3, 1
    v_lshlrev_b32 v11, 2, v11
    v_bfe_u32 v12, v96, 1, 1
    v_and_b32 v13, 1, v97
    v_lshl_or_b32 v11, v13, 1, v11
    v_xor_b32 v11, v12, v11
    v_lshl_add_u32 v6, v11, 4, v6
    v_xor_b32 v7, 32, v6
    v_xor_b32 v8, 64, v6
    v_xor_b32 v9, 96, v6
    s_add_u32 s31, s35, 4096
    v_lshl_add_u32 v13, v0, 4, s31
    s_mov_b32 s20, s6
    s_mov_b32 s21, s7
    s_mov_b32 s22, 3456
    s_mov_b32 s23, 0x20000
    v_mov_b32 v10, v6
    s_add_u32 s31, s34, 0
    s_and_b32 s31, s31, 3
    s_lshl_b32 s31, s31, 5
    v_xor_b32 v6, s31, v10
    s_add_u32 s31, s34, 1
    s_and_b32 s31, s31, 3
    s_lshl_b32 s31, s31, 5
    v_xor_b32 v7, s31, v10
    s_add_u32 s31, s34, 2
    s_and_b32 s31, s31, 3
    s_lshl_b32 s31, s31, 5
    v_xor_b32 v8, s31, v10
    s_add_u32 s31, s34, 3
    s_and_b32 s31, s31, 3
    s_lshl_b32 s31, s31, 5
    v_xor_b32 v9, s31, v10
    s_waitcnt vmcnt(18)
    ds_read_b64_tr_b16 v[96:97], v6 offset:0
    ds_read_b64_tr_b16 v[98:99], v6 offset:512
    ds_read_b64_tr_b16 v[100:101], v7 offset:0
    ds_read_b64_tr_b16 v[102:103], v7 offset:512
    ds_read_b64_tr_b16 v[104:105], v8 offset:0
    ds_read_b64_tr_b16 v[106:107], v8 offset:512
    ds_read_b64_tr_b16 v[108:109], v9 offset:0
    ds_read_b64_tr_b16 v[110:111], v9 offset:512
    s_setprio 0
    s_waitcnt vmcnt(16) lgkmcnt(0)
    v_mfma_f32_16x16x32_bf16 v[16:19], v[96:99], v[128:131], 0
    s_add_u32 m0, s35, 0
    v_mfma_f32_16x16x32_bf16 v[36:39], v[100:103], v[128:131], 0
    buffer_load_dwordx4 v1, s[12:15], s36 offen offset:0  lds
    v_mfma_f32_16x16x32_bf16 v[56:59], v[104:107], v[128:131], 0
    buffer_load_dwordx4 v2, s[12:15], s36 offen offset:1024  lds
    v_mfma_f32_16x16x32_bf16 v[76:79], v[108:111], v[128:131], 0
    buffer_load_dwordx4 v[128:131], v5, s[16:19], s37 offen offset:0
    v_mfma_f32_16x16x32_bf16 v[20:23], v[96:99], v[132:135], 0
    buffer_load_dwordx4 v3, s[12:15], s36 offen offset:2048  lds
    v_mfma_f32_16x16x32_bf16 v[40:43], v[100:103], v[132:135], 0
    buffer_load_dwordx4 v4, s[12:15], s36 offen offset:3072  lds
    v_mfma_f32_16x16x32_bf16 v[60:63], v[104:107], v[132:135], 0
    s_add_u32 s36, s36, 442368
    v_mfma_f32_16x16x32_bf16 v[80:83], v[108:111], v[132:135], 0
    buffer_load_dwordx4 v[132:135], v5, s[16:19], s37 offen offset:1024
    s_waitcnt vmcnt(20)
    v_mfma_f32_16x16x32_bf16 v[24:27], v[96:99], v[136:139], 0
    v_mfma_f32_16x16x32_bf16 v[44:47], v[100:103], v[136:139], 0
    s_waitcnt vmcnt(15)
    ds_read_b64_tr_b16 v[112:113], v6 offset:4096
    ds_read_b64_tr_b16 v[114:115], v6 offset:4608
    v_mfma_f32_16x16x32_bf16 v[64:67], v[104:107], v[136:139], 0
    ds_read_b64_tr_b16 v[116:117], v7 offset:4096
    ds_read_b64_tr_b16 v[118:119], v7 offset:4608
    v_mfma_f32_16x16x32_bf16 v[84:87], v[108:111], v[136:139], 0
    buffer_load_dwordx4 v[136:139], v5, s[16:19], s37 offen offset:2048
    v_mfma_f32_16x16x32_bf16 v[28:31], v[96:99], v[140:143], 0
    v_mfma_f32_16x16x32_bf16 v[48:51], v[100:103], v[140:143], 0
    ds_read_b64_tr_b16 v[120:121], v8 offset:4096
    ds_read_b64_tr_b16 v[122:123], v8 offset:4608
    v_mfma_f32_16x16x32_bf16 v[68:71], v[104:107], v[140:143], 0
    ds_read_b64_tr_b16 v[124:125], v9 offset:4096
    ds_read_b64_tr_b16 v[126:127], v9 offset:4608
    v_mfma_f32_16x16x32_bf16 v[88:91], v[108:111], v[140:143], 0
    buffer_load_dwordx4 v[140:143], v5, s[16:19], s37 offen offset:3072
    s_add_u32 s37, s37, 4096
    v_mfma_f32_16x16x32_bf16 v[32:35], v[96:99], v[144:147], 0
    v_mfma_f32_16x16x32_bf16 v[52:55], v[100:103], v[144:147], 0
    v_mfma_f32_16x16x32_bf16 v[72:75], v[104:107], v[144:147], 0
    v_mfma_f32_16x16x32_bf16 v[92:95], v[108:111], v[144:147], 0
    buffer_load_dwordx4 v[144:147], v5, s[16:19], s37 offen offset:0
    s_add_u32 s37, s37, 16384
    s_waitcnt vmcnt(16) lgkmcnt(0)
    v_mfma_f32_16x16x32_bf16 v[16:19], v[112:115], v[148:151], v[16:19]
    s_add_u32 m0, s35, 4096
    v_mfma_f32_16x16x32_bf16 v[36:39], v[116:119], v[148:151], v[36:39]
    buffer_load_dwordx4 v1, s[12:15], s36 offen offset:0  lds
    v_mfma_f32_16x16x32_bf16 v[56:59], v[120:123], v[148:151], v[56:59]
    buffer_load_dwordx4 v2, s[12:15], s36 offen offset:1024  lds
    v_mfma_f32_16x16x32_bf16 v[76:79], v[124:127], v[148:151], v[76:79]
    buffer_load_dwordx4 v[148:151], v5, s[16:19], s37 offen offset:0
    v_mfma_f32_16x16x32_bf16 v[20:23], v[112:115], v[152:155], v[20:23]
    buffer_load_dwordx4 v3, s[12:15], s36 offen offset:2048  lds
    v_mfma_f32_16x16x32_bf16 v[40:43], v[116:119], v[152:155], v[40:43]
    buffer_load_dwordx4 v4, s[12:15], s36 offen offset:3072  lds
    v_mfma_f32_16x16x32_bf16 v[60:63], v[120:123], v[152:155], v[60:63]
    s_add_u32 s36, s36, 442368
    v_mfma_f32_16x16x32_bf16 v[80:83], v[124:127], v[152:155], v[80:83]
    buffer_load_dwordx4 v[152:155], v5, s[16:19], s37 offen offset:1024
    s_waitcnt vmcnt(20)
    v_mfma_f32_16x16x32_bf16 v[24:27], v[112:115], v[156:159], v[24:27]
    v_mfma_f32_16x16x32_bf16 v[44:47], v[116:119], v[156:159], v[44:47]
    s_waitcnt vmcnt(15)
    ds_read_b64_tr_b16 v[96:97], v6 offset:8192
    ds_read_b64_tr_b16 v[98:99], v6 offset:8704
    v_mfma_f32_16x16x32_bf16 v[64:67], v[120:123], v[156:159], v[64:67]
    ds_read_b64_tr_b16 v[100:101], v7 offset:8192
    ds_read_b64_tr_b16 v[102:103], v7 offset:8704
    v_mfma_f32_16x16x32_bf16 v[84:87], v[124:127], v[156:159], v[84:87]
    buffer_load_dwordx4 v[156:159], v5, s[16:19], s37 offen offset:2048
    v_mfma_f32_16x16x32_bf16 v[28:31], v[112:115], v[160:163], v[28:31]
    v_mfma_f32_16x16x32_bf16 v[48:51], v[116:119], v[160:163], v[48:51]
    ds_read_b64_tr_b16 v[104:105], v8 offset:8192
    ds_read_b64_tr_b16 v[106:107], v8 offset:8704
    v_mfma_f32_16x16x32_bf16 v[68:71], v[120:123], v[160:163], v[68:71]
    ds_read_b64_tr_b16 v[108:109], v9 offset:8192
    ds_read_b64_tr_b16 v[110:111], v9 offset:8704
    v_mfma_f32_16x16x32_bf16 v[88:91], v[124:127], v[160:163], v[88:91]
    buffer_load_dwordx4 v[160:163], v5, s[16:19], s37 offen offset:3072
    s_add_u32 s37, s37, 4096
    v_mfma_f32_16x16x32_bf16 v[32:35], v[112:115], v[164:167], v[32:35]
    v_mfma_f32_16x16x32_bf16 v[52:55], v[116:119], v[164:167], v[52:55]
    v_mfma_f32_16x16x32_bf16 v[72:75], v[120:123], v[164:167], v[72:75]
    v_mfma_f32_16x16x32_bf16 v[92:95], v[124:127], v[164:167], v[92:95]
    buffer_load_dwordx4 v[164:167], v5, s[16:19], s37 offen offset:0
    s_add_u32 s37, s37, 16384
    s_waitcnt vmcnt(12) lgkmcnt(0)
    v_mfma_f32_16x16x32_bf16 v[16:19], v[96:99], v[128:131], v[16:19]
    s_add_u32 m0, s35, 8192
    v_mfma_f32_16x16x32_bf16 v[36:39], v[100:103], v[128:131], v[36:39]
    buffer_load_dwordx4 v1, s[12:15], s36 offen offset:0  lds
    v_mfma_f32_16x16x32_bf16 v[56:59], v[104:107], v[128:131], v[56:59]
    buffer_load_dwordx4 v2, s[12:15], s36 offen offset:1024  lds
    v_mfma_f32_16x16x32_bf16 v[76:79], v[108:111], v[128:131], v[76:79]
    buffer_load_dwordx4 v[128:131], v5, s[16:19], s37 offen offset:0
    v_mfma_f32_16x16x32_bf16 v[20:23], v[96:99], v[132:135], v[20:23]
    buffer_load_dwordx4 v3, s[12:15], s36 offen offset:2048  lds
    v_mfma_f32_16x16x32_bf16 v[40:43], v[100:103], v[132:135], v[40:43]
    buffer_load_dwordx4 v4, s[12:15], s36 offen offset:3072  lds
    v_mfma_f32_16x16x32_bf16 v[60:63], v[104:107], v[132:135], v[60:63]
    s_add_u32 s36, s36, 442368
    v_mfma_f32_16x16x32_bf16 v[80:83], v[108:111], v[132:135], v[80:83]
    buffer_load_dwordx4 v[132:135], v5, s[16:19], s37 offen offset:1024
    s_waitcnt vmcnt(16)
    v_mfma_f32_16x16x32_bf16 v[24:27], v[96:99], v[136:139], v[24:27]
    v_mfma_f32_16x16x32_bf16 v[44:47], v[100:103], v[136:139], v[44:47]
    ds_read_b64_tr_b16 v[112:113], v6 offset:0
    ds_read_b64_tr_b16 v[114:115], v6 offset:512
    v_mfma_f32_16x16x32_bf16 v[64:67], v[104:107], v[136:139], v[64:67]
    ds_read_b64_tr_b16 v[116:117], v7 offset:0
    ds_read_b64_tr_b16 v[118:119], v7 offset:512
    v_mfma_f32_16x16x32_bf16 v[84:87], v[108:111], v[136:139], v[84:87]
    buffer_load_dwordx4 v[136:139], v5, s[16:19], s37 offen offset:2048
    v_mfma_f32_16x16x32_bf16 v[28:31], v[96:99], v[140:143], v[28:31]
    v_mfma_f32_16x16x32_bf16 v[48:51], v[100:103], v[140:143], v[48:51]
    ds_read_b64_tr_b16 v[120:121], v8 offset:0
    ds_read_b64_tr_b16 v[122:123], v8 offset:512
    v_mfma_f32_16x16x32_bf16 v[68:71], v[104:107], v[140:143], v[68:71]
    ds_read_b64_tr_b16 v[124:125], v9 offset:0
    ds_read_b64_tr_b16 v[126:127], v9 offset:512
    v_mfma_f32_16x16x32_bf16 v[88:91], v[108:111], v[140:143], v[88:91]
    buffer_load_dwordx4 v[140:143], v5, s[16:19], s37 offen offset:3072
    s_add_u32 s37, s37, 4096
    s_waitcnt vmcnt(17)
    v_mfma_f32_16x16x32_bf16 v[32:35], v[96:99], v[144:147], v[32:35]
    v_mfma_f32_16x16x32_bf16 v[52:55], v[100:103], v[144:147], v[52:55]
    v_mfma_f32_16x16x32_bf16 v[72:75], v[104:107], v[144:147], v[72:75]
    v_mfma_f32_16x16x32_bf16 v[92:95], v[108:111], v[144:147], v[92:95]
    buffer_load_dwordx4 v[144:147], v5, s[16:19], s37 offen offset:0
    s_add_u32 s37, s37, 16384
    s_waitcnt vmcnt(12) lgkmcnt(0)
    v_mfma_f32_16x16x32_bf16 v[16:19], v[112:115], v[148:151], v[16:19]
    s_add_u32 m0, s35, 0
    v_mfma_f32_16x16x32_bf16 v[36:39], v[116:119], v[148:151], v[36:39]
    buffer_load_dwordx4 v1, s[12:15], s36 offen offset:0  lds
    v_mfma_f32_16x16x32_bf16 v[56:59], v[120:123], v[148:151], v[56:59]
    buffer_load_dwordx4 v2, s[12:15], s36 offen offset:1024  lds
    v_mfma_f32_16x16x32_bf16 v[76:79], v[124:127], v[148:151], v[76:79]
    buffer_load_dwordx4 v[148:151], v5, s[16:19], s37 offen offset:0
    v_mfma_f32_16x16x32_bf16 v[20:23], v[112:115], v[152:155], v[20:23]
    buffer_load_dwordx4 v3, s[12:15], s36 offen offset:2048  lds
    v_mfma_f32_16x16x32_bf16 v[40:43], v[116:119], v[152:155], v[40:43]
    buffer_load_dwordx4 v4, s[12:15], s36 offen offset:3072  lds
    v_mfma_f32_16x16x32_bf16 v[60:63], v[120:123], v[152:155], v[60:63]
    s_add_u32 s36, s36, 442368
    v_mfma_f32_16x16x32_bf16 v[80:83], v[124:127], v[152:155], v[80:83]
    buffer_load_dwordx4 v[152:155], v5, s[16:19], s37 offen offset:1024
    s_waitcnt vmcnt(16)
    v_mfma_f32_16x16x32_bf16 v[24:27], v[112:115], v[156:159], v[24:27]
    v_mfma_f32_16x16x32_bf16 v[44:47], v[116:119], v[156:159], v[44:47]
    ds_read_b64_tr_b16 v[96:97], v6 offset:4096
    ds_read_b64_tr_b16 v[98:99], v6 offset:4608
    v_mfma_f32_16x16x32_bf16 v[64:67], v[120:123], v[156:159], v[64:67]
    ds_read_b64_tr_b16 v[100:101], v7 offset:4096
    ds_read_b64_tr_b16 v[102:103], v7 offset:4608
    v_mfma_f32_16x16x32_bf16 v[84:87], v[124:127], v[156:159], v[84:87]
    buffer_load_dwordx4 v[156:159], v5, s[16:19], s37 offen offset:2048
    v_mfma_f32_16x16x32_bf16 v[28:31], v[112:115], v[160:163], v[28:31]
    v_mfma_f32_16x16x32_bf16 v[48:51], v[116:119], v[160:163], v[48:51]
    ds_read_b64_tr_b16 v[104:105], v8 offset:4096
    ds_read_b64_tr_b16 v[106:107], v8 offset:4608
    v_mfma_f32_16x16x32_bf16 v[68:71], v[120:123], v[160:163], v[68:71]
    ds_read_b64_tr_b16 v[108:109], v9 offset:4096
    ds_read_b64_tr_b16 v[110:111], v9 offset:4608
    v_mfma_f32_16x16x32_bf16 v[88:91], v[124:127], v[160:163], v[88:91]
    buffer_load_dwordx4 v[160:163], v5, s[16:19], s37 offen offset:3072
    s_add_u32 s37, s37, 4096
    s_waitcnt vmcnt(17)
    v_mfma_f32_16x16x32_bf16 v[32:35], v[112:115], v[164:167], v[32:35]
    v_mfma_f32_16x16x32_bf16 v[52:55], v[116:119], v[164:167], v[52:55]
    v_mfma_f32_16x16x32_bf16 v[72:75], v[120:123], v[164:167], v[72:75]
    v_mfma_f32_16x16x32_bf16 v[92:95], v[124:127], v[164:167], v[92:95]
    buffer_load_dwordx4 v[164:167], v5, s[16:19], s37 offen offset:0
    s_add_u32 s37, s37, 16384
    s_waitcnt vmcnt(12) lgkmcnt(0)
    v_mfma_f32_16x16x32_bf16 v[16:19], v[96:99], v[128:131], v[16:19]
    s_add_u32 m0, s35, 4096
    v_mfma_f32_16x16x32_bf16 v[36:39], v[100:103], v[128:131], v[36:39]
    buffer_load_dwordx4 v1, s[12:15], s36 offen offset:0  lds
    v_mfma_f32_16x16x32_bf16 v[56:59], v[104:107], v[128:131], v[56:59]
    buffer_load_dwordx4 v2, s[12:15], s36 offen offset:1024  lds
    v_mfma_f32_16x16x32_bf16 v[76:79], v[108:111], v[128:131], v[76:79]
    buffer_load_dwordx4 v[128:131], v5, s[16:19], s37 offen offset:0
    v_mfma_f32_16x16x32_bf16 v[20:23], v[96:99], v[132:135], v[20:23]
    buffer_load_dwordx4 v3, s[12:15], s36 offen offset:2048  lds
    v_mfma_f32_16x16x32_bf16 v[40:43], v[100:103], v[132:135], v[40:43]
    buffer_load_dwordx4 v4, s[12:15], s36 offen offset:3072  lds
    v_mfma_f32_16x16x32_bf16 v[60:63], v[104:107], v[132:135], v[60:63]
    s_add_u32 s36, s36, 442368
    v_mfma_f32_16x16x32_bf16 v[80:83], v[108:111], v[132:135], v[80:83]
    buffer_load_dwordx4 v[132:135], v5, s[16:19], s37 offen offset:1024
    s_waitcnt vmcnt(16)
    v_mfma_f32_16x16x32_bf16 v[24:27], v[96:99], v[136:139], v[24:27]
    v_mfma_f32_16x16x32_bf16 v[44:47], v[100:103], v[136:139], v[44:47]
    ds_read_b64_tr_b16 v[112:113], v6 offset:8192
    ds_read_b64_tr_b16 v[114:115], v6 offset:8704
    v_mfma_f32_16x16x32_bf16 v[64:67], v[104:107], v[136:139], v[64:67]
    ds_read_b64_tr_b16 v[116:117], v7 offset:8192
    ds_read_b64_tr_b16 v[118:119], v7 offset:8704
    v_mfma_f32_16x16x32_bf16 v[84:87], v[108:111], v[136:139], v[84:87]
    buffer_load_dwordx4 v[136:139], v5, s[16:19], s37 offen offset:2048
    v_mfma_f32_16x16x32_bf16 v[28:31], v[96:99], v[140:143], v[28:31]
    v_mfma_f32_16x16x32_bf16 v[48:51], v[100:103], v[140:143], v[48:51]
    ds_read_b64_tr_b16 v[120:121], v8 offset:8192
    ds_read_b64_tr_b16 v[122:123], v8 offset:8704
    v_mfma_f32_16x16x32_bf16 v[68:71], v[104:107], v[140:143], v[68:71]
    ds_read_b64_tr_b16 v[124:125], v9 offset:8192
    ds_read_b64_tr_b16 v[126:127], v9 offset:8704
    v_mfma_f32_16x16x32_bf16 v[88:91], v[108:111], v[140:143], v[88:91]
    buffer_load_dwordx4 v[140:143], v5, s[16:19], s37 offen offset:3072
    s_add_u32 s37, s37, 4096
    s_waitcnt vmcnt(17)
    v_mfma_f32_16x16x32_bf16 v[32:35], v[96:99], v[144:147], v[32:35]
    v_mfma_f32_16x16x32_bf16 v[52:55], v[100:103], v[144:147], v[52:55]
    v_mfma_f32_16x16x32_bf16 v[72:75], v[104:107], v[144:147], v[72:75]
    v_mfma_f32_16x16x32_bf16 v[92:95], v[108:111], v[144:147], v[92:95]
    buffer_load_dwordx4 v[144:147], v5, s[16:19], s37 offen offset:0
    s_add_u32 s37, s37, 16384
    s_waitcnt vmcnt(12) lgkmcnt(0)
    v_mfma_f32_16x16x32_bf16 v[16:19], v[112:115], v[148:151], v[16:19]
    s_add_u32 m0, s35, 8192
    v_mfma_f32_16x16x32_bf16 v[36:39], v[116:119], v[148:151], v[36:39]
    buffer_load_dwordx4 v1, s[12:15], s36 offen offset:0  lds
    v_mfma_f32_16x16x32_bf16 v[56:59], v[120:123], v[148:151], v[56:59]
    buffer_load_dwordx4 v2, s[12:15], s36 offen offset:1024  lds
    v_mfma_f32_16x16x32_bf16 v[76:79], v[124:127], v[148:151], v[76:79]
    buffer_load_dwordx4 v[148:151], v5, s[16:19], s37 offen offset:0
    v_mfma_f32_16x16x32_bf16 v[20:23], v[112:115], v[152:155], v[20:23]
    buffer_load_dwordx4 v3, s[12:15], s36 offen offset:2048  lds
    v_mfma_f32_16x16x32_bf16 v[40:43], v[116:119], v[152:155], v[40:43]
    buffer_load_dwordx4 v4, s[12:15], s36 offen offset:3072  lds
    v_mfma_f32_16x16x32_bf16 v[60:63], v[120:123], v[152:155], v[60:63]
    s_add_u32 s36, s36, 442368
    v_mfma_f32_16x16x32_bf16 v[80:83], v[124:127], v[152:155], v[80:83]
    buffer_load_dwordx4 v[152:155], v5, s[16:19], s37 offen offset:1024
    s_waitcnt vmcnt(16)
    v_mfma_f32_16x16x32_bf16 v[24:27], v[112:115], v[156:159], v[24:27]
    v_mfma_f32_16x16x32_bf16 v[44:47], v[116:119], v[156:159], v[44:47]
    ds_read_b64_tr_b16 v[96:97], v6 offset:0
    ds_read_b64_tr_b16 v[98:99], v6 offset:512
    v_mfma_f32_16x16x32_bf16 v[64:67], v[120:123], v[156:159], v[64:67]
    ds_read_b64_tr_b16 v[100:101], v7 offset:0
    ds_read_b64_tr_b16 v[102:103], v7 offset:512
    v_mfma_f32_16x16x32_bf16 v[84:87], v[124:127], v[156:159], v[84:87]
    buffer_load_dwordx4 v[156:159], v5, s[16:19], s37 offen offset:2048
    v_mfma_f32_16x16x32_bf16 v[28:31], v[112:115], v[160:163], v[28:31]
    v_mfma_f32_16x16x32_bf16 v[48:51], v[116:119], v[160:163], v[48:51]
    ds_read_b64_tr_b16 v[104:105], v8 offset:0
    ds_read_b64_tr_b16 v[106:107], v8 offset:512
    v_mfma_f32_16x16x32_bf16 v[68:71], v[120:123], v[160:163], v[68:71]
    ds_read_b64_tr_b16 v[108:109], v9 offset:0
    ds_read_b64_tr_b16 v[110:111], v9 offset:512
    v_mfma_f32_16x16x32_bf16 v[88:91], v[124:127], v[160:163], v[88:91]
    buffer_load_dwordx4 v[160:163], v5, s[16:19], s37 offen offset:3072
    s_add_u32 s37, s37, 4096
    s_waitcnt vmcnt(17)
    v_mfma_f32_16x16x32_bf16 v[32:35], v[112:115], v[164:167], v[32:35]
    v_mfma_f32_16x16x32_bf16 v[52:55], v[116:119], v[164:167], v[52:55]
    v_mfma_f32_16x16x32_bf16 v[72:75], v[120:123], v[164:167], v[72:75]
    v_mfma_f32_16x16x32_bf16 v[92:95], v[124:127], v[164:167], v[92:95]
    buffer_load_dwordx4 v[164:167], v5, s[16:19], s37 offen offset:0
    s_add_u32 s37, s37, 16384
    s_waitcnt vmcnt(12) lgkmcnt(0)
    v_mfma_f32_16x16x32_bf16 v[16:19], v[96:99], v[128:131], v[16:19]
    s_add_u32 m0, s35, 0
    v_mfma_f32_16x16x32_bf16 v[36:39], v[100:103], v[128:131], v[36:39]
    buffer_load_dwordx4 v1, s[12:15], s36 offen offset:0  lds
    v_mfma_f32_16x16x32_bf16 v[56:59], v[104:107], v[128:131], v[56:59]
    buffer_load_dwordx4 v2, s[12:15], s36 offen offset:1024  lds
    v_mfma_f32_16x16x32_bf16 v[76:79], v[108:111], v[128:131], v[76:79]
    buffer_load_dwordx4 v[128:131], v5, s[16:19], s37 offen offset:0
    v_mfma_f32_16x16x32_bf16 v[20:23], v[96:99], v[132:135], v[20:23]
    buffer_load_dwordx4 v3, s[12:15], s36 offen offset:2048  lds
    v_mfma_f32_16x16x32_bf16 v[40:43], v[100:103], v[132:135], v[40:43]
    buffer_load_dwordx4 v4, s[12:15], s36 offen offset:3072  lds
    v_mfma_f32_16x16x32_bf16 v[60:63], v[104:107], v[132:135], v[60:63]
    s_add_u32 s36, s36, 442368
    v_mfma_f32_16x16x32_bf16 v[80:83], v[108:111], v[132:135], v[80:83]
    buffer_load_dwordx4 v[132:135], v5, s[16:19], s37 offen offset:1024
    s_waitcnt vmcnt(16)
    v_mfma_f32_16x16x32_bf16 v[24:27], v[96:99], v[136:139], v[24:27]
    v_mfma_f32_16x16x32_bf16 v[44:47], v[100:103], v[136:139], v[44:47]
    ds_read_b64_tr_b16 v[112:113], v6 offset:4096
    ds_read_b64_tr_b16 v[114:115], v6 offset:4608
    v_mfma_f32_16x16x32_bf16 v[64:67], v[104:107], v[136:139], v[64:67]
    ds_read_b64_tr_b16 v[116:117], v7 offset:4096
    ds_read_b64_tr_b16 v[118:119], v7 offset:4608
    v_mfma_f32_16x16x32_bf16 v[84:87], v[108:111], v[136:139], v[84:87]
    buffer_load_dwordx4 v[136:139], v5, s[16:19], s37 offen offset:2048
    v_mfma_f32_16x16x32_bf16 v[28:31], v[96:99], v[140:143], v[28:31]
    v_mfma_f32_16x16x32_bf16 v[48:51], v[100:103], v[140:143], v[48:51]
    ds_read_b64_tr_b16 v[120:121], v8 offset:4096
    ds_read_b64_tr_b16 v[122:123], v8 offset:4608
    v_mfma_f32_16x16x32_bf16 v[68:71], v[104:107], v[140:143], v[68:71]
    ds_read_b64_tr_b16 v[124:125], v9 offset:4096
    ds_read_b64_tr_b16 v[126:127], v9 offset:4608
    v_mfma_f32_16x16x32_bf16 v[88:91], v[108:111], v[140:143], v[88:91]
    buffer_load_dwordx4 v[140:143], v5, s[16:19], s37 offen offset:3072
    s_add_u32 s37, s37, 4096
    s_waitcnt vmcnt(17)
    v_mfma_f32_16x16x32_bf16 v[32:35], v[96:99], v[144:147], v[32:35]
    v_mfma_f32_16x16x32_bf16 v[52:55], v[100:103], v[144:147], v[52:55]
    v_mfma_f32_16x16x32_bf16 v[72:75], v[104:107], v[144:147], v[72:75]
    v_mfma_f32_16x16x32_bf16 v[92:95], v[108:111], v[144:147], v[92:95]
    buffer_load_dwordx4 v[144:147], v5, s[16:19], s37 offen offset:0
    s_add_u32 s37, s37, 16384
    s_waitcnt vmcnt(12) lgkmcnt(0)
    v_mfma_f32_16x16x32_bf16 v[16:19], v[112:115], v[148:151], v[16:19]
    s_add_u32 m0, s35, 4096
    v_mfma_f32_16x16x32_bf16 v[36:39], v[116:119], v[148:151], v[36:39]
    buffer_load_dwordx4 v1, s[12:15], s36 offen offset:0  lds
    v_mfma_f32_16x16x32_bf16 v[56:59], v[120:123], v[148:151], v[56:59]
    buffer_load_dwordx4 v2, s[12:15], s36 offen offset:1024  lds
    v_mfma_f32_16x16x32_bf16 v[76:79], v[124:127], v[148:151], v[76:79]
    buffer_load_dwordx4 v[148:151], v5, s[16:19], s37 offen offset:0
    v_mfma_f32_16x16x32_bf16 v[20:23], v[112:115], v[152:155], v[20:23]
    buffer_load_dwordx4 v3, s[12:15], s36 offen offset:2048  lds
    v_mfma_f32_16x16x32_bf16 v[40:43], v[116:119], v[152:155], v[40:43]
    buffer_load_dwordx4 v4, s[12:15], s36 offen offset:3072  lds
    v_mfma_f32_16x16x32_bf16 v[60:63], v[120:123], v[152:155], v[60:63]
    s_add_u32 s36, s36, 442368
    v_mfma_f32_16x16x32_bf16 v[80:83], v[124:127], v[152:155], v[80:83]
    buffer_load_dwordx4 v[152:155], v5, s[16:19], s37 offen offset:1024
    s_waitcnt vmcnt(16)
    v_mfma_f32_16x16x32_bf16 v[24:27], v[112:115], v[156:159], v[24:27]
    v_mfma_f32_16x16x32_bf16 v[44:47], v[116:119], v[156:159], v[44:47]
    ds_read_b64_tr_b16 v[96:97], v6 offset:8192
    ds_read_b64_tr_b16 v[98:99], v6 offset:8704
    v_mfma_f32_16x16x32_bf16 v[64:67], v[120:123], v[156:159], v[64:67]
    ds_read_b64_tr_b16 v[100:101], v7 offset:8192
    ds_read_b64_tr_b16 v[102:103], v7 offset:8704
    v_mfma_f32_16x16x32_bf16 v[84:87], v[124:127], v[156:159], v[84:87]
    buffer_load_dwordx4 v[156:159], v5, s[16:19], s37 offen offset:2048
    v_mfma_f32_16x16x32_bf16 v[28:31], v[112:115], v[160:163], v[28:31]
    v_mfma_f32_16x16x32_bf16 v[48:51], v[116:119], v[160:163], v[48:51]
    ds_read_b64_tr_b16 v[104:105], v8 offset:8192
    ds_read_b64_tr_b16 v[106:107], v8 offset:8704
    v_mfma_f32_16x16x32_bf16 v[68:71], v[120:123], v[160:163], v[68:71]
    ds_read_b64_tr_b16 v[108:109], v9 offset:8192
    ds_read_b64_tr_b16 v[110:111], v9 offset:8704
    v_mfma_f32_16x16x32_bf16 v[88:91], v[124:127], v[160:163], v[88:91]
    buffer_load_dwordx4 v[160:163], v5, s[16:19], s37 offen offset:3072
    s_add_u32 s37, s37, 4096
    s_waitcnt vmcnt(17)
    v_mfma_f32_16x16x32_bf16 v[32:35], v[112:115], v[164:167], v[32:35]
    v_mfma_f32_16x16x32_bf16 v[52:55], v[116:119], v[164:167], v[52:55]
    v_mfma_f32_16x16x32_bf16 v[72:75], v[120:123], v[164:167], v[72:75]
    v_mfma_f32_16x16x32_bf16 v[92:95], v[124:127], v[164:167], v[92:95]
    buffer_load_dwordx4 v[164:167], v5, s[16:19], s37 offen offset:0
    s_add_u32 s37, s37, 16384
    s_waitcnt vmcnt(12) lgkmcnt(0)
    v_mfma_f32_16x16x32_bf16 v[16:19], v[96:99], v[128:131], v[16:19]
    s_add_u32 m0, s35, 8192
    v_mfma_f32_16x16x32_bf16 v[36:39], v[100:103], v[128:131], v[36:39]
    buffer_load_dwordx4 v1, s[12:15], s36 offen offset:0  lds
    v_mfma_f32_16x16x32_bf16 v[56:59], v[104:107], v[128:131], v[56:59]
    buffer_load_dwordx4 v2, s[12:15], s36 offen offset:1024  lds
    v_mfma_f32_16x16x32_bf16 v[76:79], v[108:111], v[128:131], v[76:79]
    buffer_load_dwordx4 v[128:131], v5, s[16:19], s37 offen offset:0
    v_mfma_f32_16x16x32_bf16 v[20:23], v[96:99], v[132:135], v[20:23]
    buffer_load_dwordx4 v3, s[12:15], s36 offen offset:2048  lds
    v_mfma_f32_16x16x32_bf16 v[40:43], v[100:103], v[132:135], v[40:43]
    buffer_load_dwordx4 v4, s[12:15], s36 offen offset:3072  lds
    v_mfma_f32_16x16x32_bf16 v[60:63], v[104:107], v[132:135], v[60:63]
    s_add_u32 s36, s36, 442368
    v_mfma_f32_16x16x32_bf16 v[80:83], v[108:111], v[132:135], v[80:83]
    buffer_load_dwordx4 v[132:135], v5, s[16:19], s37 offen offset:1024
    s_waitcnt vmcnt(16)
    v_mfma_f32_16x16x32_bf16 v[24:27], v[96:99], v[136:139], v[24:27]
    v_mfma_f32_16x16x32_bf16 v[44:47], v[100:103], v[136:139], v[44:47]
    ds_read_b64_tr_b16 v[112:113], v6 offset:0
    ds_read_b64_tr_b16 v[114:115], v6 offset:512
    v_mfma_f32_16x16x32_bf16 v[64:67], v[104:107], v[136:139], v[64:67]
    ds_read_b64_tr_b16 v[116:117], v7 offset:0
    ds_read_b64_tr_b16 v[118:119], v7 offset:512
    v_mfma_f32_16x16x32_bf16 v[84:87], v[108:111], v[136:139], v[84:87]
    buffer_load_dwordx4 v[136:139], v5, s[16:19], s37 offen offset:2048
    v_mfma_f32_16x16x32_bf16 v[28:31], v[96:99], v[140:143], v[28:31]
    v_mfma_f32_16x16x32_bf16 v[48:51], v[100:103], v[140:143], v[48:51]
    ds_read_b64_tr_b16 v[120:121], v8 offset:0
    ds_read_b64_tr_b16 v[122:123], v8 offset:512
    v_mfma_f32_16x16x32_bf16 v[68:71], v[104:107], v[140:143], v[68:71]
    ds_read_b64_tr_b16 v[124:125], v9 offset:0
    ds_read_b64_tr_b16 v[126:127], v9 offset:512
    v_mfma_f32_16x16x32_bf16 v[88:91], v[108:111], v[140:143], v[88:91]
    buffer_load_dwordx4 v[140:143], v5, s[16:19], s37 offen offset:3072
    s_add_u32 s37, s37, 4096
    s_waitcnt vmcnt(17)
    v_mfma_f32_16x16x32_bf16 v[32:35], v[96:99], v[144:147], v[32:35]
    v_mfma_f32_16x16x32_bf16 v[52:55], v[100:103], v[144:147], v[52:55]
    v_mfma_f32_16x16x32_bf16 v[72:75], v[104:107], v[144:147], v[72:75]
    v_mfma_f32_16x16x32_bf16 v[92:95], v[108:111], v[144:147], v[92:95]
    buffer_load_dwordx4 v[144:147], v5, s[16:19], s37 offen offset:0
    s_add_u32 s37, s37, 16384
    s_waitcnt vmcnt(12) lgkmcnt(0)
    v_mfma_f32_16x16x32_bf16 v[16:19], v[112:115], v[148:151], v[16:19]
    s_add_u32 m0, s35, 0
    v_mfma_f32_16x16x32_bf16 v[36:39], v[116:119], v[148:151], v[36:39]
    buffer_load_dwordx4 v1, s[12:15], s36 offen offset:0  lds
    v_mfma_f32_16x16x32_bf16 v[56:59], v[120:123], v[148:151], v[56:59]
    buffer_load_dwordx4 v2, s[12:15], s36 offen offset:1024  lds
    v_mfma_f32_16x16x32_bf16 v[76:79], v[124:127], v[148:151], v[76:79]
    buffer_load_dwordx4 v[148:151], v5, s[16:19], s37 offen offset:0
    v_mfma_f32_16x16x32_bf16 v[20:23], v[112:115], v[152:155], v[20:23]
    buffer_load_dwordx4 v3, s[12:15], s36 offen offset:2048  lds
    v_mfma_f32_16x16x32_bf16 v[40:43], v[116:119], v[152:155], v[40:43]
    buffer_load_dwordx4 v4, s[12:15], s36 offen offset:3072  lds
    v_mfma_f32_16x16x32_bf16 v[60:63], v[120:123], v[152:155], v[60:63]
    s_add_u32 s36, s36, 442368
    v_mfma_f32_16x16x32_bf16 v[80:83], v[124:127], v[152:155], v[80:83]
    buffer_load_dwordx4 v[152:155], v5, s[16:19], s37 offen offset:1024
    s_waitcnt vmcnt(16)
    v_mfma_f32_16x16x32_bf16 v[24:27], v[112:115], v[156:159], v[24:27]
    v_mfma_f32_16x16x32_bf16 v[44:47], v[116:119], v[156:159], v[44:47]
    ds_read_b64_tr_b16 v[96:97], v6 offset:4096
    ds_read_b64_tr_b16 v[98:99], v6 offset:4608
    v_mfma_f32_16x16x32_bf16 v[64:67], v[120:123], v[156:159], v[64:67]
    ds_read_b64_tr_b16 v[100:101], v7 offset:4096
    ds_read_b64_tr_b16 v[102:103], v7 offset:4608
    v_mfma_f32_16x16x32_bf16 v[84:87], v[124:127], v[156:159], v[84:87]
    buffer_load_dwordx4 v[156:159], v5, s[16:19], s37 offen offset:2048
    v_mfma_f32_16x16x32_bf16 v[28:31], v[112:115], v[160:163], v[28:31]
    v_mfma_f32_16x16x32_bf16 v[48:51], v[116:119], v[160:163], v[48:51]
    ds_read_b64_tr_b16 v[104:105], v8 offset:4096
    ds_read_b64_tr_b16 v[106:107], v8 offset:4608
    v_mfma_f32_16x16x32_bf16 v[68:71], v[120:123], v[160:163], v[68:71]
    ds_read_b64_tr_b16 v[108:109], v9 offset:4096
    ds_read_b64_tr_b16 v[110:111], v9 offset:4608
    v_mfma_f32_16x16x32_bf16 v[88:91], v[124:127], v[160:163], v[88:91]
    buffer_load_dwordx4 v[160:163], v5, s[16:19], s37 offen offset:3072
    s_add_u32 s37, s37, 4096
    s_waitcnt vmcnt(17)
    v_mfma_f32_16x16x32_bf16 v[32:35], v[112:115], v[164:167], v[32:35]
    v_mfma_f32_16x16x32_bf16 v[52:55], v[116:119], v[164:167], v[52:55]
    v_mfma_f32_16x16x32_bf16 v[72:75], v[120:123], v[164:167], v[72:75]
    v_mfma_f32_16x16x32_bf16 v[92:95], v[124:127], v[164:167], v[92:95]
    buffer_load_dwordx4 v[164:167], v5, s[16:19], s37 offen offset:0
    s_add_u32 s37, s37, 16384
    s_waitcnt vmcnt(12) lgkmcnt(0)
    v_mfma_f32_16x16x32_bf16 v[16:19], v[96:99], v[128:131], v[16:19]
    s_add_u32 m0, s35, 4096
    v_mfma_f32_16x16x32_bf16 v[36:39], v[100:103], v[128:131], v[36:39]
    buffer_load_dwordx4 v1, s[12:15], s36 offen offset:0  lds
    v_mfma_f32_16x16x32_bf16 v[56:59], v[104:107], v[128:131], v[56:59]
    buffer_load_dwordx4 v2, s[12:15], s36 offen offset:1024  lds
    v_mfma_f32_16x16x32_bf16 v[76:79], v[108:111], v[128:131], v[76:79]
    buffer_load_dwordx4 v[128:131], v5, s[16:19], s37 offen offset:0
    v_mfma_f32_16x16x32_bf16 v[20:23], v[96:99], v[132:135], v[20:23]
    buffer_load_dwordx4 v3, s[12:15], s36 offen offset:2048  lds
    v_mfma_f32_16x16x32_bf16 v[40:43], v[100:103], v[132:135], v[40:43]
    buffer_load_dwordx4 v4, s[12:15], s36 offen offset:3072  lds
    v_mfma_f32_16x16x32_bf16 v[60:63], v[104:107], v[132:135], v[60:63]
    s_add_u32 s36, s36, 442368
    v_mfma_f32_16x16x32_bf16 v[80:83], v[108:111], v[132:135], v[80:83]
    buffer_load_dwordx4 v[132:135], v5, s[16:19], s37 offen offset:1024
    s_waitcnt vmcnt(16)
    v_mfma_f32_16x16x32_bf16 v[24:27], v[96:99], v[136:139], v[24:27]
    v_mfma_f32_16x16x32_bf16 v[44:47], v[100:103], v[136:139], v[44:47]
    ds_read_b64_tr_b16 v[112:113], v6 offset:8192
    ds_read_b64_tr_b16 v[114:115], v6 offset:8704
    v_mfma_f32_16x16x32_bf16 v[64:67], v[104:107], v[136:139], v[64:67]
    ds_read_b64_tr_b16 v[116:117], v7 offset:8192
    ds_read_b64_tr_b16 v[118:119], v7 offset:8704
    v_mfma_f32_16x16x32_bf16 v[84:87], v[108:111], v[136:139], v[84:87]
    buffer_load_dwordx4 v[136:139], v5, s[16:19], s37 offen offset:2048
    v_mfma_f32_16x16x32_bf16 v[28:31], v[96:99], v[140:143], v[28:31]
    v_mfma_f32_16x16x32_bf16 v[48:51], v[100:103], v[140:143], v[48:51]
    ds_read_b64_tr_b16 v[120:121], v8 offset:8192
    ds_read_b64_tr_b16 v[122:123], v8 offset:8704
    v_mfma_f32_16x16x32_bf16 v[68:71], v[104:107], v[140:143], v[68:71]
    ds_read_b64_tr_b16 v[124:125], v9 offset:8192
    ds_read_b64_tr_b16 v[126:127], v9 offset:8704
    v_mfma_f32_16x16x32_bf16 v[88:91], v[108:111], v[140:143], v[88:91]
    buffer_load_dwordx4 v[140:143], v5, s[16:19], s37 offen offset:3072
    s_add_u32 s37, s37, 4096
    s_waitcnt vmcnt(17)
    v_mfma_f32_16x16x32_bf16 v[32:35], v[96:99], v[144:147], v[32:35]
    v_mfma_f32_16x16x32_bf16 v[52:55], v[100:103], v[144:147], v[52:55]
    v_mfma_f32_16x16x32_bf16 v[72:75], v[104:107], v[144:147], v[72:75]
    v_mfma_f32_16x16x32_bf16 v[92:95], v[108:111], v[144:147], v[92:95]
    buffer_load_dwordx4 v[144:147], v5, s[16:19], s37 offen offset:0
    s_add_u32 s37, s37, 16384
    s_waitcnt vmcnt(12) lgkmcnt(0)
    v_mfma_f32_16x16x32_bf16 v[16:19], v[112:115], v[148:151], v[16:19]
    s_add_u32 m0, s35, 8192
    v_mfma_f32_16x16x32_bf16 v[36:39], v[116:119], v[148:151], v[36:39]
    buffer_load_dwordx4 v1, s[12:15], s36 offen offset:0  lds
    v_mfma_f32_16x16x32_bf16 v[56:59], v[120:123], v[148:151], v[56:59]
    buffer_load_dwordx4 v2, s[12:15], s36 offen offset:1024  lds
    v_mfma_f32_16x16x32_bf16 v[76:79], v[124:127], v[148:151], v[76:79]
    buffer_load_dwordx4 v[148:151], v5, s[16:19], s37 offen offset:0
    v_mfma_f32_16x16x32_bf16 v[20:23], v[112:115], v[152:155], v[20:23]
    buffer_load_dwordx4 v3, s[12:15], s36 offen offset:2048  lds
    v_mfma_f32_16x16x32_bf16 v[40:43], v[116:119], v[152:155], v[40:43]
    buffer_load_dwordx4 v4, s[12:15], s36 offen offset:3072  lds
    v_mfma_f32_16x16x32_bf16 v[60:63], v[120:123], v[152:155], v[60:63]
    s_add_u32 s36, s36, 442368
    v_mfma_f32_16x16x32_bf16 v[80:83], v[124:127], v[152:155], v[80:83]
    buffer_load_dwordx4 v[152:155], v5, s[16:19], s37 offen offset:1024
    s_waitcnt vmcnt(16)
    v_mfma_f32_16x16x32_bf16 v[24:27], v[112:115], v[156:159], v[24:27]
    v_mfma_f32_16x16x32_bf16 v[44:47], v[116:119], v[156:159], v[44:47]
    ds_read_b64_tr_b16 v[96:97], v6 offset:0
    ds_read_b64_tr_b16 v[98:99], v6 offset:512
    v_mfma_f32_16x16x32_bf16 v[64:67], v[120:123], v[156:159], v[64:67]
    ds_read_b64_tr_b16 v[100:101], v7 offset:0
    ds_read_b64_tr_b16 v[102:103], v7 offset:512
    v_mfma_f32_16x16x32_bf16 v[84:87], v[124:127], v[156:159], v[84:87]
    buffer_load_dwordx4 v[156:159], v5, s[16:19], s37 offen offset:2048
    v_mfma_f32_16x16x32_bf16 v[28:31], v[112:115], v[160:163], v[28:31]
    v_mfma_f32_16x16x32_bf16 v[48:51], v[116:119], v[160:163], v[48:51]
    ds_read_b64_tr_b16 v[104:105], v8 offset:0
    ds_read_b64_tr_b16 v[106:107], v8 offset:512
    v_mfma_f32_16x16x32_bf16 v[68:71], v[120:123], v[160:163], v[68:71]
    ds_read_b64_tr_b16 v[108:109], v9 offset:0
    ds_read_b64_tr_b16 v[110:111], v9 offset:512
    v_mfma_f32_16x16x32_bf16 v[88:91], v[124:127], v[160:163], v[88:91]
    buffer_load_dwordx4 v[160:163], v5, s[16:19], s37 offen offset:3072
    s_add_u32 s37, s37, 4096
    s_waitcnt vmcnt(17)
    v_mfma_f32_16x16x32_bf16 v[32:35], v[112:115], v[164:167], v[32:35]
    v_mfma_f32_16x16x32_bf16 v[52:55], v[116:119], v[164:167], v[52:55]
    v_mfma_f32_16x16x32_bf16 v[72:75], v[120:123], v[164:167], v[72:75]
    v_mfma_f32_16x16x32_bf16 v[92:95], v[124:127], v[164:167], v[92:95]
    buffer_load_dwordx4 v[164:167], v5, s[16:19], s37 offen offset:0
    s_add_u32 s37, s37, 16384
    s_waitcnt vmcnt(12) lgkmcnt(0)
    v_mfma_f32_16x16x32_bf16 v[16:19], v[96:99], v[128:131], v[16:19]
    s_add_u32 m0, s35, 0
    v_mfma_f32_16x16x32_bf16 v[36:39], v[100:103], v[128:131], v[36:39]
    buffer_load_dwordx4 v1, s[12:15], s36 offen offset:0  lds
    v_mfma_f32_16x16x32_bf16 v[56:59], v[104:107], v[128:131], v[56:59]
    buffer_load_dwordx4 v2, s[12:15], s36 offen offset:1024  lds
    v_mfma_f32_16x16x32_bf16 v[76:79], v[108:111], v[128:131], v[76:79]
    buffer_load_dwordx4 v[128:131], v5, s[16:19], s37 offen offset:0
    v_mfma_f32_16x16x32_bf16 v[20:23], v[96:99], v[132:135], v[20:23]
    buffer_load_dwordx4 v3, s[12:15], s36 offen offset:2048  lds
    v_mfma_f32_16x16x32_bf16 v[40:43], v[100:103], v[132:135], v[40:43]
    buffer_load_dwordx4 v4, s[12:15], s36 offen offset:3072  lds
    v_mfma_f32_16x16x32_bf16 v[60:63], v[104:107], v[132:135], v[60:63]
    s_add_u32 s36, s36, 442368
    v_mfma_f32_16x16x32_bf16 v[80:83], v[108:111], v[132:135], v[80:83]
    buffer_load_dwordx4 v[132:135], v5, s[16:19], s37 offen offset:1024
    s_waitcnt vmcnt(16)
    v_mfma_f32_16x16x32_bf16 v[24:27], v[96:99], v[136:139], v[24:27]
    v_mfma_f32_16x16x32_bf16 v[44:47], v[100:103], v[136:139], v[44:47]
    ds_read_b64_tr_b16 v[112:113], v6 offset:4096
    ds_read_b64_tr_b16 v[114:115], v6 offset:4608
    v_mfma_f32_16x16x32_bf16 v[64:67], v[104:107], v[136:139], v[64:67]
    ds_read_b64_tr_b16 v[116:117], v7 offset:4096
    ds_read_b64_tr_b16 v[118:119], v7 offset:4608
    v_mfma_f32_16x16x32_bf16 v[84:87], v[108:111], v[136:139], v[84:87]
    buffer_load_dwordx4 v[136:139], v5, s[16:19], s37 offen offset:2048
    v_mfma_f32_16x16x32_bf16 v[28:31], v[96:99], v[140:143], v[28:31]
    v_mfma_f32_16x16x32_bf16 v[48:51], v[100:103], v[140:143], v[48:51]
    ds_read_b64_tr_b16 v[120:121], v8 offset:4096
    ds_read_b64_tr_b16 v[122:123], v8 offset:4608
    v_mfma_f32_16x16x32_bf16 v[68:71], v[104:107], v[140:143], v[68:71]
    ds_read_b64_tr_b16 v[124:125], v9 offset:4096
    ds_read_b64_tr_b16 v[126:127], v9 offset:4608
    v_mfma_f32_16x16x32_bf16 v[88:91], v[108:111], v[140:143], v[88:91]
    buffer_load_dwordx4 v[140:143], v5, s[16:19], s37 offen offset:3072
    s_add_u32 s37, s37, 4096
    s_waitcnt vmcnt(17)
    v_mfma_f32_16x16x32_bf16 v[32:35], v[96:99], v[144:147], v[32:35]
    v_mfma_f32_16x16x32_bf16 v[52:55], v[100:103], v[144:147], v[52:55]
    v_mfma_f32_16x16x32_bf16 v[72:75], v[104:107], v[144:147], v[72:75]
    v_mfma_f32_16x16x32_bf16 v[92:95], v[108:111], v[144:147], v[92:95]
    buffer_load_dwordx4 v[144:147], v5, s[16:19], s37 offen offset:0
    s_add_u32 s37, s37, 16384
    s_waitcnt vmcnt(12) lgkmcnt(0)
    v_mfma_f32_16x16x32_bf16 v[16:19], v[112:115], v[148:151], v[16:19]
    v_mfma_f32_16x16x32_bf16 v[36:39], v[116:119], v[148:151], v[36:39]
    v_mfma_f32_16x16x32_bf16 v[56:59], v[120:123], v[148:151], v[56:59]
    v_mfma_f32_16x16x32_bf16 v[76:79], v[124:127], v[148:151], v[76:79]
    buffer_load_dwordx4 v[148:151], v5, s[16:19], s37 offen offset:0
    v_mfma_f32_16x16x32_bf16 v[20:23], v[112:115], v[152:155], v[20:23]
    v_mfma_f32_16x16x32_bf16 v[40:43], v[116:119], v[152:155], v[40:43]
    v_mfma_f32_16x16x32_bf16 v[60:63], v[120:123], v[152:155], v[60:63]
    v_mfma_f32_16x16x32_bf16 v[80:83], v[124:127], v[152:155], v[80:83]
    buffer_load_dwordx4 v[152:155], v5, s[16:19], s37 offen offset:1024
    s_waitcnt vmcnt(12)
    v_mfma_f32_16x16x32_bf16 v[24:27], v[112:115], v[156:159], v[24:27]
    v_mfma_f32_16x16x32_bf16 v[44:47], v[116:119], v[156:159], v[44:47]
    ds_read_b64_tr_b16 v[96:97], v6 offset:8192
    ds_read_b64_tr_b16 v[98:99], v6 offset:8704
    v_mfma_f32_16x16x32_bf16 v[64:67], v[120:123], v[156:159], v[64:67]
    ds_read_b64_tr_b16 v[100:101], v7 offset:8192
    ds_read_b64_tr_b16 v[102:103], v7 offset:8704
    v_mfma_f32_16x16x32_bf16 v[84:87], v[124:127], v[156:159], v[84:87]
    buffer_load_dwordx4 v[156:159], v5, s[16:19], s37 offen offset:2048
    v_mfma_f32_16x16x32_bf16 v[28:31], v[112:115], v[160:163], v[28:31]
    v_mfma_f32_16x16x32_bf16 v[48:51], v[116:119], v[160:163], v[48:51]
    ds_read_b64_tr_b16 v[104:105], v8 offset:8192
    ds_read_b64_tr_b16 v[106:107], v8 offset:8704
    v_mfma_f32_16x16x32_bf16 v[68:71], v[120:123], v[160:163], v[68:71]
    ds_read_b64_tr_b16 v[108:109], v9 offset:8192
    ds_read_b64_tr_b16 v[110:111], v9 offset:8704
    v_mfma_f32_16x16x32_bf16 v[88:91], v[124:127], v[160:163], v[88:91]
    buffer_load_dwordx4 v[160:163], v5, s[16:19], s37 offen offset:3072
    s_add_u32 s37, s37, 4096
    s_waitcnt vmcnt(13)
    v_mfma_f32_16x16x32_bf16 v[32:35], v[112:115], v[164:167], v[32:35]
    v_mfma_f32_16x16x32_bf16 v[52:55], v[116:119], v[164:167], v[52:55]
    v_mfma_f32_16x16x32_bf16 v[72:75], v[120:123], v[164:167], v[72:75]
    v_mfma_f32_16x16x32_bf16 v[92:95], v[124:127], v[164:167], v[92:95]
    buffer_load_dwordx4 v[164:167], v5, s[16:19], s37 offen offset:0
    s_add_u32 s37, s37, 16384
    s_waitcnt vmcnt(8) lgkmcnt(0)
    v_mfma_f32_16x16x32_bf16 v[16:19], v[96:99], v[128:131], v[16:19]
    v_mfma_f32_16x16x32_bf16 v[36:39], v[100:103], v[128:131], v[36:39]
    v_mfma_f32_16x16x32_bf16 v[56:59], v[104:107], v[128:131], v[56:59]
    v_mfma_f32_16x16x32_bf16 v[76:79], v[108:111], v[128:131], v[76:79]
    v_mfma_f32_16x16x32_bf16 v[20:23], v[96:99], v[132:135], v[20:23]
    v_mfma_f32_16x16x32_bf16 v[40:43], v[100:103], v[132:135], v[40:43]
    v_mfma_f32_16x16x32_bf16 v[60:63], v[104:107], v[132:135], v[60:63]
    v_mfma_f32_16x16x32_bf16 v[80:83], v[108:111], v[132:135], v[80:83]
    s_waitcnt vmcnt(6)
    v_mfma_f32_16x16x32_bf16 v[24:27], v[96:99], v[136:139], v[24:27]
    v_mfma_f32_16x16x32_bf16 v[44:47], v[100:103], v[136:139], v[44:47]
    ds_read_b64_tr_b16 v[112:113], v6 offset:0
    ds_read_b64_tr_b16 v[114:115], v6 offset:512
    v_mfma_f32_16x16x32_bf16 v[64:67], v[104:107], v[136:139], v[64:67]
    ds_read_b64_tr_b16 v[116:117], v7 offset:0
    ds_read_b64_tr_b16 v[118:119], v7 offset:512
    v_mfma_f32_16x16x32_bf16 v[84:87], v[108:111], v[136:139], v[84:87]
    v_mfma_f32_16x16x32_bf16 v[28:31], v[96:99], v[140:143], v[28:31]
    v_mfma_f32_16x16x32_bf16 v[48:51], v[100:103], v[140:143], v[48:51]
    ds_read_b64_tr_b16 v[120:121], v8 offset:0
    ds_read_b64_tr_b16 v[122:123], v8 offset:512
    v_mfma_f32_16x16x32_bf16 v[68:71], v[104:107], v[140:143], v[68:71]
    ds_read_b64_tr_b16 v[124:125], v9 offset:0
    ds_read_b64_tr_b16 v[126:127], v9 offset:512
    v_mfma_f32_16x16x32_bf16 v[88:91], v[108:111], v[140:143], v[88:91]
    s_waitcnt vmcnt(5)
    v_mfma_f32_16x16x32_bf16 v[32:35], v[96:99], v[144:147], v[32:35]
    v_mfma_f32_16x16x32_bf16 v[52:55], v[100:103], v[144:147], v[52:55]
    v_mfma_f32_16x16x32_bf16 v[72:75], v[104:107], v[144:147], v[72:75]
    v_mfma_f32_16x16x32_bf16 v[92:95], v[108:111], v[144:147], v[92:95]
    s_setprio 1
    s_lshl_b32 s57, s28, 7
    s_lshl_b32 s58, s34, 5
    s_add_u32 s57, s57, s58
    v_lshrrev_b32 v130, 4, v0
    v_lshlrev_b32 v130, 3, v130
    buffer_load_dwordx2 v[128:129], v130, s[20:23], s57 offen
    s_add_u32 s31, s34, 1
    s_and_b32 s31, s31, 3
    s_mul_i32 s31, s31, 27648
    s_add_u32 s31, s31, 12288
    v_add_u32 v10, s31, v5
    s_add_u32 s31, s34, 2
    s_and_b32 s31, s31, 3
    s_mul_i32 s31, s31, 27648
    s_add_u32 s31, s31, 17408
    v_add_u32 v11, s31, v5
    s_add_u32 s31, s34, 3
    s_and_b32 s31, s31, 3
    s_mul_i32 s31, s31, 27648
    s_add_u32 s31, s31, 22528
    v_add_u32 v12, s31, v5
    s_waitcnt vmcnt(1) lgkmcnt(0)
    v_mfma_f32_16x16x32_bf16 v[36:39], v[116:119], v[148:151], v[36:39]
    v_mfma_f32_16x16x32_bf16 v[40:43], v[116:119], v[152:155], v[40:43]
    v_mfma_f32_16x16x32_bf16 v[44:47], v[116:119], v[156:159], v[44:47]
    v_mfma_f32_16x16x32_bf16 v[48:51], v[116:119], v[160:163], v[48:51]
    v_mfma_f32_16x16x32_bf16 v[52:55], v[116:119], v[164:167], v[52:55]
    v_mfma_f32_16x16x32_bf16 v[56:59], v[120:123], v[148:151], v[56:59]
    s_nop 2
    ds_write_b128 v10, v[36:39] offset:0
    v_mfma_f32_16x16x32_bf16 v[60:63], v[120:123], v[152:155], v[60:63]
    ds_write_b128 v10, v[40:43] offset:1024
    v_mfma_f32_16x16x32_bf16 v[64:67], v[120:123], v[156:159], v[64:67]
    ds_write_b128 v10, v[44:47] offset:2048
    v_mfma_f32_16x16x32_bf16 v[68:71], v[120:123], v[160:163], v[68:71]
    ds_write_b128 v10, v[48:51] offset:3072
    v_mfma_f32_16x16x32_bf16 v[72:75], v[120:123], v[164:167], v[72:75]
    ds_write_b128 v10, v[52:55] offset:4096
    v_mfma_f32_16x16x32_bf16 v[76:79], v[124:127], v[148:151], v[76:79]
    ds_write_b128 v11, v[56:59] offset:0
    v_mfma_f32_16x16x32_bf16 v[80:83], v[124:127], v[152:155], v[80:83]
    ds_write_b128 v11, v[60:63] offset:1024
    v_mfma_f32_16x16x32_bf16 v[84:87], v[124:127], v[156:159], v[84:87]
    ds_write_b128 v11, v[64:67] offset:2048
    v_mfma_f32_16x16x32_bf16 v[88:91], v[124:127], v[160:163], v[88:91]
    ds_write_b128 v11, v[68:71] offset:3072
    v_mfma_f32_16x16x32_bf16 v[92:95], v[124:127], v[164:167], v[92:95]
    ds_write_b128 v11, v[72:75] offset:4096
    v_mfma_f32_16x16x32_bf16 v[16:19], v[112:115], v[148:151], v[16:19]
    ds_write_b128 v12, v[76:79] offset:0
    v_mfma_f32_16x16x32_bf16 v[20:23], v[112:115], v[152:155], v[20:23]
    ds_write_b128 v12, v[80:83] offset:1024
    v_mfma_f32_16x16x32_bf16 v[24:27], v[112:115], v[156:159], v[24:27]
    ds_write_b128 v12, v[84:87] offset:2048
    v_mfma_f32_16x16x32_bf16 v[28:31], v[112:115], v[160:163], v[28:31]
    ds_write_b128 v12, v[88:91] offset:3072
    v_mfma_f32_16x16x32_bf16 v[32:35], v[112:115], v[164:167], v[32:35]
    ds_write_b128 v12, v[92:95] offset:4096
    s_waitcnt lgkmcnt(0)
    s_mov_b64 exec, 1
    v_mov_b32 v10, 1
    ds_add_u32 v15, v10
    s_mov_b64 exec, -1
    s_setprio 1
    s_add_u32 s57, s35, 12288
    v_add_u32 v131, s57, v5
    v_lshrrev_b32 v10, 5, v0
    v_and_b32 v11, 15, v0
    v_lshl_add_u32 v10, v10, 4, v11
    v_bfe_u32 v11, v0, 4, 1
    v_lshlrev_b32 v11, 3, v11
    v_lshl_add_u32 v132, v10, 4, v11
    s_mul_i32 s32, s29, 378880
    s_lshl_b32 s57, s28, 1
    s_lshr_b32 s58, s34, 1
    s_add_u32 s57, s57, s58
    s_mul_i32 s57, s57, 5120
    s_add_u32 s32, s32, s57
    s_and_b32 s58, s34, 1
    s_lshl_b32 s58, s58, 9
    s_add_u32 s32, s32, s58
    s_add_u32 s32, s32, 6291456
    s_add_u32 s62, s32, 4096
    v_mov_b32 v133, 0xc0135761
    s_waitcnt vmcnt(0)
    v_lshlrev_b32 v136, 16, v128
    v_and_b32 v137, 0xffff0000, v128
    v_lshlrev_b32 v138, 16, v129
    v_and_b32 v139, 0xffff0000, v129
    v_add_f32 v16, v16, v136
    v_add_f32 v17, v17, v137
    v_add_f32 v18, v18, v138
    v_add_f32 v19, v19, v139
    v_add_f32 v20, v20, v136
    v_add_f32 v21, v21, v137
    v_add_f32 v22, v22, v138
    v_add_f32 v23, v23, v139
    v_add_f32 v24, v24, v136
    v_add_f32 v25, v25, v137
    v_add_f32 v26, v26, v138
    v_add_f32 v27, v27, v139
    v_add_f32 v28, v28, v136
    v_add_f32 v29, v29, v137
    v_add_f32 v30, v30, v138
    v_add_f32 v31, v31, v139
    v_add_f32 v32, v32, v136
    v_add_f32 v33, v33, v137
    v_add_f32 v34, v34, v138
    v_add_f32 v35, v35, v139
    s_mov_b32 s63, 1048576
K2_spinE:
    ds_read_b32 v11, v15 offset:0
    s_waitcnt lgkmcnt(0)
    v_readfirstlane_b32 s31, v11
    s_nop 0
    s_cmp_ge_u32 s31, 4
    s_cbranch_scc1 K2_spinE_x
    s_sleep 1
    s_sub_u32 s63, s63, 1
    s_cbranch_scc0 K2_spinE
K2_spinE_x:
    ds_read_b128 v[36:39], v131 offset:0
    ds_read_b128 v[56:59], v131 offset:5120
    ds_read_b128 v[76:79], v131 offset:10240
    ds_read_b128 v[40:43], v131 offset:1024
    ds_read_b128 v[60:63], v131 offset:6144
    ds_read_b128 v[80:83], v131 offset:11264
    ds_read_b128 v[44:47], v131 offset:2048
    ds_read_b128 v[64:67], v131 offset:7168
    ds_read_b128 v[84:87], v131 offset:12288
    ds_read_b128 v[48:51], v131 offset:3072
    ds_read_b128 v[68:71], v131 offset:8192
    ds_read_b128 v[88:91], v131 offset:13312
    ds_read_b128 v[52:55], v131 offset:4096
    ds_read_b128 v[72:75], v131 offset:9216
    ds_read_b128 v[92:95], v131 offset:14336
    s_waitcnt lgkmcnt(9)
    v_add_f32 v36, v36, v56
    v_add_f32 v16, v16, v76
    v_add_f32 v37, v37, v57
    v_add_f32 v17, v17, v77
    v_add_f32 v38, v38, v58
    v_add_f32 v18, v18, v78
    v_add_f32 v39, v39, v59
    v_add_f32 v19, v19, v79
    v_add_f32 v16, v16, v36
    v_add_f32 v17, v17, v37
    v_add_f32 v18, v18, v38
    v_add_f32 v19, v19, v39
    v_add_f32 v40, v40, v60
    v_add_f32 v20, v20, v80
    v_add_f32 v41, v41, v61
    v_add_f32 v21, v21, v81
    v_add_f32 v42, v42, v62
    v_add_f32 v22, v22, v82
    v_add_f32 v43, v43, v63
    v_add_f32 v23, v23, v83
    v_add_f32 v20, v20, v40
    v_add_f32 v21, v21, v41
    v_add_f32 v22, v22, v42
    v_add_f32 v23, v23, v43
    v_mul_f32 v96, v16, v16
    v_mul_f32 v97, v17, v17
    v_mul_f32 v98, v18, v18
    v_mul_f32 v99, v19, v19
    v_mul_f32 v100, v20, v20
    v_mul_f32 v101, v21, v21
    v_mul_f32 v102, v22, v22
    v_mul_f32 v103, v23, v23
    v_fmamk_f32 v96, v96, 0xbdd2d3e8, v133
    v_fmamk_f32 v97, v97, 0xbdd2d3e8, v133
    v_fmamk_f32 v98, v98, 0xbdd2d3e8, v133
    v_fmamk_f32 v99, v99, 0xbdd2d3e8, v133
    v_fmamk_f32 v100, v100, 0xbdd2d3e8, v133
    v_fmamk_f32 v101, v101, 0xbdd2d3e8, v133
    v_fmamk_f32 v102, v102, 0xbdd2d3e8, v133
    v_fmamk_f32 v103, v103, 0xbdd2d3e8, v133
    v_mul_f32 v96, v96, v16
    v_mul_f32 v97, v97, v17
    v_mul_f32 v98, v98, v18
    v_mul_f32 v99, v99, v19
    v_mul_f32 v100, v100, v20
    v_mul_f32 v101, v101, v21
    v_mul_f32 v102, v102, v22
    v_mul_f32 v103, v103, v23
    v_exp_f32 v96, v96
    v_exp_f32 v97, v97
    v_exp_f32 v98, v98
    v_exp_f32 v99, v99
    v_exp_f32 v100, v100
    v_exp_f32 v101, v101
    v_exp_f32 v102, v102
    v_exp_f32 v103, v103
    v_add_f32 v96, 1.0, v96
    v_add_f32 v97, 1.0, v97
    v_add_f32 v98, 1.0, v98
    v_add_f32 v99, 1.0, v99
    v_add_f32 v100, 1.0, v100
    v_add_f32 v101, 1.0, v101
    v_add_f32 v102, 1.0, v102
    v_add_f32 v103, 1.0, v103
    v_rcp_f32 v96, v96
    v_rcp_f32 v97, v97
    v_rcp_f32 v98, v98
    v_rcp_f32 v99, v99
    v_rcp_f32 v100, v100
    v_rcp_f32 v101, v101
    v_rcp_f32 v102, v102
    v_rcp_f32 v103, v103
    v_mul_f32 v96, v96, v16
    v_mul_f32 v97, v97, v17
    v_mul_f32 v98, v98, v18
    v_mul_f32 v99, v99, v19
    v_mul_f32 v100, v100, v20
    v_mul_f32 v101, v101, v21
    v_mul_f32 v102, v102, v22
    v_mul_f32 v103, v103, v23
    v_cvt_pk_bf16_f32 v112, v96, v97
    v_cvt_pk_bf16_f32 v113, v98, v99
    buffer_store_dwordx2 v[112:113], v132, s[16:19], s32 offen offset:0 sc1
    v_cvt_pk_bf16_f32 v114, v100, v101
    v_cvt_pk_bf16_f32 v115, v102, v103
    buffer_store_dwordx2 v[114:115], v132, s[16:19], s32 offen offset:1024 sc1
    s_waitcnt lgkmcnt(3)
    v_add_f32 v44, v44, v64
    v_add_f32 v24, v24, v84
    v_add_f32 v45, v45, v65
    v_add_f32 v25, v25, v85
    v_add_f32 v46, v46, v66
    v_add_f32 v26, v26, v86
    v_add_f32 v47, v47, v67
    v_add_f32 v27, v27, v87
    v_add_f32 v24, v24, v44
    v_add_f32 v25, v25, v45
    v_add_f32 v26, v26, v46
    v_add_f32 v27, v27, v47
    v_add_f32 v48, v48, v68
    v_add_f32 v28, v28, v88
    v_add_f32 v49, v49, v69
    v_add_f32 v29, v29, v89
    v_add_f32 v50, v50, v70
    v_add_f32 v30, v30, v90
    v_add_f32 v51, v51, v71
    v_add_f32 v31, v31, v91
    v_add_f32 v28, v28, v48
    v_add_f32 v29, v29, v49
    v_add_f32 v30, v30, v50
    v_add_f32 v31, v31, v51
    v_mul_f32 v96, v24, v24
    v_mul_f32 v97, v25, v25
    v_mul_f32 v98, v26, v26
    v_mul_f32 v99, v27, v27
    v_mul_f32 v100, v28, v28
    v_mul_f32 v101, v29, v29
    v_mul_f32 v102, v30, v30
    v_mul_f32 v103, v31, v31
    v_fmamk_f32 v96, v96, 0xbdd2d3e8, v133
    v_fmamk_f32 v97, v97, 0xbdd2d3e8, v133
    v_fmamk_f32 v98, v98, 0xbdd2d3e8, v133
    v_fmamk_f32 v99, v99, 0xbdd2d3e8, v133
    v_fmamk_f32 v100, v100, 0xbdd2d3e8, v133
    v_fmamk_f32 v101, v101, 0xbdd2d3e8, v133
    v_fmamk_f32 v102, v102, 0xbdd2d3e8, v133
    v_fmamk_f32 v103, v103, 0xbdd2d3e8, v133
    v_mul_f32 v96, v96, v24
    v_mul_f32 v97, v97, v25
    v_mul_f32 v98, v98, v26
    v_mul_f32 v99, v99, v27
    v_mul_f32 v100, v100, v28
    v_mul_f32 v101, v101, v29
    v_mul_f32 v102, v102, v30
    v_mul_f32 v103, v103, v31
    v_exp_f32 v96, v96
    v_exp_f32 v97, v97
    v_exp_f32 v98, v98
    v_exp_f32 v99, v99
    v_exp_f32 v100, v100
    v_exp_f32 v101, v101
    v_exp_f32 v102, v102
    v_exp_f32 v103, v103
    v_add_f32 v96, 1.0, v96
    v_add_f32 v97, 1.0, v97
    v_add_f32 v98, 1.0, v98
    v_add_f32 v99, 1.0, v99
    v_add_f32 v100, 1.0, v100
    v_add_f32 v101, 1.0, v101
    v_add_f32 v102, 1.0, v102
    v_add_f32 v103, 1.0, v103
    v_rcp_f32 v96, v96
    v_rcp_f32 v97, v97
    v_rcp_f32 v98, v98
    v_rcp_f32 v99, v99
    v_rcp_f32 v100, v100
    v_rcp_f32 v101, v101
    v_rcp_f32 v102, v102
    v_rcp_f32 v103, v103
    v_mul_f32 v96, v96, v24
    v_mul_f32 v97, v97, v25
    v_mul_f32 v98, v98, v26
    v_mul_f32 v99, v99, v27
    v_mul_f32 v100, v100, v28
    v_mul_f32 v101, v101, v29
    v_mul_f32 v102, v102, v30
    v_mul_f32 v103, v103, v31
    v_cvt_pk_bf16_f32 v116, v96, v97
    v_cvt_pk_bf16_f32 v117, v98, v99
    buffer_store_dwordx2 v[116:117], v132, s[16:19], s32 offen offset:2048 sc1
    v_cvt_pk_bf16_f32 v118, v100, v101
    v_cvt_pk_bf16_f32 v119, v102, v103
    buffer_store_dwordx2 v[118:119], v132, s[16:19], s32 offen offset:3072 sc1
    s_waitcnt lgkmcnt(0)
    v_add_f32 v52, v52, v72
    v_add_f32 v32, v32, v92
    v_add_f32 v53, v53, v73
    v_add_f32 v33, v33, v93
    v_add_f32 v54, v54, v74
    v_add_f32 v34, v34, v94
    v_add_f32 v55, v55, v75
    v_add_f32 v35, v35, v95
    v_add_f32 v32, v32, v52
    v_add_f32 v33, v33, v53
    v_add_f32 v34, v34, v54
    v_add_f32 v35, v35, v55
    v_mul_f32 v96, v32, v32
    v_mul_f32 v97, v33, v33
    v_mul_f32 v98, v34, v34
    v_mul_f32 v99, v35, v35
    v_fmamk_f32 v96, v96, 0xbdd2d3e8, v133
    v_fmamk_f32 v97, v97, 0xbdd2d3e8, v133
    v_fmamk_f32 v98, v98, 0xbdd2d3e8, v133
    v_fmamk_f32 v99, v99, 0xbdd2d3e8, v133
    v_mul_f32 v96, v96, v32
    v_mul_f32 v97, v97, v33
    v_mul_f32 v98, v98, v34
    v_mul_f32 v99, v99, v35
    v_exp_f32 v96, v96
    v_exp_f32 v97, v97
    v_exp_f32 v98, v98
    v_exp_f32 v99, v99
    v_add_f32 v96, 1.0, v96
    v_add_f32 v97, 1.0, v97
    v_add_f32 v98, 1.0, v98
    v_add_f32 v99, 1.0, v99
    v_rcp_f32 v96, v96
    v_rcp_f32 v97, v97
    v_rcp_f32 v98, v98
    v_rcp_f32 v99, v99
    v_mul_f32 v96, v96, v32
    v_mul_f32 v97, v97, v33
    v_mul_f32 v98, v98, v34
    v_mul_f32 v99, v99, v35
    v_cvt_pk_bf16_f32 v120, v96, v97
    v_cvt_pk_bf16_f32 v121, v98, v99
    buffer_store_dwordx2 v[120:121], v132, s[16:19], s62 offen offset:0 sc1
    s_waitcnt vmcnt(0) lgkmcnt(0)
    s_mov_b64 exec, 1
    v_mov_b32 v10, 1
    ds_add_u32 v15, v10
    s_mov_b64 exec, -1
    s_lshl_b32 s31, s34, 5
    v_xor_b32 v6, s31, v6
    v_xor_b32 v7, 32, v6
    v_xor_b32 v8, 64, v6
    v_xor_b32 v9, 96, v6
    s_lshl_b32 s57, s29, 5
    s_add_u32 s57, s57, s28
    s_lshl_b32 s57, s57, 2
    s_add_u32 s57, s57, 12062720
K2_merge:
    s_mov_b32 s63, 1048576
K2_pubU:
    ds_read_b32 v11, v15 offset:0
    s_waitcnt lgkmcnt(0)
    v_readfirstlane_b32 s31, v11
    s_nop 0
    s_cmp_ge_u32 s31, 8
    s_cbranch_scc1 K2_pubU_x
    s_sleep 1
    s_sub_u32 s63, s63, 1
    s_cbranch_scc0 K2_pubU
K2_pubU_x:
    s_cmp_lg_u32 s34, 0
    s_cbranch_scc1 K2_pubU_np
    s_mov_b64 exec, 255
    v_mov_b32 v10, 1
    v_lshl_add_u32 v11, v0, 10, s57
    buffer_store_dword v10, v11, s[16:19], 0 offen sc1
    s_mov_b64 exec, -1
K2_pubU_np:
K2_merge2:
    s_mov_b32 s12, s68
    s_mov_b32 s13, s69
    s_mov_b32 s14, 7077888
    s_mov_b32 s15, 0x20000
    s_lshl_b32 s32, s26, 7
    v_lshrrev_b32 v10, 3, v0
    v_and_b32 v11, 7, v0
    v_bfe_u32 v12, v10, 1, 1
    v_lshlrev_b32 v12, 2, v12
    v_xor_b32 v11, v11, v12
    v_mul_u32_u24 v10, 4096, v10
    v_lshl_add_u32 v10, v11, 4, v10
    v_add_u32 v1, s32, v10
    v_xor_b32 v2, 32, v1
    v_add_u32 v2, 31744, v2
    v_add_u32 v3, 63488, v1
    v_add_u32 v4, 63488, v2
    s_lshl_b32 s36, s34, 17
    s_mul_i32 s37, s27, 74
    s_add_u32 s37, s37, s34
    s_mul_i32 s37, s37, 5120
    s_add_u32 s37, s37, 6291456
    s_setprio 0
    s_add_u32 m0, s35, 4096
    s_nop 0
    buffer_load_dwordx4 v1, s[12:15], s36 offen offset:0  lds
    buffer_load_dwordx4 v2, s[12:15], s36 offen offset:1024  lds
    buffer_load_dwordx4 v3, s[12:15], s36 offen offset:2048  lds
    buffer_load_dwordx4 v4, s[12:15], s36 offen offset:3072  lds
    s_add_u32 s36, s36, 524288
    s_add_u32 m0, s35, 8192
    s_nop 0
    buffer_load_dwordx4 v1, s[12:15], s36 offen offset:0  lds
    buffer_load_dwordx4 v2, s[12:15], s36 offen offset:1024  lds
    buffer_load_dwordx4 v3, s[12:15], s36 offen offset:2048  lds
    buffer_load_dwordx4 v4, s[12:15], s36 offen offset:3072  lds
    s_add_u32 s36, s36, 524288
    s_add_u32 m0, s35, 0
    s_nop 0
    buffer_load_dwordx4 v1, s[12:15], s36 offen offset:0  lds
    buffer_load_dwordx4 v2, s[12:15], s36 offen offset:1024  lds
    buffer_load_dwordx4 v3, s[12:15], s36 offen offset:2048  lds
    buffer_load_dwordx4 v4, s[12:15], s36 offen offset:3072  lds
    s_add_u32 s36, s36, 524288
    s_lshl_b32 s57, s27, 7
    s_lshl_b32 s58, s24, 10
    s_add_u32 s57, s57, s58
    s_add_u32 s57, s57, 12062720
    s_cmp_lg_u32 s34, 0
    s_cbranch_scc1 K2_pollU_w
    v_and_b32 v10, 31, v0
    v_lshl_add_u32 v10, v10, 2, s57
    s_mov_b32 s63, 0x40000
K2_pollU:
    buffer_load_dword v16, v10, s[16:19], 0 offen sc1
    s_waitcnt vmcnt(0)
    v_cmp_ne_u32 vcc, 1, v16
    s_cbranch_vccz K2_pollU_ok
    s_sleep 4
    s_sub_u32 s63, s63, 1
    s_cbranch_scc0 K2_pollU
K2_pollU_ok:
    s_waitcnt vmcnt(0)
    v_mov_b32 v11, 1
    ds_write_b32 v15, v11 offset:8
K2_pollU_w:
    v_add_u32 v12, 8, v15
    s_mov_b32 s63, 1048576
K2_pollU_l:
    ds_read_b32 v11, v12 offset:0
    s_waitcnt lgkmcnt(0)
    v_readfirstlane_b32 s31, v11
    s_nop 0
    s_cmp_ge_u32 s31, 1
    s_cbranch_scc1 K2_pollU_l_x
    s_sleep 1
    s_sub_u32 s63, s63, 1
    s_cbranch_scc0 K2_pollU_l
K2_pollU_l_x:
    s_setprio 1
    buffer_load_dwordx4 v[128:131], v5, s[16:19], s37 offen offset:0
    buffer_load_dwordx4 v[132:135], v5, s[16:19], s37 offen offset:1024
    buffer_load_dwordx4 v[136:139], v5, s[16:19], s37 offen offset:2048
    buffer_load_dwordx4 v[140:143], v5, s[16:19], s37 offen offset:3072
    s_add_u32 s37, s37, 4096
    buffer_load_dwordx4 v[144:147], v5, s[16:19], s37 offen offset:0
    s_add_u32 s37, s37, 16384
    buffer_load_dwordx4 v[148:151], v5, s[16:19], s37 offen offset:0
    buffer_load_dwordx4 v[152:155], v5, s[16:19], s37 offen offset:1024
    buffer_load_dwordx4 v[156:159], v5, s[16:19], s37 offen offset:2048
    buffer_load_dwordx4 v[160:163], v5, s[16:19], s37 offen offset:3072
    s_add_u32 s37, s37, 4096
    buffer_load_dwordx4 v[164:167], v5, s[16:19], s37 offen offset:0
    s_add_u32 s37, s37, 16384
    s_waitcnt vmcnt(18)
    ds_read_b64_tr_b16 v[96:97], v6 offset:4096
    ds_read_b64_tr_b16 v[98:99], v6 offset:4608
    ds_read_b64_tr_b16 v[100:101], v7 offset:4096
    ds_read_b64_tr_b16 v[102:103], v7 offset:4608
    ds_read_b64_tr_b16 v[104:105], v8 offset:4096
    ds_read_b64_tr_b16 v[106:107], v8 offset:4608
    ds_read_b64_tr_b16 v[108:109], v9 offset:4096
    ds_read_b64_tr_b16 v[110:111], v9 offset:4608
    s_setprio 0
    s_waitcnt vmcnt(8) lgkmcnt(0)
    v_mfma_f32_16x16x32_bf16 v[16:19], v[128:131], v[96:99], 0
    s_add_u32 m0, s35, 4096
    v_mfma_f32_16x16x32_bf16 v[36:39], v[128:131], v[100:103], 0
    buffer_load_dwordx4 v1, s[12:15], s36 offen offset:0  lds
    v_mfma_f32_16x16x32_bf16 v[56:59], v[128:131], v[104:107], 0
    buffer_load_dwordx4 v2, s[12:15], s36 offen offset:1024  lds
    v_mfma_f32_16x16x32_bf16 v[76:79], v[128:131], v[108:111], 0
    buffer_load_dwordx4 v[128:131], v5, s[16:19], s37 offen offset:0
    v_mfma_f32_16x16x32_bf16 v[20:23], v[132:135], v[96:99], 0
    buffer_load_dwordx4 v3, s[12:15], s36 offen offset:2048  lds
    v_mfma_f32_16x16x32_bf16 v[40:43], v[132:135], v[100:103], 0
    buffer_load_dwordx4 v4, s[12:15], s36 offen offset:3072  lds
    v_mfma_f32_16x16x32_bf16 v[60:63], v[132:135], v[104:107], 0
    s_add_u32 s36, s36, 524288
    v_mfma_f32_16x16x32_bf16 v[80:83], v[132:135], v[108:111], 0
    buffer_load_dwordx4 v[132:135], v5, s[16:19], s37 offen offset:1024
    s_waitcnt vmcnt(12)
    v_mfma_f32_16x16x32_bf16 v[24:27], v[136:139], v[96:99], 0
    v_mfma_f32_16x16x32_bf16 v[44:47], v[136:139], v[100:103], 0
    ds_read_b64_tr_b16 v[112:113], v6 offset:8192
    ds_read_b64_tr_b16 v[114:115], v6 offset:8704
    v_mfma_f32_16x16x32_bf16 v[64:67], v[136:139], v[104:107], 0
    ds_read_b64_tr_b16 v[116:117], v7 offset:8192
    ds_read_b64_tr_b16 v[118:119], v7 offset:8704
    v_mfma_f32_16x16x32_bf16 v[84:87], v[136:139], v[108:111], 0
    buffer_load_dwordx4 v[136:139], v5, s[16:19], s37 offen offset:2048
    v_mfma_f32_16x16x32_bf16 v[28:31], v[140:143], v[96:99], 0
    v_mfma_f32_16x16x32_bf16 v[48:51], v[140:143], v[100:103], 0
    ds_read_b64_tr_b16 v[120:121], v8 offset:8192
    ds_read_b64_tr_b16 v[122:123], v8 offset:8704
    v_mfma_f32_16x16x32_bf16 v[68:71], v[140:143], v[104:107], 0
    ds_read_b64_tr_b16 v[124:125], v9 offset:8192
    ds_read_b64_tr_b16 v[126:127], v9 offset:8704
    v_mfma_f32_16x16x32_bf16 v[88:91], v[140:143], v[108:111], 0
    buffer_load_dwordx4 v[140:143], v5, s[16:19], s37 offen offset:3072
    s_add_u32 s37, s37, 4096
    s_waitcnt vmcnt(13)
    v_mfma_f32_16x16x32_bf16 v[32:35], v[144:147], v[96:99], 0
    v_mfma_f32_16x16x32_bf16 v[52:55], v[144:147], v[100:103], 0
    v_mfma_f32_16x16x32_bf16 v[72:75], v[144:147], v[104:107], 0
    v_mfma_f32_16x16x32_bf16 v[92:95], v[144:147], v[108:111], 0
    buffer_load_dwordx4 v[144:147], v5, s[16:19], s37 offen offset:0
    s_add_u32 s37, s37, 16384
    s_waitcnt vmcnt(12) lgkmcnt(0)
    v_mfma_f32_16x16x32_bf16 v[16:19], v[148:151], v[112:115], v[16:19]
    s_add_u32 m0, s35, 8192
    v_mfma_f32_16x16x32_bf16 v[36:39], v[148:151], v[116:119], v[36:39]
    buffer_load_dwordx4 v1, s[12:15], s36 offen offset:0  lds
    v_mfma_f32_16x16x32_bf16 v[56:59], v[148:151], v[120:123], v[56:59]
    buffer_load_dwordx4 v2, s[12:15], s36 offen offset:1024  lds
    v_mfma_f32_16x16x32_bf16 v[76:79], v[148:151], v[124:127], v[76:79]
    buffer_load_dwordx4 v[148:151], v5, s[16:19], s37 offen offset:0
    v_mfma_f32_16x16x32_bf16 v[20:23], v[152:155], v[112:115], v[20:23]
    buffer_load_dwordx4 v3, s[12:15], s36 offen offset:2048  lds
    v_mfma_f32_16x16x32_bf16 v[40:43], v[152:155], v[116:119], v[40:43]
    buffer_load_dwordx4 v4, s[12:15], s36 offen offset:3072  lds
    v_mfma_f32_16x16x32_bf16 v[60:63], v[152:155], v[120:123], v[60:63]
    s_add_u32 s36, s36, 524288
    v_mfma_f32_16x16x32_bf16 v[80:83], v[152:155], v[124:127], v[80:83]
    buffer_load_dwordx4 v[152:155], v5, s[16:19], s37 offen offset:1024
    s_waitcnt vmcnt(16)
    v_mfma_f32_16x16x32_bf16 v[24:27], v[156:159], v[112:115], v[24:27]
    v_mfma_f32_16x16x32_bf16 v[44:47], v[156:159], v[116:119], v[44:47]
    ds_read_b64_tr_b16 v[96:97], v6 offset:0
    ds_read_b64_tr_b16 v[98:99], v6 offset:512
    v_mfma_f32_16x16x32_bf16 v[64:67], v[156:159], v[120:123], v[64:67]
    ds_read_b64_tr_b16 v[100:101], v7 offset:0
    ds_read_b64_tr_b16 v[102:103], v7 offset:512
    v_mfma_f32_16x16x32_bf16 v[84:87], v[156:159], v[124:127], v[84:87]
    buffer_load_dwordx4 v[156:159], v5, s[16:19], s37 offen offset:2048
    v_mfma_f32_16x16x32_bf16 v[28:31], v[160:163], v[112:115], v[28:31]
    v_mfma_f32_16x16x32_bf16 v[48:51], v[160:163], v[116:119], v[48:51]
    ds_read_b64_tr_b16 v[104:105], v8 offset:0
    ds_read_b64_tr_b16 v[106:107], v8 offset:512
    v_mfma_f32_16x16x32_bf16 v[68:71], v[160:163], v[120:123], v[68:71]
    ds_read_b64_tr_b16 v[108:109], v9 offset:0
    ds_read_b64_tr_b16 v[110:111], v9 offset:512
    v_mfma_f32_16x16x32_bf16 v[88:91], v[160:163], v[124:127], v[88:91]
    buffer_load_dwordx4 v[160:163], v5, s[16:19], s37 offen offset:3072
    s_add_u32 s37, s37, 4096
    s_waitcnt vmcnt(17)
    v_mfma_f32_16x16x32_bf16 v[32:35], v[164:167], v[112:115], v[32:35]
    v_mfma_f32_16x16x32_bf16 v[52:55], v[164:167], v[116:119], v[52:55]
    v_mfma_f32_16x16x32_bf16 v[72:75], v[164:167], v[120:123], v[72:75]
    v_mfma_f32_16x16x32_bf16 v[92:95], v[164:167], v[124:127], v[92:95]
    buffer_load_dwordx4 v[164:167], v5, s[16:19], s37 offen offset:0
    s_add_u32 s37, s37, 16384
    s_waitcnt vmcnt(12) lgkmcnt(0)
    v_mfma_f32_16x16x32_bf16 v[16:19], v[128:131], v[96:99], v[16:19]
    s_add_u32 m0, s35, 0
    v_mfma_f32_16x16x32_bf16 v[36:39], v[128:131], v[100:103], v[36:39]
    buffer_load_dwordx4 v1, s[12:15], s36 offen offset:0  lds
    v_mfma_f32_16x16x32_bf16 v[56:59], v[128:131], v[104:107], v[56:59]
    buffer_load_dwordx4 v2, s[12:15], s36 offen offset:1024  lds
    v_mfma_f32_16x16x32_bf16 v[76:79], v[128:131], v[108:111], v[76:79]
    buffer_load_dwordx4 v[128:131], v5, s[16:19], s37 offen offset:0
    v_mfma_f32_16x16x32_bf16 v[20:23], v[132:135], v[96:99], v[20:23]
    buffer_load_dwordx4 v3, s[12:15], s36 offen offset:2048  lds
    v_mfma_f32_16x16x32_bf16 v[40:43], v[132:135], v[100:103], v[40:43]
    buffer_load_dwordx4 v4, s[12:15], s36 offen offset:3072  lds
    v_mfma_f32_16x16x32_bf16 v[60:63], v[132:135], v[104:107], v[60:63]
    s_add_u32 s36, s36, 524288
    v_mfma_f32_16x16x32_bf16 v[80:83], v[132:135], v[108:111], v[80:83]
    buffer_load_dwordx4 v[132:135], v5, s[16:19], s37 offen offset:1024
    s_waitcnt vmcnt(16)
    v_mfma_f32_16x16x32_bf16 v[24:27], v[136:139], v[96:99], v[24:27]
    v_mfma_f32_16x16x32_bf16 v[44:47], v[136:139], v[100:103], v[44:47]
    ds_read_b64_tr_b16 v[112:113], v6 offset:4096
    ds_read_b64_tr_b16 v[114:115], v6 offset:4608
    v_mfma_f32_16x16x32_bf16 v[64:67], v[136:139], v[104:107], v[64:67]
    ds_read_b64_tr_b16 v[116:117], v7 offset:4096
    ds_read_b64_tr_b16 v[118:119], v7 offset:4608
    v_mfma_f32_16x16x32_bf16 v[84:87], v[136:139], v[108:111], v[84:87]
    buffer_load_dwordx4 v[136:139], v5, s[16:19], s37 offen offset:2048
    v_mfma_f32_16x16x32_bf16 v[28:31], v[140:143], v[96:99], v[28:31]
    v_mfma_f32_16x16x32_bf16 v[48:51], v[140:143], v[100:103], v[48:51]
    ds_read_b64_tr_b16 v[120:121], v8 offset:4096
    ds_read_b64_tr_b16 v[122:123], v8 offset:4608
    v_mfma_f32_16x16x32_bf16 v[68:71], v[140:143], v[104:107], v[68:71]
    ds_read_b64_tr_b16 v[124:125], v9 offset:4096
    ds_read_b64_tr_b16 v[126:127], v9 offset:4608
    v_mfma_f32_16x16x32_bf16 v[88:91], v[140:143], v[108:111], v[88:91]
    buffer_load_dwordx4 v[140:143], v5, s[16:19], s37 offen offset:3072
    s_add_u32 s37, s37, 4096
    s_waitcnt vmcnt(17)
    v_mfma_f32_16x16x32_bf16 v[32:35], v[144:147], v[96:99], v[32:35]
    v_mfma_f32_16x16x32_bf16 v[52:55], v[144:147], v[100:103], v[52:55]
    v_mfma_f32_16x16x32_bf16 v[72:75], v[144:147], v[104:107], v[72:75]
    v_mfma_f32_16x16x32_bf16 v[92:95], v[144:147], v[108:111], v[92:95]
    buffer_load_dwordx4 v[144:147], v5, s[16:19], s37 offen offset:0
    s_add_u32 s37, s37, 16384
    s_waitcnt vmcnt(12) lgkmcnt(0)
    v_mfma_f32_16x16x32_bf16 v[16:19], v[148:151], v[112:115], v[16:19]
    s_add_u32 m0, s35, 4096
    v_mfma_f32_16x16x32_bf16 v[36:39], v[148:151], v[116:119], v[36:39]
    buffer_load_dwordx4 v1, s[12:15], s36 offen offset:0  lds
    v_mfma_f32_16x16x32_bf16 v[56:59], v[148:151], v[120:123], v[56:59]
    buffer_load_dwordx4 v2, s[12:15], s36 offen offset:1024  lds
    v_mfma_f32_16x16x32_bf16 v[76:79], v[148:151], v[124:127], v[76:79]
    buffer_load_dwordx4 v[148:151], v5, s[16:19], s37 offen offset:0
    v_mfma_f32_16x16x32_bf16 v[20:23], v[152:155], v[112:115], v[20:23]
    buffer_load_dwordx4 v3, s[12:15], s36 offen offset:2048  lds
    v_mfma_f32_16x16x32_bf16 v[40:43], v[152:155], v[116:119], v[40:43]
    buffer_load_dwordx4 v4, s[12:15], s36 offen offset:3072  lds
    v_mfma_f32_16x16x32_bf16 v[60:63], v[152:155], v[120:123], v[60:63]
    s_add_u32 s36, s36, 524288
    v_mfma_f32_16x16x32_bf16 v[80:83], v[152:155], v[124:127], v[80:83]
    buffer_load_dwordx4 v[152:155], v5, s[16:19], s37 offen offset:1024
    s_waitcnt vmcnt(16)
    v_mfma_f32_16x16x32_bf16 v[24:27], v[156:159], v[112:115], v[24:27]
    v_mfma_f32_16x16x32_bf16 v[44:47], v[156:159], v[116:119], v[44:47]
    ds_read_b64_tr_b16 v[96:97], v6 offset:8192
    ds_read_b64_tr_b16 v[98:99], v6 offset:8704
    v_mfma_f32_16x16x32_bf16 v[64:67], v[156:159], v[120:123], v[64:67]
    ds_read_b64_tr_b16 v[100:101], v7 offset:8192
    ds_read_b64_tr_b16 v[102:103], v7 offset:8704
    v_mfma_f32_16x16x32_bf16 v[84:87], v[156:159], v[124:127], v[84:87]
    buffer_load_dwordx4 v[156:159], v5, s[16:19], s37 offen offset:2048
    v_mfma_f32_16x16x32_bf16 v[28:31], v[160:163], v[112:115], v[28:31]
    v_mfma_f32_16x16x32_bf16 v[48:51], v[160:163], v[116:119], v[48:51]
    ds_read_b64_tr_b16 v[104:105], v8 offset:8192
    ds_read_b64_tr_b16 v[106:107], v8 offset:8704
    v_mfma_f32_16x16x32_bf16 v[68:71], v[160:163], v[120:123], v[68:71]
    ds_read_b64_tr_b16 v[108:109], v9 offset:8192
    ds_read_b64_tr_b16 v[110:111], v9 offset:8704
    v_mfma_f32_16x16x32_bf16 v[88:91], v[160:163], v[124:127], v[88:91]
    buffer_load_dwordx4 v[160:163], v5, s[16:19], s37 offen offset:3072
    s_add_u32 s37, s37, 4096
    s_waitcnt vmcnt(17)
    v_mfma_f32_16x16x32_bf16 v[32:35], v[164:167], v[112:115], v[32:35]
    v_mfma_f32_16x16x32_bf16 v[52:55], v[164:167], v[116:119], v[52:55]
    v_mfma_f32_16x16x32_bf16 v[72:75], v[164:167], v[120:123], v[72:75]
    v_mfma_f32_16x16x32_bf16 v[92:95], v[164:167], v[124:127], v[92:95]
    buffer_load_dwordx4 v[164:167], v5, s[16:19], s37 offen offset:0
    s_add_u32 s37, s37, 16384
    s_waitcnt vmcnt(12) lgkmcnt(0)
    v_mfma_f32_16x16x32_bf16 v[16:19], v[128:131], v[96:99], v[16:19]
    s_add_u32 m0, s35, 8192
    v_mfma_f32_16x16x32_bf16 v[36:39], v[128:131], v[100:103], v[36:39]
    buffer_load_dwordx4 v1, s[12:15], s36 offen offset:0  lds
    v_mfma_f32_16x16x32_bf16 v[56:59], v[128:131], v[104:107], v[56:59]
    buffer_load_dwordx4 v2, s[12:15], s36 offen offset:1024  lds
    v_mfma_f32_16x16x32_bf16 v[76:79], v[128:131], v[108:111], v[76:79]
    buffer_load_dwordx4 v[128:131], v5, s[16:19], s37 offen offset:0
    v_mfma_f32_16x16x32_bf16 v[20:23], v[132:135], v[96:99], v[20:23]
    buffer_load_dwordx4 v3, s[12:15], s36 offen offset:2048  lds
    v_mfma_f32_16x16x32_bf16 v[40:43], v[132:135], v[100:103], v[40:43]
    buffer_load_dwordx4 v4, s[12:15], s36 offen offset:3072  lds
    v_mfma_f32_16x16x32_bf16 v[60:63], v[132:135], v[104:107], v[60:63]
    s_add_u32 s36, s36, 524288
    v_mfma_f32_16x16x32_bf16 v[80:83], v[132:135], v[108:111], v[80:83]
    buffer_load_dwordx4 v[132:135], v5, s[16:19], s37 offen offset:1024
    s_waitcnt vmcnt(16)
    v_mfma_f32_16x16x32_bf16 v[24:27], v[136:139], v[96:99], v[24:27]
    v_mfma_f32_16x16x32_bf16 v[44:47], v[136:139], v[100:103], v[44:47]
    ds_read_b64_tr_b16 v[112:113], v6 offset:0
    ds_read_b64_tr_b16 v[114:115], v6 offset:512
    v_mfma_f32_16x16x32_bf16 v[64:67], v[136:139], v[104:107], v[64:67]
    ds_read_b64_tr_b16 v[116:117], v7 offset:0
    ds_read_b64_tr_b16 v[118:119], v7 offset:512
    v_mfma_f32_16x16x32_bf16 v[84:87], v[136:139], v[108:111], v[84:87]
    buffer_load_dwordx4 v[136:139], v5, s[16:19], s37 offen offset:2048
    v_mfma_f32_16x16x32_bf16 v[28:31], v[140:143], v[96:99], v[28:31]
    v_mfma_f32_16x16x32_bf16 v[48:51], v[140:143], v[100:103], v[48:51]
    ds_read_b64_tr_b16 v[120:121], v8 offset:0
    ds_read_b64_tr_b16 v[122:123], v8 offset:512
    v_mfma_f32_16x16x32_bf16 v[68:71], v[140:143], v[104:107], v[68:71]
    ds_read_b64_tr_b16 v[124:125], v9 offset:0
    ds_read_b64_tr_b16 v[126:127], v9 offset:512
    v_mfma_f32_16x16x32_bf16 v[88:91], v[140:143], v[108:111], v[88:91]
    buffer_load_dwordx4 v[140:143], v5, s[16:19], s37 offen offset:3072
    s_add_u32 s37, s37, 4096
    s_waitcnt vmcnt(17)
    v_mfma_f32_16x16x32_bf16 v[32:35], v[144:147], v[96:99], v[32:35]
    v_mfma_f32_16x16x32_bf16 v[52:55], v[144:147], v[100:103], v[52:55]
    v_mfma_f32_16x16x32_bf16 v[72:75], v[144:147], v[104:107], v[72:75]
    v_mfma_f32_16x16x32_bf16 v[92:95], v[144:147], v[108:111], v[92:95]
    buffer_load_dwordx4 v[144:147], v5, s[16:19], s37 offen offset:0
    s_add_u32 s37, s37, 16384
    s_waitcnt vmcnt(12) lgkmcnt(0)
    v_mfma_f32_16x16x32_bf16 v[16:19], v[148:151], v[112:115], v[16:19]
    s_add_u32 m0, s35, 0
    v_mfma_f32_16x16x32_bf16 v[36:39], v[148:151], v[116:119], v[36:39]
    buffer_load_dwordx4 v1, s[12:15], s36 offen offset:0  lds
    v_mfma_f32_16x16x32_bf16 v[56:59], v[148:151], v[120:123], v[56:59]
    buffer_load_dwordx4 v2, s[12:15], s36 offen offset:1024  lds
    v_mfma_f32_16x16x32_bf16 v[76:79], v[148:151], v[124:127], v[76:79]
    buffer_load_dwordx4 v[148:151], v5, s[16:19], s37 offen offset:0
    v_mfma_f32_16x16x32_bf16 v[20:23], v[152:155], v[112:115], v[20:23]
    buffer_load_dwordx4 v3, s[12:15], s36 offen offset:2048  lds
    v_mfma_f32_16x16x32_bf16 v[40:43], v[152:155], v[116:119], v[40:43]
    buffer_load_dwordx4 v4, s[12:15], s36 offen offset:3072  lds
    v_mfma_f32_16x16x32_bf16 v[60:63], v[152:155], v[120:123], v[60:63]
    s_add_u32 s36, s36, 524288
    v_mfma_f32_16x16x32_bf16 v[80:83], v[152:155], v[124:127], v[80:83]
    buffer_load_dwordx4 v[152:155], v5, s[16:19], s37 offen offset:1024
    s_waitcnt vmcnt(16)
    v_mfma_f32_16x16x32_bf16 v[24:27], v[156:159], v[112:115], v[24:27]
    v_mfma_f32_16x16x32_bf16 v[44:47], v[156:159], v[116:119], v[44:47]
    ds_read_b64_tr_b16 v[96:97], v6 offset:4096
    ds_read_b64_tr_b16 v[98:99], v6 offset:4608
    v_mfma_f32_16x16x32_bf16 v[64:67], v[156:159], v[120:123], v[64:67]
    ds_read_b64_tr_b16 v[100:101], v7 offset:4096
    ds_read_b64_tr_b16 v[102:103], v7 offset:4608
    v_mfma_f32_16x16x32_bf16 v[84:87], v[156:159], v[124:127], v[84:87]
    buffer_load_dwordx4 v[156:159], v5, s[16:19], s37 offen offset:2048
    v_mfma_f32_16x16x32_bf16 v[28:31], v[160:163], v[112:115], v[28:31]
    v_mfma_f32_16x16x32_bf16 v[48:51], v[160:163], v[116:119], v[48:51]
    ds_read_b64_tr_b16 v[104:105], v8 offset:4096
    ds_read_b64_tr_b16 v[106:107], v8 offset:4608
    v_mfma_f32_16x16x32_bf16 v[68:71], v[160:163], v[120:123], v[68:71]
    ds_read_b64_tr_b16 v[108:109], v9 offset:4096
    ds_read_b64_tr_b16 v[110:111], v9 offset:4608
    v_mfma_f32_16x16x32_bf16 v[88:91], v[160:163], v[124:127], v[88:91]
    buffer_load_dwordx4 v[160:163], v5, s[16:19], s37 offen offset:3072
    s_add_u32 s37, s37, 4096
    s_waitcnt vmcnt(17)
    v_mfma_f32_16x16x32_bf16 v[32:35], v[164:167], v[112:115], v[32:35]
    v_mfma_f32_16x16x32_bf16 v[52:55], v[164:167], v[116:119], v[52:55]
    v_mfma_f32_16x16x32_bf16 v[72:75], v[164:167], v[120:123], v[72:75]
    v_mfma_f32_16x16x32_bf16 v[92:95], v[164:167], v[124:127], v[92:95]
    buffer_load_dwordx4 v[164:167], v5, s[16:19], s37 offen offset:0
    s_add_u32 s37, s37, 16384
    s_waitcnt vmcnt(12) lgkmcnt(0)
    v_mfma_f32_16x16x32_bf16 v[16:19], v[128:131], v[96:99], v[16:19]
    s_add_u32 m0, s35, 4096
    v_mfma_f32_16x16x32_bf16 v[36:39], v[128:131], v[100:103], v[36:39]
    buffer_load_dwordx4 v1, s[12:15], s36 offen offset:0  lds
    v_mfma_f32_16x16x32_bf16 v[56:59], v[128:131], v[104:107], v[56:59]
    buffer_load_dwordx4 v2, s[12:15], s36 offen offset:1024  lds
    v_mfma_f32_16x16x32_bf16 v[76:79], v[128:131], v[108:111], v[76:79]
    buffer_load_dwordx4 v[128:131], v5, s[16:19], s37 offen offset:0
    v_mfma_f32_16x16x32_bf16 v[20:23], v[132:135], v[96:99], v[20:23]
    buffer_load_dwordx4 v3, s[12:15], s36 offen offset:2048  lds
    v_mfma_f32_16x16x32_bf16 v[40:43], v[132:135], v[100:103], v[40:43]
    buffer_load_dwordx4 v4, s[12:15], s36 offen offset:3072  lds
    v_mfma_f32_16x16x32_bf16 v[60:63], v[132:135], v[104:107], v[60:63]
    s_add_u32 s36, s36, 524288
    v_mfma_f32_16x16x32_bf16 v[80:83], v[132:135], v[108:111], v[80:83]
    buffer_load_dwordx4 v[132:135], v5, s[16:19], s37 offen offset:1024
    s_waitcnt vmcnt(16)
    v_mfma_f32_16x16x32_bf16 v[24:27], v[136:139], v[96:99], v[24:27]
    v_mfma_f32_16x16x32_bf16 v[44:47], v[136:139], v[100:103], v[44:47]
    ds_read_b64_tr_b16 v[112:113], v6 offset:8192
    ds_read_b64_tr_b16 v[114:115], v6 offset:8704
    v_mfma_f32_16x16x32_bf16 v[64:67], v[136:139], v[104:107], v[64:67]
    ds_read_b64_tr_b16 v[116:117], v7 offset:8192
    ds_read_b64_tr_b16 v[118:119], v7 offset:8704
    v_mfma_f32_16x16x32_bf16 v[84:87], v[136:139], v[108:111], v[84:87]
    buffer_load_dwordx4 v[136:139], v5, s[16:19], s37 offen offset:2048
    v_mfma_f32_16x16x32_bf16 v[28:31], v[140:143], v[96:99], v[28:31]
    v_mfma_f32_16x16x32_bf16 v[48:51], v[140:143], v[100:103], v[48:51]
    ds_read_b64_tr_b16 v[120:121], v8 offset:8192
    ds_read_b64_tr_b16 v[122:123], v8 offset:8704
    v_mfma_f32_16x16x32_bf16 v[68:71], v[140:143], v[104:107], v[68:71]
    ds_read_b64_tr_b16 v[124:125], v9 offset:8192
    ds_read_b64_tr_b16 v[126:127], v9 offset:8704
    v_mfma_f32_16x16x32_bf16 v[88:91], v[140:143], v[108:111], v[88:91]
    buffer_load_dwordx4 v[140:143], v5, s[16:19], s37 offen offset:3072
    s_add_u32 s37, s37, 4096
    s_waitcnt vmcnt(17)
    v_mfma_f32_16x16x32_bf16 v[32:35], v[144:147], v[96:99], v[32:35]
    v_mfma_f32_16x16x32_bf16 v[52:55], v[144:147], v[100:103], v[52:55]
    v_mfma_f32_16x16x32_bf16 v[72:75], v[144:147], v[104:107], v[72:75]
    v_mfma_f32_16x16x32_bf16 v[92:95], v[144:147], v[108:111], v[92:95]
    buffer_load_dwordx4 v[144:147], v5, s[16:19], s37 offen offset:0
    s_add_u32 s37, s37, 16384
    s_waitcnt vmcnt(12) lgkmcnt(0)
    v_mfma_f32_16x16x32_bf16 v[16:19], v[148:151], v[112:115], v[16:19]
    s_add_u32 m0, s35, 8192
    v_mfma_f32_16x16x32_bf16 v[36:39], v[148:151], v[116:119], v[36:39]
    buffer_load_dwordx4 v1, s[12:15], s36 offen offset:0  lds
    v_mfma_f32_16x16x32_bf16 v[56:59], v[148:151], v[120:123], v[56:59]
    buffer_load_dwordx4 v2, s[12:15], s36 offen offset:1024  lds
    v_mfma_f32_16x16x32_bf16 v[76:79], v[148:151], v[124:127], v[76:79]
    buffer_load_dwordx4 v[148:151], v5, s[16:19], s37 offen offset:0
    v_mfma_f32_16x16x32_bf16 v[20:23], v[152:155], v[112:115], v[20:23]
    buffer_load_dwordx4 v3, s[12:15], s36 offen offset:2048  lds
    v_mfma_f32_16x16x32_bf16 v[40:43], v[152:155], v[116:119], v[40:43]
    buffer_load_dwordx4 v4, s[12:15], s36 offen offset:3072  lds
    v_mfma_f32_16x16x32_bf16 v[60:63], v[152:155], v[120:123], v[60:63]
    s_add_u32 s36, s36, 524288
    v_mfma_f32_16x16x32_bf16 v[80:83], v[152:155], v[124:127], v[80:83]
    buffer_load_dwordx4 v[152:155], v5, s[16:19], s37 offen offset:1024
    s_waitcnt vmcnt(16)
    v_mfma_f32_16x16x32_bf16 v[24:27], v[156:159], v[112:115], v[24:27]
    v_mfma_f32_16x16x32_bf16 v[44:47], v[156:159], v[116:119], v[44:47]
    ds_read_b64_tr_b16 v[96:97], v6 offset:0
    ds_read_b64_tr_b16 v[98:99], v6 offset:512
    v_mfma_f32_16x16x32_bf16 v[64:67], v[156:159], v[120:123], v[64:67]
    ds_read_b64_tr_b16 v[100:101], v7 offset:0
    ds_read_b64_tr_b16 v[102:103], v7 offset:512
    v_mfma_f32_16x16x32_bf16 v[84:87], v[156:159], v[124:127], v[84:87]
    buffer_load_dwordx4 v[156:159], v5, s[16:19], s37 offen offset:2048
    v_mfma_f32_16x16x32_bf16 v[28:31], v[160:163], v[112:115], v[28:31]
    v_mfma_f32_16x16x32_bf16 v[48:51], v[160:163], v[116:119], v[48:51]
    ds_read_b64_tr_b16 v[104:105], v8 offset:0
    ds_read_b64_tr_b16 v[106:107], v8 offset:512
    v_mfma_f32_16x16x32_bf16 v[68:71], v[160:163], v[120:123], v[68:71]
    ds_read_b64_tr_b16 v[108:109], v9 offset:0
    ds_read_b64_tr_b16 v[110:111], v9 offset:512
    v_mfma_f32_16x16x32_bf16 v[88:91], v[160:163], v[124:127], v[88:91]
    buffer_load_dwordx4 v[160:163], v5, s[16:19], s37 offen offset:3072
    s_add_u32 s37, s37, 4096
    s_waitcnt vmcnt(17)
    v_mfma_f32_16x16x32_bf16 v[32:35], v[164:167], v[112:115], v[32:35]
    v_mfma_f32_16x16x32_bf16 v[52:55], v[164:167], v[116:119], v[52:55]
    v_mfma_f32_16x16x32_bf16 v[72:75], v[164:167], v[120:123], v[72:75]
    v_mfma_f32_16x16x32_bf16 v[92:95], v[164:167], v[124:127], v[92:95]
    buffer_load_dwordx4 v[164:167], v5, s[16:19], s37 offen offset:0
    s_add_u32 s37, s37, 16384
    s_waitcnt vmcnt(12) lgkmcnt(0)
    v_mfma_f32_16x16x32_bf16 v[16:19], v[128:131], v[96:99], v[16:19]
    s_add_u32 m0, s35, 0
    v_mfma_f32_16x16x32_bf16 v[36:39], v[128:131], v[100:103], v[36:39]
    buffer_load_dwordx4 v1, s[12:15], s36 offen offset:0  lds
    v_mfma_f32_16x16x32_bf16 v[56:59], v[128:131], v[104:107], v[56:59]
    buffer_load_dwordx4 v2, s[12:15], s36 offen offset:1024  lds
    v_mfma_f32_16x16x32_bf16 v[76:79], v[128:131], v[108:111], v[76:79]
    buffer_load_dwordx4 v[128:131], v5, s[16:19], s37 offen offset:0
    v_mfma_f32_16x16x32_bf16 v[20:23], v[132:135], v[96:99], v[20:23]
    buffer_load_dwordx4 v3, s[12:15], s36 offen offset:2048  lds
    v_mfma_f32_16x16x32_bf16 v[40:43], v[132:135], v[100:103], v[40:43]
    buffer_load_dwordx4 v4, s[12:15], s36 offen offset:3072  lds
    v_mfma_f32_16x16x32_bf16 v[60:63], v[132:135], v[104:107], v[60:63]
    s_add_u32 s36, s36, 524288
    v_mfma_f32_16x16x32_bf16 v[80:83], v[132:135], v[108:111], v[80:83]
    buffer_load_dwordx4 v[132:135], v5, s[16:19], s37 offen offset:1024
    s_waitcnt vmcnt(16)
    v_mfma_f32_16x16x32_bf16 v[24:27], v[136:139], v[96:99], v[24:27]
    v_mfma_f32_16x16x32_bf16 v[44:47], v[136:139], v[100:103], v[44:47]
    ds_read_b64_tr_b16 v[112:113], v6 offset:4096
    ds_read_b64_tr_b16 v[114:115], v6 offset:4608
    v_mfma_f32_16x16x32_bf16 v[64:67], v[136:139], v[104:107], v[64:67]
    ds_read_b64_tr_b16 v[116:117], v7 offset:4096
    ds_read_b64_tr_b16 v[118:119], v7 offset:4608
    v_mfma_f32_16x16x32_bf16 v[84:87], v[136:139], v[108:111], v[84:87]
    buffer_load_dwordx4 v[136:139], v5, s[16:19], s37 offen offset:2048
    v_mfma_f32_16x16x32_bf16 v[28:31], v[140:143], v[96:99], v[28:31]
    v_mfma_f32_16x16x32_bf16 v[48:51], v[140:143], v[100:103], v[48:51]
    ds_read_b64_tr_b16 v[120:121], v8 offset:4096
    ds_read_b64_tr_b16 v[122:123], v8 offset:4608
    v_mfma_f32_16x16x32_bf16 v[68:71], v[140:143], v[104:107], v[68:71]
    ds_read_b64_tr_b16 v[124:125], v9 offset:4096
    ds_read_b64_tr_b16 v[126:127], v9 offset:4608
    v_mfma_f32_16x16x32_bf16 v[88:91], v[140:143], v[108:111], v[88:91]
    buffer_load_dwordx4 v[140:143], v5, s[16:19], s37 offen offset:3072
    s_add_u32 s37, s37, 4096
    s_waitcnt vmcnt(17)
    v_mfma_f32_16x16x32_bf16 v[32:35], v[144:147], v[96:99], v[32:35]
    v_mfma_f32_16x16x32_bf16 v[52:55], v[144:147], v[100:103], v[52:55]
    v_mfma_f32_16x16x32_bf16 v[72:75], v[144:147], v[104:107], v[72:75]
    v_mfma_f32_16x16x32_bf16 v[92:95], v[144:147], v[108:111], v[92:95]
    buffer_load_dwordx4 v[144:147], v5, s[16:19], s37 offen offset:0
    s_add_u32 s37, s37, 16384
    s_waitcnt vmcnt(12) lgkmcnt(0)
    v_mfma_f32_16x16x32_bf16 v[16:19], v[148:151], v[112:115], v[16:19]
    s_add_u32 m0, s35, 4096
    v_mfma_f32_16x16x32_bf16 v[36:39], v[148:151], v[116:119], v[36:39]
    buffer_load_dwordx4 v1, s[12:15], s36 offen offset:0  lds
    v_mfma_f32_16x16x32_bf16 v[56:59], v[148:151], v[120:123], v[56:59]
    buffer_load_dwordx4 v2, s[12:15], s36 offen offset:1024  lds
    v_mfma_f32_16x16x32_bf16 v[76:79], v[148:151], v[124:127], v[76:79]
    buffer_load_dwordx4 v[148:151], v5, s[16:19], s37 offen offset:0
    v_mfma_f32_16x16x32_bf16 v[20:23], v[152:155], v[112:115], v[20:23]
    buffer_load_dwordx4 v3, s[12:15], s36 offen offset:2048  lds
    v_mfma_f32_16x16x32_bf16 v[40:43], v[152:155], v[116:119], v[40:43]
    buffer_load_dwordx4 v4, s[12:15], s36 offen offset:3072  lds
    v_mfma_f32_16x16x32_bf16 v[60:63], v[152:155], v[120:123], v[60:63]
    s_add_u32 s36, s36, 524288
    v_mfma_f32_16x16x32_bf16 v[80:83], v[152:155], v[124:127], v[80:83]
    buffer_load_dwordx4 v[152:155], v5, s[16:19], s37 offen offset:1024
    s_waitcnt vmcnt(16)
    v_mfma_f32_16x16x32_bf16 v[24:27], v[156:159], v[112:115], v[24:27]
    v_mfma_f32_16x16x32_bf16 v[44:47], v[156:159], v[116:119], v[44:47]
    ds_read_b64_tr_b16 v[96:97], v6 offset:8192
    ds_read_b64_tr_b16 v[98:99], v6 offset:8704
    v_mfma_f32_16x16x32_bf16 v[64:67], v[156:159], v[120:123], v[64:67]
    ds_read_b64_tr_b16 v[100:101], v7 offset:8192
    ds_read_b64_tr_b16 v[102:103], v7 offset:8704
    v_mfma_f32_16x16x32_bf16 v[84:87], v[156:159], v[124:127], v[84:87]
    buffer_load_dwordx4 v[156:159], v5, s[16:19], s37 offen offset:2048
    v_mfma_f32_16x16x32_bf16 v[28:31], v[160:163], v[112:115], v[28:31]
    v_mfma_f32_16x16x32_bf16 v[48:51], v[160:163], v[116:119], v[48:51]
    ds_read_b64_tr_b16 v[104:105], v8 offset:8192
    ds_read_b64_tr_b16 v[106:107], v8 offset:8704
    v_mfma_f32_16x16x32_bf16 v[68:71], v[160:163], v[120:123], v[68:71]
    ds_read_b64_tr_b16 v[108:109], v9 offset:8192
    ds_read_b64_tr_b16 v[110:111], v9 offset:8704
    v_mfma_f32_16x16x32_bf16 v[88:91], v[160:163], v[124:127], v[88:91]
    buffer_load_dwordx4 v[160:163], v5, s[16:19], s37 offen offset:3072
    s_add_u32 s37, s37, 4096
    s_waitcnt vmcnt(17)
    v_mfma_f32_16x16x32_bf16 v[32:35], v[164:167], v[112:115], v[32:35]
    v_mfma_f32_16x16x32_bf16 v[52:55], v[164:167], v[116:119], v[52:55]
    v_mfma_f32_16x16x32_bf16 v[72:75], v[164:167], v[120:123], v[72:75]
    v_mfma_f32_16x16x32_bf16 v[92:95], v[164:167], v[124:127], v[92:95]
    buffer_load_dwordx4 v[164:167], v5, s[16:19], s37 offen offset:0
    s_add_u32 s37, s37, 16384
    ds_read_b32 v14, v15 offset:12
    s_waitcnt vmcnt(12) lgkmcnt(1)
    v_mfma_f32_16x16x32_bf16 v[16:19], v[128:131], v[96:99], v[16:19]
    s_add_u32 m0, s35, 8192
    v_mfma_f32_16x16x32_bf16 v[36:39], v[128:131], v[100:103], v[36:39]
    buffer_load_dwordx4 v1, s[12:15], s36 offen offset:0  lds
    v_mfma_f32_16x16x32_bf16 v[56:59], v[128:131], v[104:107], v[56:59]
    buffer_load_dwordx4 v2, s[12:15], s36 offen offset:1024  lds
    v_mfma_f32_16x16x32_bf16 v[76:79], v[128:131], v[108:111], v[76:79]
    buffer_load_dwordx4 v[128:131], v5, s[16:19], s37 offen offset:0
    v_mfma_f32_16x16x32_bf16 v[20:23], v[132:135], v[96:99], v[20:23]
    buffer_load_dwordx4 v3, s[12:15], s36 offen offset:2048  lds
    v_mfma_f32_16x16x32_bf16 v[40:43], v[132:135], v[100:103], v[40:43]
    buffer_load_dwordx4 v4, s[12:15], s36 offen offset:3072  lds
    v_mfma_f32_16x16x32_bf16 v[60:63], v[132:135], v[104:107], v[60:63]
    s_add_u32 s36, s36, 524288
    v_mfma_f32_16x16x32_bf16 v[80:83], v[132:135], v[108:111], v[80:83]
    buffer_load_dwordx4 v[132:135], v5, s[16:19], s37 offen offset:1024
    s_waitcnt vmcnt(16)
    v_mfma_f32_16x16x32_bf16 v[24:27], v[136:139], v[96:99], v[24:27]
    v_mfma_f32_16x16x32_bf16 v[44:47], v[136:139], v[100:103], v[44:47]
    ds_read_b64_tr_b16 v[112:113], v6 offset:0
    ds_read_b64_tr_b16 v[114:115], v6 offset:512
    v_mfma_f32_16x16x32_bf16 v[64:67], v[136:139], v[104:107], v[64:67]
    ds_read_b64_tr_b16 v[116:117], v7 offset:0
    ds_read_b64_tr_b16 v[118:119], v7 offset:512
    v_mfma_f32_16x16x32_bf16 v[84:87], v[136:139], v[108:111], v[84:87]
    buffer_load_dwordx4 v[136:139], v5, s[16:19], s37 offen offset:2048
    v_mfma_f32_16x16x32_bf16 v[28:31], v[140:143], v[96:99], v[28:31]
    v_mfma_f32_16x16x32_bf16 v[48:51], v[140:143], v[100:103], v[48:51]
    ds_read_b64_tr_b16 v[120:121], v8 offset:0
    ds_read_b64_tr_b16 v[122:123], v8 offset:512
    v_mfma_f32_16x16x32_bf16 v[68:71], v[140:143], v[104:107], v[68:71]
    ds_read_b64_tr_b16 v[124:125], v9 offset:0
    ds_read_b64_tr_b16 v[126:127], v9 offset:512
    v_mfma_f32_16x16x32_bf16 v[88:91], v[140:143], v[108:111], v[88:91]
    buffer_load_dwordx4 v[140:143], v5, s[16:19], s37 offen offset:3072
    s_add_u32 s37, s37, 4096
    s_waitcnt vmcnt(17)
    v_mfma_f32_16x16x32_bf16 v[32:35], v[144:147], v[96:99], v[32:35]
    v_mfma_f32_16x16x32_bf16 v[52:55], v[144:147], v[100:103], v[52:55]
    v_mfma_f32_16x16x32_bf16 v[72:75], v[144:147], v[104:107], v[72:75]
    v_mfma_f32_16x16x32_bf16 v[92:95], v[144:147], v[108:111], v[92:95]
    buffer_load_dwordx4 v[144:147], v5, s[16:19], s37 offen offset:0
    s_add_u32 s37, s37, 16384
    s_waitcnt lgkmcnt(8)
    v_cmp_ne_u32 vcc, 1, v14
    s_cbranch_vccnz K2_late
    s_mul_i32 s32, s26, 81920
    s_add_u32 s32, s32, 9437184
    v_lshrrev_b32 v10, 3, v0
    v_and_b32 v11, 7, v0
    v_bfe_u32 v12, v10, 1, 1
    v_lshlrev_b32 v12, 2, v12
    v_xor_b32 v11, v11, v12
    v_mul_u32_u24 v10, 128, v10
    v_lshl_add_u32 v10, v11, 4, v10
    v_add_u32 v1, s32, v10
    v_xor_b32 v2, 32, v1
    v_add_u32 v2, 0, v2
    v_add_u32 v3, 0, v1
    v_add_u32 v4, 0, v2
    s_lshl_b32 s36, s34, 12
    s_add_u32 s62, s37, 10240
    s_cmp_ge_u32 s34, 2
    s_cselect_b32 s37, 0x40000000, s37
    s_waitcnt vmcnt(12) lgkmcnt(0)
    v_mfma_f32_16x16x32_bf16 v[16:19], v[148:151], v[112:115], v[16:19]
    s_add_u32 m0, s35, 0
    v_mfma_f32_16x16x32_bf16 v[36:39], v[148:151], v[116:119], v[36:39]
    buffer_load_dwordx4 v1, s[16:19], s36 offen offset:0  lds
    v_mfma_f32_16x16x32_bf16 v[56:59], v[148:151], v[120:123], v[56:59]
    buffer_load_dwordx4 v2, s[16:19], s36 offen offset:1024  lds
    v_mfma_f32_16x16x32_bf16 v[76:79], v[148:151], v[124:127], v[76:79]
    buffer_load_dwordx4 v[148:151], v5, s[16:19], s37 offen offset:0
    v_mfma_f32_16x16x32_bf16 v[20:23], v[152:155], v[112:115], v[20:23]
    buffer_load_dwordx4 v3, s[16:19], s36 offen offset:2048  lds
    v_mfma_f32_16x16x32_bf16 v[40:43], v[152:155], v[116:119], v[40:43]
    buffer_load_dwordx4 v4, s[16:19], s36 offen offset:3072  lds
    v_mfma_f32_16x16x32_bf16 v[60:63], v[152:155], v[120:123], v[60:63]
    s_add_u32 s36, s36, 16384
    v_mfma_f32_16x16x32_bf16 v[80:83], v[152:155], v[124:127], v[80:83]
    buffer_load_dwordx4 v[152:155], v5, s[16:19], s37 offen offset:1024
    s_waitcnt vmcnt(16)
    v_mfma_f32_16x16x32_bf16 v[24:27], v[156:159], v[112:115], v[24:27]
    v_mfma_f32_16x16x32_bf16 v[44:47], v[156:159], v[116:119], v[44:47]
    ds_read_b64_tr_b16 v[96:97], v6 offset:4096
    ds_read_b64_tr_b16 v[98:99], v6 offset:4608
    v_mfma_f32_16x16x32_bf16 v[64:67], v[156:159], v[120:123], v[64:67]
    ds_read_b64_tr_b16 v[100:101], v7 offset:4096
    ds_read_b64_tr_b16 v[102:103], v7 offset:4608
    v_mfma_f32_16x16x32_bf16 v[84:87], v[156:159], v[124:127], v[84:87]
    buffer_load_dwordx4 v[156:159], v5, s[16:19], s37 offen offset:2048
    v_mfma_f32_16x16x32_bf16 v[28:31], v[160:163], v[112:115], v[28:31]
    v_mfma_f32_16x16x32_bf16 v[48:51], v[160:163], v[116:119], v[48:51]
    ds_read_b64_tr_b16 v[104:105], v8 offset:4096
    ds_read_b64_tr_b16 v[106:107], v8 offset:4608
    v_mfma_f32_16x16x32_bf16 v[68:71], v[160:163], v[120:123], v[68:71]
    ds_read_b64_tr_b16 v[108:109], v9 offset:4096
    ds_read_b64_tr_b16 v[110:111], v9 offset:4608
    v_mfma_f32_16x16x32_bf16 v[88:91], v[160:163], v[124:127], v[88:91]
    buffer_load_dwordx4 v[160:163], v5, s[16:19], s37 offen offset:3072
    s_add_u32 s37, s37, 4096
    s_waitcnt vmcnt(17)
    v_mfma_f32_16x16x32_bf16 v[32:35], v[164:167], v[112:115], v[32:35]
    v_mfma_f32_16x16x32_bf16 v[52:55], v[164:167], v[116:119], v[52:55]
    v_mfma_f32_16x16x32_bf16 v[72:75], v[164:167], v[120:123], v[72:75]
    v_mfma_f32_16x16x32_bf16 v[92:95], v[164:167], v[124:127], v[92:95]
    buffer_load_dwordx4 v[164:167], v5, s[16:19], s37 offen offset:0
    s_add_u32 s37, s37, 16384
    s_mov_b32 s37, s62
    s_waitcnt vmcnt(12) lgkmcnt(0)
    v_mfma_f32_16x16x32_bf16 v[16:19], v[128:131], v[96:99], v[16:19]
    s_add_u32 m0, s35, 4096
    v_mfma_f32_16x16x32_bf16 v[36:39], v[128:131], v[100:103], v[36:39]
    buffer_load_dwordx4 v1, s[16:19], s36 offen offset:0  lds
    v_mfma_f32_16x16x32_bf16 v[56:59], v[128:131], v[104:107], v[56:59]
    buffer_load_dwordx4 v2, s[16:19], s36 offen offset:1024  lds
    v_mfma_f32_16x16x32_bf16 v[76:79], v[128:131], v[108:111], v[76:79]
    buffer_load_dwordx4 v[128:131], v5, s[16:19], s37 offen offset:0
    v_mfma_f32_16x16x32_bf16 v[20:23], v[132:135], v[96:99], v[20:23]
    buffer_load_dwordx4 v3, s[16:19], s36 offen offset:2048  lds
    v_mfma_f32_16x16x32_bf16 v[40:43], v[132:135], v[100:103], v[40:43]
    buffer_load_dwordx4 v4, s[16:19], s36 offen offset:3072  lds
    v_mfma_f32_16x16x32_bf16 v[60:63], v[132:135], v[104:107], v[60:63]
    s_add_u32 s36, s36, 16384
    v_mfma_f32_16x16x32_bf16 v[80:83], v[132:135], v[108:111], v[80:83]
    buffer_load_dwordx4 v[132:135], v5, s[16:19], s37 offen offset:1024
    s_waitcnt vmcnt(16)
    v_mfma_f32_16x16x32_bf16 v[24:27], v[136:139], v[96:99], v[24:27]
    v_mfma_f32_16x16x32_bf16 v[44:47], v[136:139], v[100:103], v[44:47]
    ds_read_b64_tr_b16 v[112:113], v6 offset:8192
    ds_read_b64_tr_b16 v[114:115], v6 offset:8704
    v_mfma_f32_16x16x32_bf16 v[64:67], v[136:139], v[104:107], v[64:67]
    ds_read_b64_tr_b16 v[116:117], v7 offset:8192
    ds_read_b64_tr_b16 v[118:119], v7 offset:8704
    v_mfma_f32_16x16x32_bf16 v[84:87], v[136:139], v[108:111], v[84:87]
    buffer_load_dwordx4 v[136:139], v5, s[16:19], s37 offen offset:2048
    v_mfma_f32_16x16x32_bf16 v[28:31], v[140:143], v[96:99], v[28:31]
    v_mfma_f32_16x16x32_bf16 v[48:51], v[140:143], v[100:103], v[48:51]
    ds_read_b64_tr_b16 v[120:121], v8 offset:8192
    ds_read_b64_tr_b16 v[122:123], v8 offset:8704
    v_mfma_f32_16x16x32_bf16 v[68:71], v[140:143], v[104:107], v[68:71]
    ds_read_b64_tr_b16 v[124:125], v9 offset:8192
    ds_read_b64_tr_b16 v[126:127], v9 offset:8704
    v_mfma_f32_16x16x32_bf16 v[88:91], v[140:143], v[108:111], v[88:91]
    buffer_load_dwordx4 v[140:143], v5, s[16:19], s37 offen offset:3072
    s_add_u32 s37, s37, 4096
    s_waitcnt vmcnt(17)
    v_mfma_f32_16x16x32_bf16 v[32:35], v[144:147], v[96:99], v[32:35]
    v_mfma_f32_16x16x32_bf16 v[52:55], v[144:147], v[100:103], v[52:55]
    v_mfma_f32_16x16x32_bf16 v[72:75], v[144:147], v[104:107], v[72:75]
    v_mfma_f32_16x16x32_bf16 v[92:95], v[144:147], v[108:111], v[92:95]
    buffer_load_dwordx4 v[144:147], v5, s[16:19], s37 offen offset:0
    s_add_u32 s37, s37, 16384
    s_waitcnt vmcnt(12) lgkmcnt(0)
    v_mfma_f32_16x16x32_bf16 v[16:19], v[148:151], v[112:115], v[16:19]
    s_add_u32 m0, s35, 8192
    v_mfma_f32_16x16x32_bf16 v[36:39], v[148:151], v[116:119], v[36:39]
    buffer_load_dwordx4 v1, s[16:19], s36 offen offset:0  lds
    v_mfma_f32_16x16x32_bf16 v[56:59], v[148:151], v[120:123], v[56:59]
    buffer_load_dwordx4 v2, s[16:19], s36 offen offset:1024  lds
    v_mfma_f32_16x16x32_bf16 v[76:79], v[148:151], v[124:127], v[76:79]
    buffer_load_dwordx4 v[148:151], v5, s[16:19], s37 offen offset:0
    v_mfma_f32_16x16x32_bf16 v[20:23], v[152:155], v[112:115], v[20:23]
    buffer_load_dwordx4 v3, s[16:19], s36 offen offset:2048  lds
    v_mfma_f32_16x16x32_bf16 v[40:43], v[152:155], v[116:119], v[40:43]
    buffer_load_dwordx4 v4, s[16:19], s36 offen offset:3072  lds
    v_mfma_f32_16x16x32_bf16 v[60:63], v[152:155], v[120:123], v[60:63]
    s_add_u32 s36, s36, 16384
    v_mfma_f32_16x16x32_bf16 v[80:83], v[152:155], v[124:127], v[80:83]
    buffer_load_dwordx4 v[152:155], v5, s[16:19], s37 offen offset:1024
    s_waitcnt vmcnt(16)
    v_mfma_f32_16x16x32_bf16 v[24:27], v[156:159], v[112:115], v[24:27]
    v_mfma_f32_16x16x32_bf16 v[44:47], v[156:159], v[116:119], v[44:47]
    ds_read_b64_tr_b16 v[96:97], v6 offset:0
    ds_read_b64_tr_b16 v[98:99], v6 offset:512
    v_mfma_f32_16x16x32_bf16 v[64:67], v[156:159], v[120:123], v[64:67]
    ds_read_b64_tr_b16 v[100:101], v7 offset:0
    ds_read_b64_tr_b16 v[102:103], v7 offset:512
    v_mfma_f32_16x16x32_bf16 v[84:87], v[156:159], v[124:127], v[84:87]
    buffer_load_dwordx4 v[156:159], v5, s[16:19], s37 offen offset:2048
    v_mfma_f32_16x16x32_bf16 v[28:31], v[160:163], v[112:115], v[28:31]
    v_mfma_f32_16x16x32_bf16 v[48:51], v[160:163], v[116:119], v[48:51]
    ds_read_b64_tr_b16 v[104:105], v8 offset:0
    ds_read_b64_tr_b16 v[106:107], v8 offset:512
    v_mfma_f32_16x16x32_bf16 v[68:71], v[160:163], v[120:123], v[68:71]
    ds_read_b64_tr_b16 v[108:109], v9 offset:0
    ds_read_b64_tr_b16 v[110:111], v9 offset:512
    v_mfma_f32_16x16x32_bf16 v[88:91], v[160:163], v[124:127], v[88:91]
    buffer_load_dwordx4 v[160:163], v5, s[16:19], s37 offen offset:3072
    s_add_u32 s37, s37, 4096
    s_waitcnt vmcnt(17)
    v_mfma_f32_16x16x32_bf16 v[32:35], v[164:167], v[112:115], v[32:35]
    v_mfma_f32_16x16x32_bf16 v[52:55], v[164:167], v[116:119], v[52:55]
    v_mfma_f32_16x16x32_bf16 v[72:75], v[164:167], v[120:123], v[72:75]
    v_mfma_f32_16x16x32_bf16 v[92:95], v[164:167], v[124:127], v[92:95]
    buffer_load_dwordx4 v[164:167], v5, s[16:19], s37 offen offset:0
    s_add_u32 s37, s37, 16384
    s_waitcnt vmcnt(12) lgkmcnt(0)
    v_mfma_f32_16x16x32_bf16 v[16:19], v[128:131], v[96:99], v[16:19]
    s_add_u32 m0, s35, 0
    v_mfma_f32_16x16x32_bf16 v[36:39], v[128:131], v[100:103], v[36:39]
    buffer_load_dwordx4 v1, s[16:19], s36 offen offset:0  lds
    v_mfma_f32_16x16x32_bf16 v[56:59], v[128:131], v[104:107], v[56:59]
    buffer_load_dwordx4 v2, s[16:19], s36 offen offset:1024  lds
    v_mfma_f32_16x16x32_bf16 v[76:79], v[128:131], v[108:111], v[76:79]
    buffer_load_dwordx4 v[128:131], v5, s[16:19], s37 offen offset:0
    v_mfma_f32_16x16x32_bf16 v[20:23], v[132:135], v[96:99], v[20:23]
    buffer_load_dwordx4 v3, s[16:19], s36 offen offset:2048  lds
    v_mfma_f32_16x16x32_bf16 v[40:43], v[132:135], v[100:103], v[40:43]
    buffer_load_dwordx4 v4, s[16:19], s36 offen offset:3072  lds
    v_mfma_f32_16x16x32_bf16 v[60:63], v[132:135], v[104:107], v[60:63]
    s_add_u32 s36, s36, 16384
    v_mfma_f32_16x16x32_bf16 v[80:83], v[132:135], v[108:111], v[80:83]
    buffer_load_dwordx4 v[132:135], v5, s[16:19], s37 offen offset:1024
    s_waitcnt vmcnt(16)
    v_mfma_f32_16x16x32_bf16 v[24:27], v[136:139], v[96:99], v[24:27]
    v_mfma_f32_16x16x32_bf16 v[44:47], v[136:139], v[100:103], v[44:47]
    ds_read_b64_tr_b16 v[112:113], v6 offset:4096
    ds_read_b64_tr_b16 v[114:115], v6 offset:4608
    v_mfma_f32_16x16x32_bf16 v[64:67], v[136:139], v[104:107], v[64:67]
    ds_read_b64_tr_b16 v[116:117], v7 offset:4096
    ds_read_b64_tr_b16 v[118:119], v7 offset:4608
    v_mfma_f32_16x16x32_bf16 v[84:87], v[136:139], v[108:111], v[84:87]
    buffer_load_dwordx4 v[136:139], v5, s[16:19], s37 offen offset:2048
    v_mfma_f32_16x16x32_bf16 v[28:31], v[140:143], v[96:99], v[28:31]
    v_mfma_f32_16x16x32_bf16 v[48:51], v[140:143], v[100:103], v[48:51]
    ds_read_b64_tr_b16 v[120:121], v8 offset:4096
    ds_read_b64_tr_b16 v[122:123], v8 offset:4608
    v_mfma_f32_16x16x32_bf16 v[68:71], v[140:143], v[104:107], v[68:71]
    ds_read_b64_tr_b16 v[124:125], v9 offset:4096
    ds_read_b64_tr_b16 v[126:127], v9 offset:4608
    v_mfma_f32_16x16x32_bf16 v[88:91], v[140:143], v[108:111], v[88:91]
    buffer_load_dwordx4 v[140:143], v5, s[16:19], s37 offen offset:3072
    s_add_u32 s37, s37, 4096
    s_waitcnt vmcnt(17)
    v_mfma_f32_16x16x32_bf16 v[32:35], v[144:147], v[96:99], v[32:35]
    v_mfma_f32_16x16x32_bf16 v[52:55], v[144:147], v[100:103], v[52:55]
    v_mfma_f32_16x16x32_bf16 v[72:75], v[144:147], v[104:107], v[72:75]
    v_mfma_f32_16x16x32_bf16 v[92:95], v[144:147], v[108:111], v[92:95]
    buffer_load_dwordx4 v[144:147], v5, s[16:19], s37 offen offset:0
    s_add_u32 s37, s37, 16384
    s_waitcnt vmcnt(12) lgkmcnt(0)
    v_mfma_f32_16x16x32_bf16 v[16:19], v[148:151], v[112:115], v[16:19]
    s_add_u32 m0, s35, 4096
    v_mfma_f32_16x16x32_bf16 v[36:39], v[148:151], v[116:119], v[36:39]
    buffer_load_dwordx4 v1, s[16:19], s36 offen offset:0  lds
    v_mfma_f32_16x16x32_bf16 v[56:59], v[148:151], v[120:123], v[56:59]
    buffer_load_dwordx4 v2, s[16:19], s36 offen offset:1024  lds
    v_mfma_f32_16x16x32_bf16 v[76:79], v[148:151], v[124:127], v[76:79]
    buffer_load_dwordx4 v[148:151], v5, s[16:19], s37 offen offset:0
    v_mfma_f32_16x16x32_bf16 v[20:23], v[152:155], v[112:115], v[20:23]
    buffer_load_dwordx4 v3, s[16:19], s36 offen offset:2048  lds
    v_mfma_f32_16x16x32_bf16 v[40:43], v[152:155], v[116:119], v[40:43]
    buffer_load_dwordx4 v4, s[16:19], s36 offen offset:3072  lds
    v_mfma_f32_16x16x32_bf16 v[60:63], v[152:155], v[120:123], v[60:63]
    s_add_u32 s36, s36, 16384
    v_mfma_f32_16x16x32_bf16 v[80:83], v[152:155], v[124:127], v[80:83]
    buffer_load_dwordx4 v[152:155], v5, s[16:19], s37 offen offset:1024
    s_waitcnt vmcnt(16)
    v_mfma_f32_16x16x32_bf16 v[24:27], v[156:159], v[112:115], v[24:27]
    v_mfma_f32_16x16x32_bf16 v[44:47], v[156:159], v[116:119], v[44:47]
    ds_read_b64_tr_b16 v[96:97], v6 offset:8192
    ds_read_b64_tr_b16 v[98:99], v6 offset:8704
    v_mfma_f32_16x16x32_bf16 v[64:67], v[156:159], v[120:123], v[64:67]
    ds_read_b64_tr_b16 v[100:101], v7 offset:8192
    ds_read_b64_tr_b16 v[102:103], v7 offset:8704
    v_mfma_f32_16x16x32_bf16 v[84:87], v[156:159], v[124:127], v[84:87]
    buffer_load_dwordx4 v[156:159], v5, s[16:19], s37 offen offset:2048
    v_mfma_f32_16x16x32_bf16 v[28:31], v[160:163], v[112:115], v[28:31]
    v_mfma_f32_16x16x32_bf16 v[48:51], v[160:163], v[116:119], v[48:51]
    ds_read_b64_tr_b16 v[104:105], v8 offset:8192
    ds_read_b64_tr_b16 v[106:107], v8 offset:8704
    v_mfma_f32_16x16x32_bf16 v[68:71], v[160:163], v[120:123], v[68:71]
    ds_read_b64_tr_b16 v[108:109], v9 offset:8192
    ds_read_b64_tr_b16 v[110:111], v9 offset:8704
    v_mfma_f32_16x16x32_bf16 v[88:91], v[160:163], v[124:127], v[88:91]
    buffer_load_dwordx4 v[160:163], v5, s[16:19], s37 offen offset:3072
    s_add_u32 s37, s37, 4096
    s_waitcnt vmcnt(17)
    v_mfma_f32_16x16x32_bf16 v[32:35], v[164:167], v[112:115], v[32:35]
    v_mfma_f32_16x16x32_bf16 v[52:55], v[164:167], v[116:119], v[52:55]
    v_mfma_f32_16x16x32_bf16 v[72:75], v[164:167], v[120:123], v[72:75]
    v_mfma_f32_16x16x32_bf16 v[92:95], v[164:167], v[124:127], v[92:95]
    buffer_load_dwordx4 v[164:167], v5, s[16:19], s37 offen offset:0
    s_add_u32 s37, s37, 16384
    s_waitcnt vmcnt(12) lgkmcnt(0)
    v_mfma_f32_16x16x32_bf16 v[16:19], v[128:131], v[96:99], v[16:19]
    v_mfma_f32_16x16x32_bf16 v[36:39], v[128:131], v[100:103], v[36:39]
    v_mfma_f32_16x16x32_bf16 v[56:59], v[128:131], v[104:107], v[56:59]
    v_mfma_f32_16x16x32_bf16 v[76:79], v[128:131], v[108:111], v[76:79]
    buffer_load_dwordx4 v[128:131], v5, s[16:19], s37 offen offset:0
    v_mfma_f32_16x16x32_bf16 v[20:23], v[132:135], v[96:99], v[20:23]
    v_mfma_f32_16x16x32_bf16 v[40:43], v[132:135], v[100:103], v[40:43]
    v_mfma_f32_16x16x32_bf16 v[60:63], v[132:135], v[104:107], v[60:63]
    v_mfma_f32_16x16x32_bf16 v[80:83], v[132:135], v[108:111], v[80:83]
    buffer_load_dwordx4 v[132:135], v5, s[16:19], s37 offen offset:1024
    s_waitcnt vmcnt(12)
    v_mfma_f32_16x16x32_bf16 v[24:27], v[136:139], v[96:99], v[24:27]
    v_mfma_f32_16x16x32_bf16 v[44:47], v[136:139], v[100:103], v[44:47]
    ds_read_b64_tr_b16 v[112:113], v6 offset:0
    ds_read_b64_tr_b16 v[114:115], v6 offset:512
    v_mfma_f32_16x16x32_bf16 v[64:67], v[136:139], v[104:107], v[64:67]
    ds_read_b64_tr_b16 v[116:117], v7 offset:0
    ds_read_b64_tr_b16 v[118:119], v7 offset:512
    v_mfma_f32_16x16x32_bf16 v[84:87], v[136:139], v[108:111], v[84:87]
    buffer_load_dwordx4 v[136:139], v5, s[16:19], s37 offen offset:2048
    v_mfma_f32_16x16x32_bf16 v[28:31], v[140:143], v[96:99], v[28:31]
    v_mfma_f32_16x16x32_bf16 v[48:51], v[140:143], v[100:103], v[48:51]
    ds_read_b64_tr_b16 v[120:121], v8 offset:0
    ds_read_b64_tr_b16 v[122:123], v8 offset:512
    v_mfma_f32_16x16x32_bf16 v[68:71], v[140:143], v[104:107], v[68:71]
    ds_read_b64_tr_b16 v[124:125], v9 offset:0
    ds_read_b64_tr_b16 v[126:127], v9 offset:512
    v_mfma_f32_16x16x32_bf16 v[88:91], v[140:143], v[108:111], v[88:91]
    buffer_load_dwordx4 v[140:143], v5, s[16:19], s37 offen offset:3072
    s_add_u32 s37, s37, 4096
    s_waitcnt vmcnt(13)
    v_mfma_f32_16x16x32_bf16 v[32:35], v[144:147], v[96:99], v[32:35]
    v_mfma_f32_16x16x32_bf16 v[52:55], v[144:147], v[100:103], v[52:55]
    v_mfma_f32_16x16x32_bf16 v[72:75], v[144:147], v[104:107], v[72:75]
    v_mfma_f32_16x16x32_bf16 v[92:95], v[144:147], v[108:111], v[92:95]
    buffer_load_dwordx4 v[144:147], v5, s[16:19], s37 offen offset:0
    s_add_u32 s37, s37, 16384
    s_waitcnt vmcnt(8) lgkmcnt(0)
    v_mfma_f32_16x16x32_bf16 v[16:19], v[148:151], v[112:115], v[16:19]
    v_mfma_f32_16x16x32_bf16 v[36:39], v[148:151], v[116:119], v[36:39]
    v_mfma_f32_16x16x32_bf16 v[56:59], v[148:151], v[120:123], v[56:59]
    v_mfma_f32_16x16x32_bf16 v[76:79], v[148:151], v[124:127], v[76:79]
    v_mfma_f32_16x16x32_bf16 v[20:23], v[152:155], v[112:115], v[20:23]
    v_mfma_f32_16x16x32_bf16 v[40:43], v[152:155], v[116:119], v[40:43]
    v_mfma_f32_16x16x32_bf16 v[60:63], v[152:155], v[120:123], v[60:63]
    v_mfma_f32_16x16x32_bf16 v[80:83], v[152:155], v[124:127], v[80:83]
    s_waitcnt vmcnt(6)
    v_mfma_f32_16x16x32_bf16 v[24:27], v[156:159], v[112:115], v[24:27]
    v_mfma_f32_16x16x32_bf16 v[44:47], v[156:159], v[116:119], v[44:47]
    ds_read_b64_tr_b16 v[96:97], v6 offset:4096
    ds_read_b64_tr_b16 v[98:99], v6 offset:4608
    v_mfma_f32_16x16x32_bf16 v[64:67], v[156:159], v[120:123], v[64:67]
    ds_read_b64_tr_b16 v[100:101], v7 offset:4096
    ds_read_b64_tr_b16 v[102:103], v7 offset:4608
    v_mfma_f32_16x16x32_bf16 v[84:87], v[156:159], v[124:127], v[84:87]
    v_mfma_f32_16x16x32_bf16 v[28:31], v[160:163], v[112:115], v[28:31]
    v_mfma_f32_16x16x32_bf16 v[48:51], v[160:163], v[116:119], v[48:51]
    ds_read_b64_tr_b16 v[104:105], v8 offset:4096
    ds_read_b64_tr_b16 v[106:107], v8 offset:4608
    v_mfma_f32_16x16x32_bf16 v[68:71], v[160:163], v[120:123], v[68:71]
    ds_read_b64_tr_b16 v[108:109], v9 offset:4096
    ds_read_b64_tr_b16 v[110:111], v9 offset:4608
    v_mfma_f32_16x16x32_bf16 v[88:91], v[160:163], v[124:127], v[88:91]
    s_waitcnt vmcnt(5)
    v_mfma_f32_16x16x32_bf16 v[32:35], v[164:167], v[112:115], v[32:35]
    v_mfma_f32_16x16x32_bf16 v[52:55], v[164:167], v[116:119], v[52:55]
    v_mfma_f32_16x16x32_bf16 v[72:75], v[164:167], v[120:123], v[72:75]
    v_mfma_f32_16x16x32_bf16 v[92:95], v[164:167], v[124:127], v[92:95]
    s_branch K2_lastu
K2_late:
    s_add_u32 s62, s37, 10240
    s_cmp_ge_u32 s34, 2
    s_cselect_b32 s37, 0x40000000, s37
    s_waitcnt vmcnt(12) lgkmcnt(0)
    v_mfma_f32_16x16x32_bf16 v[16:19], v[148:151], v[112:115], v[16:19]
    v_mfma_f32_16x16x32_bf16 v[36:39], v[148:151], v[116:119], v[36:39]
    v_mfma_f32_16x16x32_bf16 v[56:59], v[148:151], v[120:123], v[56:59]
    v_mfma_f32_16x16x32_bf16 v[76:79], v[148:151], v[124:127], v[76:79]
    buffer_load_dwordx4 v[148:151], v5, s[16:19], s37 offen offset:0
    v_mfma_f32_16x16x32_bf16 v[20:23], v[152:155], v[112:115], v[20:23]
    v_mfma_f32_16x16x32_bf16 v[40:43], v[152:155], v[116:119], v[40:43]
    v_mfma_f32_16x16x32_bf16 v[60:63], v[152:155], v[120:123], v[60:63]
    v_mfma_f32_16x16x32_bf16 v[80:83], v[152:155], v[124:127], v[80:83]
    buffer_load_dwordx4 v[152:155], v5, s[16:19], s37 offen offset:1024
    s_waitcnt vmcnt(12)
    v_mfma_f32_16x16x32_bf16 v[24:27], v[156:159], v[112:115], v[24:27]
    v_mfma_f32_16x16x32_bf16 v[44:47], v[156:159], v[116:119], v[44:47]
    ds_read_b64_tr_b16 v[96:97], v6 offset:4096
    ds_read_b64_tr_b16 v[98:99], v6 offset:4608
    v_mfma_f32_16x16x32_bf16 v[64:67], v[156:159], v[120:123], v[64:67]
    ds_read_b64_tr_b16 v[100:101], v7 offset:4096
    ds_read_b64_tr_b16 v[102:103], v7 offset:4608
    v_mfma_f32_16x16x32_bf16 v[84:87], v[156:159], v[124:127], v[84:87]
    buffer_load_dwordx4 v[156:159], v5, s[16:19], s37 offen offset:2048
    v_mfma_f32_16x16x32_bf16 v[28:31], v[160:163], v[112:115], v[28:31]
    v_mfma_f32_16x16x32_bf16 v[48:51], v[160:163], v[116:119], v[48:51]
    ds_read_b64_tr_b16 v[104:105], v8 offset:4096
    ds_read_b64_tr_b16 v[106:107], v8 offset:4608
    v_mfma_f32_16x16x32_bf16 v[68:71], v[160:163], v[120:123], v[68:71]
    ds_read_b64_tr_b16 v[108:109], v9 offset:4096
    ds_read_b64_tr_b16 v[110:111], v9 offset:4608
    v_mfma_f32_16x16x32_bf16 v[88:91], v[160:163], v[124:127], v[88:91]
    buffer_load_dwordx4 v[160:163], v5, s[16:19], s37 offen offset:3072
    s_add_u32 s37, s37, 4096
    s_waitcnt vmcnt(13)
    v_mfma_f32_16x16x32_bf16 v[32:35], v[164:167], v[112:115], v[32:35]
    v_mfma_f32_16x16x32_bf16 v[52:55], v[164:167], v[116:119], v[52:55]
    v_mfma_f32_16x16x32_bf16 v[72:75], v[164:167], v[120:123], v[72:75]
    v_mfma_f32_16x16x32_bf16 v[92:95], v[164:167], v[124:127], v[92:95]
    buffer_load_dwordx4 v[164:167], v5, s[16:19], s37 offen offset:0
    s_add_u32 s37, s37, 16384
    s_mov_b32 s37, s62
    s_waitcnt vmcnt(8) lgkmcnt(0)
    v_mfma_f32_16x16x32_bf16 v[16:19], v[128:131], v[96:99], v[16:19]
    v_mfma_f32_16x16x32_bf16 v[36:39], v[128:131], v[100:103], v[36:39]
    v_mfma_f32_16x16x32_bf16 v[56:59], v[128:131], v[104:107], v[56:59]
    v_mfma_f32_16x16x32_bf16 v[76:79], v[128:131], v[108:111], v[76:79]
    buffer_load_dwordx4 v[128:131], v5, s[16:19], s37 offen offset:0
    v_mfma_f32_16x16x32_bf16 v[20:23], v[132:135], v[96:99], v[20:23]
    v_mfma_f32_16x16x32_bf16 v[40:43], v[132:135], v[100:103], v[40:43]
    v_mfma_f32_16x16x32_bf16 v[60:63], v[132:135], v[104:107], v[60:63]
    v_mfma_f32_16x16x32_bf16 v[80:83], v[132:135], v[108:111], v[80:83]
    buffer_load_dwordx4 v[132:135], v5, s[16:19], s37 offen offset:1024
    s_waitcnt vmcnt(8)
    v_mfma_f32_16x16x32_bf16 v[24:27], v[136:139], v[96:99], v[24:27]
    v_mfma_f32_16x16x32_bf16 v[44:47], v[136:139], v[100:103], v[44:47]
    ds_read_b64_tr_b16 v[112:113], v6 offset:8192
    ds_read_b64_tr_b16 v[114:115], v6 offset:8704
    v_mfma_f32_16x16x32_bf16 v[64:67], v[136:139], v[104:107], v[64:67]
    ds_read_b64_tr_b16 v[116:117], v7 offset:8192
    ds_read_b64_tr_b16 v[118:119], v7 offset:8704
    v_mfma_f32_16x16x32_bf16 v[84:87], v[136:139], v[108:111], v[84:87]
    buffer_load_dwordx4 v[136:139], v5, s[16:19], s37 offen offset:2048
    v_mfma_f32_16x16x32_bf16 v[28:31], v[140:143], v[96:99], v[28:31]
    v_mfma_f32_16x16x32_bf16 v[48:51], v[140:143], v[100:103], v[48:51]
    ds_read_b64_tr_b16 v[120:121], v8 offset:8192
    ds_read_b64_tr_b16 v[122:123], v8 offset:8704
    v_mfma_f32_16x16x32_bf16 v[68:71], v[140:143], v[104:107], v[68:71]
    ds_read_b64_tr_b16 v[124:125], v9 offset:8192
    ds_read_b64_tr_b16 v[126:127], v9 offset:8704
    v_mfma_f32_16x16x32_bf16 v[88:91], v[140:143], v[108:111], v[88:91]
    buffer_load_dwordx4 v[140:143], v5, s[16:19], s37 offen offset:3072
    s_add_u32 s37, s37, 4096
    s_waitcnt vmcnt(9)
    v_mfma_f32_16x16x32_bf16 v[32:35], v[144:147], v[96:99], v[32:35]
    v_mfma_f32_16x16x32_bf16 v[52:55], v[144:147], v[100:103], v[52:55]
    v_mfma_f32_16x16x32_bf16 v[72:75], v[144:147], v[104:107], v[72:75]
    v_mfma_f32_16x16x32_bf16 v[92:95], v[144:147], v[108:111], v[92:95]
    buffer_load_dwordx4 v[144:147], v5, s[16:19], s37 offen offset:0
    s_add_u32 s37, s37, 16384
    s_waitcnt vmcnt(8) lgkmcnt(0)
    v_mfma_f32_16x16x32_bf16 v[16:19], v[148:151], v[112:115], v[16:19]
    v_mfma_f32_16x16x32_bf16 v[36:39], v[148:151], v[116:119], v[36:39]
    v_mfma_f32_16x16x32_bf16 v[56:59], v[148:151], v[120:123], v[56:59]
    v_mfma_f32_16x16x32_bf16 v[76:79], v[148:151], v[124:127], v[76:79]
    buffer_load_dwordx4 v[148:151], v5, s[16:19], s37 offen offset:0
    v_mfma_f32_16x16x32_bf16 v[20:23], v[152:155], v[112:115], v[20:23]
    v_mfma_f32_16x16x32_bf16 v[40:43], v[152:155], v[116:119], v[40:43]
    v_mfma_f32_16x16x32_bf16 v[60:63], v[152:155], v[120:123], v[60:63]
    v_mfma_f32_16x16x32_bf16 v[80:83], v[152:155], v[124:127], v[80:83]
    buffer_load_dwordx4 v[152:155], v5, s[16:19], s37 offen offset:1024
    s_waitcnt vmcnt(8)
    v_mfma_f32_16x16x32_bf16 v[24:27], v[156:159], v[112:115], v[24:27]
    v_mfma_f32_16x16x32_bf16 v[44:47], v[156:159], v[116:119], v[44:47]
    v_mfma_f32_16x16x32_bf16 v[64:67], v[156:159], v[120:123], v[64:67]
    v_mfma_f32_16x16x32_bf16 v[84:87], v[156:159], v[124:127], v[84:87]
    buffer_load_dwordx4 v[156:159], v5, s[16:19], s37 offen offset:2048
    v_mfma_f32_16x16x32_bf16 v[28:31], v[160:163], v[112:115], v[28:31]
    v_mfma_f32_16x16x32_bf16 v[48:51], v[160:163], v[116:119], v[48:51]
    v_mfma_f32_16x16x32_bf16 v[68:71], v[160:163], v[120:123], v[68:71]
    v_mfma_f32_16x16x32_bf16 v[88:91], v[160:163], v[124:127], v[88:91]
    buffer_load_dwordx4 v[160:163], v5, s[16:19], s37 offen offset:3072
    s_add_u32 s37, s37, 4096
    s_waitcnt vmcnt(9)
    v_mfma_f32_16x16x32_bf16 v[32:35], v[164:167], v[112:115], v[32:35]
    v_mfma_f32_16x16x32_bf16 v[52:55], v[164:167], v[116:119], v[52:55]
    v_mfma_f32_16x16x32_bf16 v[72:75], v[164:167], v[120:123], v[72:75]
    v_mfma_f32_16x16x32_bf16 v[92:95], v[164:167], v[124:127], v[92:95]
    buffer_load_dwordx4 v[164:167], v5, s[16:19], s37 offen offset:0
    s_add_u32 s37, s37, 16384
    s_setprio 0
    s_mul_i32 s32, s26, 81920
    s_add_u32 s32, s32, 9437184
    v_lshrrev_b32 v10, 3, v0
    v_and_b32 v11, 7, v0
    v_bfe_u32 v12, v10, 1, 1
    v_lshlrev_b32 v12, 2, v12
    v_xor_b32 v11, v11, v12
    v_mul_u32_u24 v10, 128, v10
    v_lshl_add_u32 v10, v11, 4, v10
    v_add_u32 v1, s32, v10
    v_xor_b32 v2, 32, v1
    v_add_u32 v2, 0, v2
    v_add_u32 v3, 0, v1
    v_add_u32 v4, 0, v2
    s_lshl_b32 s36, s34, 12
    s_mov_b32 s63, 4194304
K2_waitO:
    ds_read_b32 v11, v15 offset:12
    s_waitcnt lgkmcnt(0)
    v_readfirstlane_b32 s31, v11
    s_nop 0
    s_cmp_ge_u32 s31, 1
    s_cbranch_scc1 K2_waitO_x
    s_sleep 1
    s_sub_u32 s63, s63, 1
    s_cbranch_scc0 K2_waitO
K2_waitO_x:
    s_add_u32 m0, s35, 0
    s_nop 0
    buffer_load_dwordx4 v1, s[16:19], s36 offen offset:0  lds
    buffer_load_dwordx4 v2, s[16:19], s36 offen offset:1024  lds
    buffer_load_dwordx4 v3, s[16:19], s36 offen offset:2048  lds
    buffer_load_dwordx4 v4, s[16:19], s36 offen offset:3072  lds
    s_add_u32 s36, s36, 16384
    s_add_u32 m0, s35, 4096
    s_nop 0
    buffer_load_dwordx4 v1, s[16:19], s36 offen offset:0  lds
    buffer_load_dwordx4 v2, s[16:19], s36 offen offset:1024  lds
    buffer_load_dwordx4 v3, s[16:19], s36 offen offset:2048  lds
    buffer_load_dwordx4 v4, s[16:19], s36 offen offset:3072  lds
    s_add_u32 s36, s36, 16384
    s_add_u32 m0, s35, 8192
    s_nop 0
    buffer_load_dwordx4 v1, s[16:19], s36 offen offset:0  lds
    buffer_load_dwordx4 v2, s[16:19], s36 offen offset:1024  lds
    buffer_load_dwordx4 v3, s[16:19], s36 offen offset:2048  lds
    buffer_load_dwordx4 v4, s[16:19], s36 offen offset:3072  lds
    s_add_u32 s36, s36, 16384
    s_waitcnt vmcnt(8)
    ds_read_b64_tr_b16 v[96:97], v6 offset:0
    ds_read_b64_tr_b16 v[98:99], v6 offset:512
    ds_read_b64_tr_b16 v[100:101], v7 offset:0
    ds_read_b64_tr_b16 v[102:103], v7 offset:512
    ds_read_b64_tr_b16 v[104:105], v8 offset:0
    ds_read_b64_tr_b16 v[106:107], v8 offset:512
    ds_read_b64_tr_b16 v[108:109], v9 offset:0
    ds_read_b64_tr_b16 v[110:111], v9 offset:512
    s_waitcnt lgkmcnt(0)
    v_mfma_f32_16x16x32_bf16 v[16:19], v[128:131], v[96:99], v[16:19]
    s_add_u32 m0, s35, 0
    v_mfma_f32_16x16x32_bf16 v[36:39], v[128:131], v[100:103], v[36:39]
    buffer_load_dwordx4 v1, s[16:19], s36 offen offset:0  lds
    v_mfma_f32_16x16x32_bf16 v[56:59], v[128:131], v[104:107], v[56:59]
    buffer_load_dwordx4 v2, s[16:19], s36 offen offset:1024  lds
    v_mfma_f32_16x16x32_bf16 v[76:79], v[128:131], v[108:111], v[76:79]
    buffer_load_dwordx4 v[128:131], v5, s[16:19], s37 offen offset:0
    v_mfma_f32_16x16x32_bf16 v[20:23], v[132:135], v[96:99], v[20:23]
    buffer_load_dwordx4 v3, s[16:19], s36 offen offset:2048  lds
    v_mfma_f32_16x16x32_bf16 v[40:43], v[132:135], v[100:103], v[40:43]
    buffer_load_dwordx4 v4, s[16:19], s36 offen offset:3072  lds
    v_mfma_f32_16x16x32_bf16 v[60:63], v[132:135], v[104:107], v[60:63]
    s_add_u32 s36, s36, 16384
    v_mfma_f32_16x16x32_bf16 v[80:83], v[132:135], v[108:111], v[80:83]
    buffer_load_dwordx4 v[132:135], v5, s[16:19], s37 offen offset:1024
    v_mfma_f32_16x16x32_bf16 v[24:27], v[136:139], v[96:99], v[24:27]
    v_mfma_f32_16x16x32_bf16 v[44:47], v[136:139], v[100:103], v[44:47]
    s_waitcnt vmcnt(10)
    ds_read_b64_tr_b16 v[112:113], v6 offset:4096
    ds_read_b64_tr_b16 v[114:115], v6 offset:4608
    v_mfma_f32_16x16x32_bf16 v[64:67], v[136:139], v[104:107], v[64:67]
    ds_read_b64_tr_b16 v[116:117], v7 offset:4096
    ds_read_b64_tr_b16 v[118:119], v7 offset:4608
    v_mfma_f32_16x16x32_bf16 v[84:87], v[136:139], v[108:111], v[84:87]
    buffer_load_dwordx4 v[136:139], v5, s[16:19], s37 offen offset:2048
    v_mfma_f32_16x16x32_bf16 v[28:31], v[140:143], v[96:99], v[28:31]
    v_mfma_f32_16x16x32_bf16 v[48:51], v[140:143], v[100:103], v[48:51]
    ds_read_b64_tr_b16 v[120:121], v8 offset:4096
    ds_read_b64_tr_b16 v[122:123], v8 offset:4608
    v_mfma_f32_16x16x32_bf16 v[68:71], v[140:143], v[104:107], v[68:71]
    ds_read_b64_tr_b16 v[124:125], v9 offset:4096
    ds_read_b64_tr_b16 v[126:127], v9 offset:4608
    v_mfma_f32_16x16x32_bf16 v[88:91], v[140:143], v[108:111], v[88:91]
    buffer_load_dwordx4 v[140:143], v5, s[16:19], s37 offen offset:3072
    s_add_u32 s37, s37, 4096
    v_mfma_f32_16x16x32_bf16 v[32:35], v[144:147], v[96:99], v[32:35]
    v_mfma_f32_16x16x32_bf16 v[52:55], v[144:147], v[100:103], v[52:55]
    v_mfma_f32_16x16x32_bf16 v[72:75], v[144:147], v[104:107], v[72:75]
    v_mfma_f32_16x16x32_bf16 v[92:95], v[144:147], v[108:111], v[92:95]
    buffer_load_dwordx4 v[144:147], v5, s[16:19], s37 offen offset:0
    s_add_u32 s37, s37, 16384
    s_waitcnt lgkmcnt(0)
    v_mfma_f32_16x16x32_bf16 v[16:19], v[148:151], v[112:115], v[16:19]
    s_add_u32 m0, s35, 4096
    v_mfma_f32_16x16x32_bf16 v[36:39], v[148:151], v[116:119], v[36:39]
    buffer_load_dwordx4 v1, s[16:19], s36 offen offset:0  lds
    v_mfma_f32_16x16x32_bf16 v[56:59], v[148:151], v[120:123], v[56:59]
    buffer_load_dwordx4 v2, s[16:19], s36 offen offset:1024  lds
    v_mfma_f32_16x16x32_bf16 v[76:79], v[148:151], v[124:127], v[76:79]
    buffer_load_dwordx4 v[148:151], v5, s[16:19], s37 offen offset:0
    v_mfma_f32_16x16x32_bf16 v[20:23], v[152:155], v[112:115], v[20:23]
    buffer_load_dwordx4 v3, s[16:19], s36 offen offset:2048  lds
    v_mfma_f32_16x16x32_bf16 v[40:43], v[152:155], v[116:119], v[40:43]
    buffer_load_dwordx4 v4, s[16:19], s36 offen offset:3072  lds
    v_mfma_f32_16x16x32_bf16 v[60:63], v[152:155], v[120:123], v[60:63]
    s_add_u32 s36, s36, 16384
    v_mfma_f32_16x16x32_bf16 v[80:83], v[152:155], v[124:127], v[80:83]
    buffer_load_dwordx4 v[152:155], v5, s[16:19], s37 offen offset:1024
    v_mfma_f32_16x16x32_bf16 v[24:27], v[156:159], v[112:115], v[24:27]
    v_mfma_f32_16x16x32_bf16 v[44:47], v[156:159], v[116:119], v[44:47]
    s_waitcnt vmcnt(15)
    ds_read_b64_tr_b16 v[96:97], v6 offset:8192
    ds_read_b64_tr_b16 v[98:99], v6 offset:8704
    v_mfma_f32_16x16x32_bf16 v[64:67], v[156:159], v[120:123], v[64:67]
    ds_read_b64_tr_b16 v[100:101], v7 offset:8192
    ds_read_b64_tr_b16 v[102:103], v7 offset:8704
    v_mfma_f32_16x16x32_bf16 v[84:87], v[156:159], v[124:127], v[84:87]
    buffer_load_dwordx4 v[156:159], v5, s[16:19], s37 offen offset:2048
    v_mfma_f32_16x16x32_bf16 v[28:31], v[160:163], v[112:115], v[28:31]
    v_mfma_f32_16x16x32_bf16 v[48:51], v[160:163], v[116:119], v[48:51]
    ds_read_b64_tr_b16 v[104:105], v8 offset:8192
    ds_read_b64_tr_b16 v[106:107], v8 offset:8704
    v_mfma_f32_16x16x32_bf16 v[68:71], v[160:163], v[120:123], v[68:71]
    ds_read_b64_tr_b16 v[108:109], v9 offset:8192
    ds_read_b64_tr_b16 v[110:111], v9 offset:8704
    v_mfma_f32_16x16x32_bf16 v[88:91], v[160:163], v[124:127], v[88:91]
    buffer_load_dwordx4 v[160:163], v5, s[16:19], s37 offen offset:3072
    s_add_u32 s37, s37, 4096
    v_mfma_f32_16x16x32_bf16 v[32:35], v[164:167], v[112:115], v[32:35]
    v_mfma_f32_16x16x32_bf16 v[52:55], v[164:167], v[116:119], v[52:55]
    v_mfma_f32_16x16x32_bf16 v[72:75], v[164:167], v[120:123], v[72:75]
    v_mfma_f32_16x16x32_bf16 v[92:95], v[164:167], v[124:127], v[92:95]
    buffer_load_dwordx4 v[164:167], v5, s[16:19], s37 offen offset:0
    s_add_u32 s37, s37, 16384
    s_waitcnt vmcnt(12) lgkmcnt(0)
    v_mfma_f32_16x16x32_bf16 v[16:19], v[128:131], v[96:99], v[16:19]
    v_mfma_f32_16x16x32_bf16 v[36:39], v[128:131], v[100:103], v[36:39]
    v_mfma_f32_16x16x32_bf16 v[56:59], v[128:131], v[104:107], v[56:59]
    v_mfma_f32_16x16x32_bf16 v[76:79], v[128:131], v[108:111], v[76:79]
    buffer_load_dwordx4 v[128:131], v5, s[16:19], s37 offen offset:0
    v_mfma_f32_16x16x32_bf16 v[20:23], v[132:135], v[96:99], v[20:23]
    v_mfma_f32_16x16x32_bf16 v[40:43], v[132:135], v[100:103], v[40:43]
    v_mfma_f32_16x16x32_bf16 v[60:63], v[132:135], v[104:107], v[60:63]
    v_mfma_f32_16x16x32_bf16 v[80:83], v[132:135], v[108:111], v[80:83]
    buffer_load_dwordx4 v[132:135], v5, s[16:19], s37 offen offset:1024
    s_waitcnt vmcnt(12)
    v_mfma_f32_16x16x32_bf16 v[24:27], v[136:139], v[96:99], v[24:27]
    v_mfma_f32_16x16x32_bf16 v[44:47], v[136:139], v[100:103], v[44:47]
    ds_read_b64_tr_b16 v[112:113], v6 offset:0
    ds_read_b64_tr_b16 v[114:115], v6 offset:512
    v_mfma_f32_16x16x32_bf16 v[64:67], v[136:139], v[104:107], v[64:67]
    ds_read_b64_tr_b16 v[116:117], v7 offset:0
    ds_read_b64_tr_b16 v[118:119], v7 offset:512
    v_mfma_f32_16x16x32_bf16 v[84:87], v[136:139], v[108:111], v[84:87]
    buffer_load_dwordx4 v[136:139], v5, s[16:19], s37 offen offset:2048
    v_mfma_f32_16x16x32_bf16 v[28:31], v[140:143], v[96:99], v[28:31]
    v_mfma_f32_16x16x32_bf16 v[48:51], v[140:143], v[100:103], v[48:51]
    ds_read_b64_tr_b16 v[120:121], v8 offset:0
    ds_read_b64_tr_b16 v[122:123], v8 offset:512
    v_mfma_f32_16x16x32_bf16 v[68:71], v[140:143], v[104:107], v[68:71]
    ds_read_b64_tr_b16 v[124:125], v9 offset:0
    ds_read_b64_tr_b16 v[126:127], v9 offset:512
    v_mfma_f32_16x16x32_bf16 v[88:91], v[140:143], v[108:111], v[88:91]
    buffer_load_dwordx4 v[140:143], v5, s[16:19], s37 offen offset:3072
    s_add_u32 s37, s37, 4096
    s_waitcnt vmcnt(13)
    v_mfma_f32_16x16x32_bf16 v[32:35], v[144:147], v[96:99], v[32:35]
    v_mfma_f32_16x16x32_bf16 v[52:55], v[144:147], v[100:103], v[52:55]
    v_mfma_f32_16x16x32_bf16 v[72:75], v[144:147], v[104:107], v[72:75]
    v_mfma_f32_16x16x32_bf16 v[92:95], v[144:147], v[108:111], v[92:95]
    buffer_load_dwordx4 v[144:147], v5, s[16:19], s37 offen offset:0
    s_add_u32 s37, s37, 16384
    s_waitcnt vmcnt(8) lgkmcnt(0)
    v_mfma_f32_16x16x32_bf16 v[16:19], v[148:151], v[112:115], v[16:19]
    v_mfma_f32_16x16x32_bf16 v[36:39], v[148:151], v[116:119], v[36:39]
    v_mfma_f32_16x16x32_bf16 v[56:59], v[148:151], v[120:123], v[56:59]
    v_mfma_f32_16x16x32_bf16 v[76:79], v[148:151], v[124:127], v[76:79]
    v_mfma_f32_16x16x32_bf16 v[20:23], v[152:155], v[112:115], v[20:23]
    v_mfma_f32_16x16x32_bf16 v[40:43], v[152:155], v[116:119], v[40:43]
    v_mfma_f32_16x16x32_bf16 v[60:63], v[152:155], v[120:123], v[60:63]
    v_mfma_f32_16x16x32_bf16 v[80:83], v[152:155], v[124:127], v[80:83]
    s_waitcnt vmcnt(6)
    v_mfma_f32_16x16x32_bf16 v[24:27], v[156:159], v[112:115], v[24:27]
    v_mfma_f32_16x16x32_bf16 v[44:47], v[156:159], v[116:119], v[44:47]
    ds_read_b64_tr_b16 v[96:97], v6 offset:4096
    ds_read_b64_tr_b16 v[98:99], v6 offset:4608
    v_mfma_f32_16x16x32_bf16 v[64:67], v[156:159], v[120:123], v[64:67]
    ds_read_b64_tr_b16 v[100:101], v7 offset:4096
    ds_read_b64_tr_b16 v[102:103], v7 offset:4608
    v_mfma_f32_16x16x32_bf16 v[84:87], v[156:159], v[124:127], v[84:87]
    v_mfma_f32_16x16x32_bf16 v[28:31], v[160:163], v[112:115], v[28:31]
    v_mfma_f32_16x16x32_bf16 v[48:51], v[160:163], v[116:119], v[48:51]
    ds_read_b64_tr_b16 v[104:105], v8 offset:4096
    ds_read_b64_tr_b16 v[106:107], v8 offset:4608
    v_mfma_f32_16x16x32_bf16 v[68:71], v[160:163], v[120:123], v[68:71]
    ds_read_b64_tr_b16 v[108:109], v9 offset:4096
    ds_read_b64_tr_b16 v[110:111], v9 offset:4608
    v_mfma_f32_16x16x32_bf16 v[88:91], v[160:163], v[124:127], v[88:91]
    s_waitcnt vmcnt(5)
    v_mfma_f32_16x16x32_bf16 v[32:35], v[164:167], v[112:115], v[32:35]
    v_mfma_f32_16x16x32_bf16 v[52:55], v[164:167], v[116:119], v[52:55]
    v_mfma_f32_16x16x32_bf16 v[72:75], v[164:167], v[120:123], v[72:75]
    v_mfma_f32_16x16x32_bf16 v[92:95], v[164:167], v[124:127], v[92:95]
K2_lastu:
    s_mov_b32 s40, s64
    s_mov_b32 s41, s65
    s_mov_b32 s42, 2621440
    s_mov_b32 s43, 0x20000
    s_mov_b32 s44, s70
    s_mov_b32 s45, s71
    s_mov_b32 s46, 4096
    s_mov_b32 s47, 0x20000
    s_mov_b32 s52, s66
    s_mov_b32 s53, s67
    s_mov_b32 s54, 2621440
    s_mov_b32 s55, 0x20000
    s_mul_i32 s48, s26, 81920
    s_mul_i32 s49, s27, 160
    s_add_u32 s48, s48, s49
    s_lshl_b32 s49, s26, 7
    s_lshl_b32 s56, s30, 6
    v_add_u32 v148, s56, v0
    v_mul_u32_u24 v149, 205, v148
    v_lshrrev_b32 v149, 11, v149
    v_mul_u32_u24 v150, 10, v149
    v_sub_u32 v150, v148, v150
    v_mul_u32_u24 v151, 336, v149
    v_lshl_add_u32 v151, v150, 5, v151
    v_mul_u32_u24 v152, 1280, v149
    v_lshl_add_u32 v152, v150, 4, v152
    v_lshlrev_b32 v149, 1, v149
    buffer_load_dwordx4 v[156:159], v152, s[40:43], s48 offen
    buffer_load_ushort v153, v149, s[44:47], s49 offen
    v_add_u32 v148, 55296, v151
    v_and_b32 v12, 15, v0
    v_lshrrev_b32 v11, 4, v0
    v_mul_u32_u24 v12, 336, v12
    v_lshl_add_u32 v12, v11, 4, v12
    v_add_u32 v12, s35, v12
    s_waitcnt vmcnt(2) lgkmcnt(0)
    v_mfma_f32_16x16x32_bf16 v[16:19], v[128:131], v[96:99], v[16:19]
    v_mfma_f32_16x16x32_bf16 v[36:39], v[128:131], v[100:103], v[36:39]
    v_mfma_f32_16x16x32_bf16 v[56:59], v[128:131], v[104:107], v[56:59]
    v_mfma_f32_16x16x32_bf16 v[76:79], v[128:131], v[108:111], v[76:79]
    v_mfma_f32_16x16x32_bf16 v[20:23], v[132:135], v[96:99], v[20:23]
    v_mfma_f32_16x16x32_bf16 v[40:43], v[132:135], v[100:103], v[40:43]
    s_nop 2
    ds_write_b128 v12, v[16:19] offset:0
    v_mfma_f32_16x16x32_bf16 v[60:63], v[132:135], v[104:107], v[60:63]
    ds_write_b128 v12, v[36:39] offset:5376
    v_mfma_f32_16x16x32_bf16 v[80:83], v[132:135], v[108:111], v[80:83]
    ds_write_b128 v12, v[56:59] offset:10752
    v_mfma_f32_16x16x32_bf16 v[24:27], v[136:139], v[96:99], v[24:27]
    ds_write_b128 v12, v[76:79] offset:16128
    v_mfma_f32_16x16x32_bf16 v[44:47], v[136:139], v[100:103], v[44:47]
    ds_write_b128 v12, v[20:23] offset:64
    v_mfma_f32_16x16x32_bf16 v[64:67], v[136:139], v[104:107], v[64:67]
    ds_write_b128 v12, v[40:43] offset:5440
    v_mfma_f32_16x16x32_bf16 v[84:87], v[136:139], v[108:111], v[84:87]
    ds_write_b128 v12, v[60:63] offset:10816
    v_mfma_f32_16x16x32_bf16 v[28:31], v[140:143], v[96:99], v[28:31]
    ds_write_b128 v12, v[80:83] offset:16192
    v_mfma_f32_16x16x32_bf16 v[48:51], v[140:143], v[100:103], v[48:51]
    ds_write_b128 v12, v[24:27] offset:128
    v_mfma_f32_16x16x32_bf16 v[68:71], v[140:143], v[104:107], v[68:71]
    ds_write_b128 v12, v[44:47] offset:5504
    v_mfma_f32_16x16x32_bf16 v[88:91], v[140:143], v[108:111], v[88:91]
    ds_write_b128 v12, v[64:67] offset:10880
    v_mfma_f32_16x16x32_bf16 v[32:35], v[144:147], v[96:99], v[32:35]
    ds_write_b128 v12, v[84:87] offset:16256
    v_mfma_f32_16x16x32_bf16 v[52:55], v[144:147], v[100:103], v[52:55]
    ds_write_b128 v12, v[28:31] offset:192
    v_mfma_f32_16x16x32_bf16 v[72:75], v[144:147], v[104:107], v[72:75]
    ds_write_b128 v12, v[48:51] offset:5568
    v_mfma_f32_16x16x32_bf16 v[92:95], v[144:147], v[108:111], v[92:95]
    ds_write_b128 v12, v[68:71] offset:10944
    ds_write_b128 v12, v[88:91] offset:16320
    ds_write_b128 v12, v[32:35] offset:256
    s_nop 0
    ds_write_b128 v12, v[52:55] offset:5632
    s_nop 0
    ds_write_b128 v12, v[72:75] offset:11008
    s_nop 0
    ds_write_b128 v12, v[92:95] offset:16384
    s_waitcnt lgkmcnt(0)
    s_barrier
    s_cmp_ge_u32 s30, 10
    s_cbranch_scc1 K2_end
    ds_read_b128 v[16:19], v151 offset:0
    ds_read_b128 v[20:23], v151 offset:16
    ds_read_b128 v[24:27], v151 offset:27648
    ds_read_b128 v[28:31], v151 offset:27664
    ds_read_b128 v[32:35], v148 offset:0
    ds_read_b128 v[36:39], v148 offset:16
    ds_read_b128 v[40:43], v148 offset:27648
    ds_read_b128 v[44:47], v148 offset:27664
    s_waitcnt vmcnt(0)
    v_lshlrev_b32 v153, 16, v153
    v_lshlrev_b32 v48, 16, v156
    v_and_b32 v49, 0xffff0000, v156
    v_lshlrev_b32 v50, 16, v157
    v_and_b32 v51, 0xffff0000, v157
    v_lshlrev_b32 v52, 16, v158
    v_and_b32 v53, 0xffff0000, v158
    v_lshlrev_b32 v54, 16, v159
    v_and_b32 v55, 0xffff0000, v159
    v_add_f32 v48, v48, v153
    v_add_f32 v49, v49, v153
    v_add_f32 v50, v50, v153
    v_add_f32 v51, v51, v153
    v_add_f32 v52, v52, v153
    v_add_f32 v53, v53, v153
    v_add_f32 v54, v54, v153
    v_add_f32 v55, v55, v153
    s_waitcnt lgkmcnt(6)
    v_pk_add_f32 v[48:49], v[48:49], v[16:17]
    v_pk_add_f32 v[50:51], v[50:51], v[18:19]
    v_pk_add_f32 v[52:53], v[52:53], v[20:21]
    v_pk_add_f32 v[54:55], v[54:55], v[22:23]
    s_waitcnt lgkmcnt(4)
    v_pk_add_f32 v[48:49], v[48:49], v[24:25]
    v_pk_add_f32 v[50:51], v[50:51], v[26:27]
    v_pk_add_f32 v[52:53], v[52:53], v[28:29]
    v_pk_add_f32 v[54:55], v[54:55], v[30:31]
    s_waitcnt lgkmcnt(2)
    v_pk_add_f32 v[48:49], v[48:49], v[32:33]
    v_pk_add_f32 v[50:51], v[50:51], v[34:35]
    v_pk_add_f32 v[52:53], v[52:53], v[36:37]
    v_pk_add_f32 v[54:55], v[54:55], v[38:39]
    s_waitcnt lgkmcnt(0)
    v_pk_add_f32 v[48:49], v[48:49], v[40:41]
    v_pk_add_f32 v[50:51], v[50:51], v[42:43]
    v_pk_add_f32 v[52:53], v[52:53], v[44:45]
    v_pk_add_f32 v[54:55], v[54:55], v[46:47]
    v_cvt_pk_bf16_f32 v156, v48, v49
    v_cvt_pk_bf16_f32 v157, v50, v51
    v_cvt_pk_bf16_f32 v158, v52, v53
    v_cvt_pk_bf16_f32 v159, v54, v55
    buffer_store_dwordx4 v[156:159], v152, s[52:55], s48 offen
    s_endpgm
K2_wot:
    s_waitcnt lgkmcnt(0)
    s_mov_b32 s16, s8
    s_mov_b32 s17, s9
    s_mov_b32 s18, 12582912
    s_mov_b32 s19, 0x20000
    s_mov_b32 s12, s10
    s_mov_b32 s13, s11
    s_mov_b32 s14, 819200
    s_mov_b32 s15, 0x20000
    s_sub_u32 s31, s25, 27
    s_lshl_b32 s31, s31, 2
    s_add_u32 s28, s31, s34
    s_mul_i32 s36, s28, 40960
    s_mul_i32 s32, s24, 160
    s_add_u32 s36, s36, s32
    s_mul_i32 s37, s24, 74
    s_add_u32 s37, s37, s28
    s_add_u32 s37, s37, 54
    s_mul_i32 s37, s37, 5120
    s_add_u32 s37, s37, 6291456
    s_setprio 0
    s_cmp_lg_u32 s34, 0
    s_cbranch_scc1 K2_pollB_w
    s_lshl_b32 s57, s26, 10
    s_add_u32 s57, s57, 12070912
    v_add_u32 v10, s57, v5
    s_mov_b32 s63, 0x40000
K2_pollB:
    buffer_load_dwordx4 v[16:19], v10, s[16:19], 0 offen sc1
    s_waitcnt vmcnt(0)
    v_and_b32 v16, v16, v17
    v_and_b32 v18, v18, v19
    v_and_b32 v16, v16, v18
    v_cmp_ne_u32 vcc, 1, v16
    s_cbranch_vccz K2_pollB_ok
    s_sleep 4
    s_sub_u32 s63, s63, 1
    s_cbranch_scc0 K2_pollB
K2_pollB_ok:
    s_waitcnt vmcnt(0)
K2_pollB_w:
    s_setprio 0
    s_barrier
    v_add_u32 v10, 0, v0
    v_mul_u32_u24 v11, 205, v10
    v_lshrrev_b32 v11, 11, v11
    v_mul_u32_u24 v12, 10, v11
    v_sub_u32 v12, v10, v12
    v_mul_u32_u24 v11, 1280, v11
    v_lshl_add_u32 v11, v12, 4, v11
    s_add_u32 m0, s35, 0
    s_nop 0
    buffer_load_dwordx4 v11, s[12:15], s36 offen lds
    v_add_u32 v10, 64, v0
    v_mul_u32_u24 v11, 205, v10
    v_lshrrev_b32 v11, 11, v11
    v_mul_u32_u24 v12, 10, v11
    v_sub_u32 v12, v10, v12
    v_mul_u32_u24 v11, 1280, v11
    v_lshl_add_u32 v11, v12, 4, v11
    s_add_u32 m0, s35, 1024
    s_nop 0
    buffer_load_dwordx4 v11, s[12:15], s36 offen lds
    v_add_u32 v10, 128, v0
    v_mul_u32_u24 v11, 205, v10
    v_lshrrev_b32 v11, 11, v11
    v_mul_u32_u24 v12, 10, v11
    v_sub_u32 v12, v10, v12
    v_mul_u32_u24 v11, 1280, v11
    v_lshl_add_u32 v11, v12, 4, v11
    s_add_u32 m0, s35, 2048
    s_nop 0
    buffer_load_dwordx4 v11, s[12:15], s36 offen lds
    v_add_u32 v10, 192, v0
    v_mul_u32_u24 v11, 205, v10
    v_lshrrev_b32 v11, 11, v11
    v_mul_u32_u24 v12, 10, v11
    v_sub_u32 v12, v10, v12
    v_mul_u32_u24 v11, 1280, v11
    v_lshl_add_u32 v11, v12, 4, v11
    s_add_u32 m0, s35, 3072
    s_nop 0
    buffer_load_dwordx4 v11, s[12:15], s36 offen lds
    v_add_u32 v10, 256, v0
    v_mul_u32_u24 v11, 205, v10
    v_lshrrev_b32 v11, 11, v11
    v_mul_u32_u24 v12, 10, v11
    v_sub_u32 v12, v10, v12
    v_mul_u32_u24 v11, 1280, v11
    v_lshl_add_u32 v11, v12, 4, v11
    s_add_u32 m0, s35, 4096
    s_nop 0
    buffer_load_dwordx4 v11, s[12:15], s36 offen lds
    v_and_b32 v1, 15, v0
    v_lshrrev_b32 v2, 4, v0
    v_lshrrev_b32 v10, 2, v1
    v_lshl_add_u32 v11, v2, 3, v10
    v_mul_u32_u24 v11, 160, v11
    v_and_b32 v12, 3, v1
    v_lshl_add_u32 v11, v12, 3, v11
    v_add_u32 v11, s35, v11
    v_lshlrev_b32 v12, 4, v0
    v_add_u32 v13, 4096, v12
    s_waitcnt vmcnt(0)
    ds_read_b64_tr_b16 v[16:17], v11 offset:0
    ds_read_b64_tr_b16 v[18:19], v11 offset:640
    ds_read_b64_tr_b16 v[20:21], v11 offset:32
    ds_read_b64_tr_b16 v[22:23], v11 offset:672
    ds_read_b64_tr_b16 v[24:25], v11 offset:64
    ds_read_b64_tr_b16 v[26:27], v11 offset:704
    ds_read_b64_tr_b16 v[28:29], v11 offset:96
    ds_read_b64_tr_b16 v[30:31], v11 offset:736
    ds_read_b64_tr_b16 v[32:33], v11 offset:128
    ds_read_b64_tr_b16 v[34:35], v11 offset:768
    s_waitcnt lgkmcnt(8)
    buffer_store_dwordx4 v[16:19], v12, s[16:19], s37 offen offset:0 sc1
    s_waitcnt lgkmcnt(6)
    buffer_store_dwordx4 v[20:23], v12, s[16:19], s37 offen offset:1024 sc1
    s_waitcnt lgkmcnt(4)
    buffer_store_dwordx4 v[24:27], v12, s[16:19], s37 offen offset:2048 sc1
    s_waitcnt lgkmcnt(2)
    buffer_store_dwordx4 v[28:31], v12, s[16:19], s37 offen offset:3072 sc1
    s_waitcnt lgkmcnt(0)
    buffer_store_dwordx4 v[32:35], v13, s[16:19], s37 offen sc1
    s_waitcnt vmcnt(0) lgkmcnt(0)
    s_mov_b64 exec, 1
    v_mov_b32 v10, 1
    ds_add_u32 v15, v10
    s_mov_b64 exec, -1
    s_waitcnt vmcnt(0) lgkmcnt(0)
    s_mov_b64 exec, 1
    v_mov_b32 v10, 1
    ds_add_u32 v15, v10
    s_mov_b64 exec, -1
    s_lshl_b32 s57, s24, 5
    s_add_u32 s57, s57, s25
    s_lshl_b32 s57, s57, 2
    s_add_u32 s57, s57, 12062720
    s_mov_b32 s63, 1048576
K2_pubW:
    ds_read_b32 v11, v15 offset:0
    s_waitcnt lgkmcnt(0)
    v_readfirstlane_b32 s31, v11
    s_nop 0
    s_cmp_ge_u32 s31, 8
    s_cbranch_scc1 K2_pubW_x
    s_sleep 1
    s_sub_u32 s63, s63, 1
    s_cbranch_scc0 K2_pubW
K2_pubW_x:
    s_cmp_lg_u32 s34, 0
    s_cbranch_scc1 K2_pubW_np
    s_mov_b64 exec, 255
    v_mov_b32 v10, 1
    v_lshl_add_u32 v11, v0, 10, s57
    buffer_store_dword v10, v11, s[16:19], 0 offen sc1
    s_mov_b64 exec, -1
K2_pubW_np:
    s_mov_b32 s12, s4
    s_mov_b32 s13, s5
    s_mov_b32 s14, 7077888
    s_mov_b32 s15, 0x20000
    v_lshlrev_b32 v10, 4, v0
    s_mul_i32 s36, s24, 27
    s_lshr_b32 s36, s36, 3
    s_lshl_b32 s36, s36, 7
    s_add_u32 s32, s28, 512
    s_mul_i32 s32, s32, 3456
    s_add_u32 s36, s36, s32
    s_add_u32 m0, s35, 9216
    s_mov_b32 exec_hi, 0xff
    buffer_load_dwordx4 v10, s[12:15], s36 offen lds
    s_add_u32 s36, s36, 69120
    buffer_load_dwordx4 v10, s[12:15], s36 offen lds
    s_add_u32 s36, s36, 69120
    buffer_load_dwordx4 v10, s[12:15], s36 offen lds
    s_add_u32 s36, s36, 69120
    buffer_load_dwordx4 v10, s[12:15], s36 offen lds
    s_add_u32 s36, s36, 69120
    buffer_load_dwordx4 v10, s[12:15], s36 offen lds
    s_add_u32 s36, s36, 69120
    buffer_load_dwordx4 v10, s[12:15], s36 offen lds
    s_add_u32 s36, s36, 69120
    buffer_load_dwordx4 v10, s[12:15], s36 offen lds
    s_add_u32 s36, s36, 69120
    buffer_load_dwordx4 v10, s[12:15], s36 offen lds
    s_add_u32 s36, s36, 69120
    buffer_load_dwordx4 v10, s[12:15], s36 offen lds
    s_add_u32 s36, s36, 69120
    buffer_load_dwordx4 v10, s[12:15], s36 offen lds
    s_add_u32 s36, s36, 69120
    buffer_load_dwordx4 v10, s[12:15], s36 offen lds
    s_add_u32 s36, s36, 69120
    buffer_load_dwordx4 v10, s[12:15], s36 offen lds
    s_add_u32 s36, s36, 69120
    buffer_load_dwordx4 v10, s[12:15], s36 offen lds
    s_add_u32 s36, s36, 69120
    buffer_load_dwordx4 v10, s[12:15], s36 offen lds
    s_add_u32 s36, s36, 69120
    buffer_load_dwordx4 v10, s[12:15], s36 offen lds
    s_add_u32 s36, s36, 69120
    buffer_load_dwordx4 v10, s[12:15], s36 offen lds
    s_add_u32 s36, s36, 69120
    buffer_load_dwordx4 v10, s[12:15], s36 offen lds
    s_add_u32 s36, s36, 69120
    s_waitcnt vmcnt(16)
    buffer_load_dwordx4 v10, s[12:15], s36 offen lds
    s_add_u32 s36, s36, 69120
    s_waitcnt vmcnt(16)
    buffer_load_dwordx4 v10, s[12:15], s36 offen lds
    s_add_u32 s36, s36, 69120
    s_waitcnt vmcnt(16)
    buffer_load_dwordx4 v10, s[12:15], s36 offen lds
    s_add_u32 s36, s36, 69120
    s_waitcnt vmcnt(16)
    buffer_load_dwordx4 v10, s[12:15], s36 offen lds
    s_add_u32 s36, s36, 69120
    s_waitcnt vmcnt(16)
    buffer_load_dwordx4 v10, s[12:15], s36 offen lds
    s_add_u32 s36, s36, 69120
    s_waitcnt vmcnt(16)
    buffer_load_dwordx4 v10, s[12:15], s36 offen lds
    s_add_u32 s36, s36, 69120
    s_waitcnt vmcnt(16)
    buffer_load_dwordx4 v10, s[12:15], s36 offen lds
    s_add_u32 s36, s36, 69120
    s_waitcnt vmcnt(16)
    buffer_load_dwordx4 v10, s[12:15], s36 offen lds
    s_add_u32 s36, s36, 69120
    s_waitcnt vmcnt(16)
    buffer_load_dwordx4 v10, s[12:15], s36 offen lds
    s_add_u32 s36, s36, 69120
    s_waitcnt vmcnt(16)
    buffer_load_dwordx4 v10, s[12:15], s36 offen lds
    s_add_u32 s36, s36, 69120
    s_waitcnt vmcnt(16)
    buffer_load_dwordx4 v10, s[12:15], s36 offen lds
    s_add_u32 s36, s36, 69120
    s_waitcnt vmcnt(16)
    buffer_load_dwordx4 v10, s[12:15], s36 offen lds
    s_add_u32 s36, s36, 69120
    s_waitcnt vmcnt(16)
    buffer_load_dwordx4 v10, s[12:15], s36 offen lds
    s_add_u32 s36, s36, 69120
    s_waitcnt vmcnt(16)
    buffer_load_dwordx4 v10, s[12:15], s36 offen lds
    s_add_u32 s36, s36, 69120
    s_waitcnt vmcnt(16)
    buffer_load_dwordx4 v10, s[12:15], s36 offen lds
    s_add_u32 s36, s36, 69120
    s_waitcnt vmcnt(16)
    buffer_load_dwordx4 v10, s[12:15], s36 offen lds
    s_add_u32 s36, s36, 69120
    s_waitcnt vmcnt(16)
    buffer_load_dwordx4 v10, s[12:15], s36 offen lds
    s_add_u32 s36, s36, 69120
    s_waitcnt vmcnt(16)
    buffer_load_dwordx4 v10, s[12:15], s36 offen lds
    s_add_u32 s36, s36, 69120
    s_waitcnt vmcnt(16)
    buffer_load_dwordx4 v10, s[12:15], s36 offen lds
    s_add_u32 s36, s36, 69120
    s_waitcnt vmcnt(16)
    buffer_load_dwordx4 v10, s[12:15], s36 offen lds
    s_add_u32 s36, s36, 69120
    s_waitcnt vmcnt(16)
    buffer_load_dwordx4 v10, s[12:15], s36 offen lds
    s_add_u32 s36, s36, 69120
    s_waitcnt vmcnt(16)
    buffer_load_dwordx4 v10, s[12:15], s36 offen lds
    s_add_u32 s36, s36, 69120
    s_waitcnt vmcnt(16)
    buffer_load_dwordx4 v10, s[12:15], s36 offen lds
    s_add_u32 s36, s36, 69120
    s_waitcnt vmcnt(16)
    buffer_load_dwordx4 v10, s[12:15], s36 offen lds
    s_add_u32 s36, s36, 69120
    s_waitcnt vmcnt(16)
    buffer_load_dwordx4 v10, s[12:15], s36 offen lds
    s_add_u32 s36, s36, 69120
    s_waitcnt vmcnt(16)
    buffer_load_dwordx4 v10, s[12:15], s36 offen lds
    s_add_u32 s36, s36, 69120
    s_waitcnt vmcnt(16)
    buffer_load_dwordx4 v10, s[12:15], s36 offen lds
    s_add_u32 s36, s36, 69120
    s_waitcnt vmcnt(16)
    buffer_load_dwordx4 v10, s[12:15], s36 offen lds
    s_add_u32 s36, s36, 69120
    s_waitcnt vmcnt(16)
    buffer_load_dwordx4 v10, s[12:15], s36 offen lds
    s_add_u32 s36, s36, 69120
    s_waitcnt vmcnt(16)
    buffer_load_dwordx4 v10, s[12:15], s36 offen lds
    s_add_u32 s36, s36, 69120
    s_waitcnt vmcnt(16)
    buffer_load_dwordx4 v10, s[12:15], s36 offen lds
    s_add_u32 s36, s36, 69120
    s_waitcnt vmcnt(16)
    buffer_load_dwordx4 v10, s[12:15], s36 offen lds
    s_add_u32 s36, s36, 69120
    s_waitcnt vmcnt(16)
    buffer_load_dwordx4 v10, s[12:15], s36 offen lds
    s_add_u32 s36, s36, 69120
    s_waitcnt vmcnt(16)
    buffer_load_dwordx4 v10, s[12:15], s36 offen lds
    s_add_u32 s36, s36, 69120
    s_waitcnt vmcnt(16)
    buffer_load_dwordx4 v10, s[12:15], s36 offen lds
    s_add_u32 s36, s36, 69120
    s_waitcnt vmcnt(16)
    buffer_load_dwordx4 v10, s[12:15], s36 offen lds
    s_add_u32 s36, s36, 69120
    s_waitcnt vmcnt(16)
    buffer_load_dwordx4 v10, s[12:15], s36 offen lds
    s_add_u32 s36, s36, 69120
    s_waitcnt vmcnt(16)
    buffer_load_dwordx4 v10, s[12:15], s36 offen lds
    s_add_u32 s36, s36, 69120
    s_waitcnt vmcnt(16)
    buffer_load_dwordx4 v10, s[12:15], s36 offen lds
    s_add_u32 s36, s36, 69120
    s_waitcnt vmcnt(16)
    buffer_load_dwordx4 v10, s[12:15], s36 offen lds
    s_add_u32 s36, s36, 69120
    s_waitcnt vmcnt(16)
    buffer_load_dwordx4 v10, s[12:15], s36 offen lds
    s_add_u32 s36, s36, 69120
    s_waitcnt vmcnt(16)
    buffer_load_dwordx4 v10, s[12:15], s36 offen lds
    s_add_u32 s36, s36, 69120
    s_waitcnt vmcnt(16)
    buffer_load_dwordx4 v10, s[12:15], s36 offen lds
    s_add_u32 s36, s36, 69120
    s_waitcnt vmcnt(16)
    buffer_load_dwordx4 v10, s[12:15], s36 offen lds
    s_add_u32 s36, s36, 69120
    s_waitcnt vmcnt(16)
    buffer_load_dwordx4 v10, s[12:15], s36 offen lds
    s_add_u32 s36, s36, 69120
    s_waitcnt vmcnt(16)
    buffer_load_dwordx4 v10, s[12:15], s36 offen lds
    s_add_u32 s36, s36, 69120
    s_waitcnt vmcnt(16)
    buffer_load_dwordx4 v10, s[12:15], s36 offen lds
    s_add_u32 s36, s36, 69120
    s_waitcnt vmcnt(16)
    buffer_load_dwordx4 v10, s[12:15], s36 offen lds
    s_add_u32 s36, s36, 69120
    s_waitcnt vmcnt(16)
    buffer_load_dwordx4 v10, s[12:15], s36 offen lds
    s_add_u32 s36, s36, 69120
    s_waitcnt vmcnt(16)
    buffer_load_dwordx4 v10, s[12:15], s36 offen lds
    s_add_u32 s36, s36, 69120
    s_waitcnt vmcnt(16)
    buffer_load_dwordx4 v10, s[12:15], s36 offen lds
    s_add_u32 s36, s36, 69120
    s_waitcnt vmcnt(16)
    buffer_load_dwordx4 v10, s[12:15], s36 offen lds
    s_add_u32 s36, s36, 69120
    s_waitcnt vmcnt(16)
    buffer_load_dwordx4 v10, s[12:15], s36 offen lds
    s_add_u32 s36, s36, 69120
    s_waitcnt vmcnt(16)
    buffer_load_dwordx4 v10, s[12:15], s36 offen lds
    s_add_u32 s36, s36, 69120
    s_waitcnt vmcnt(16)
    buffer_load_dwordx4 v10, s[12:15], s36 offen lds
    s_add_u32 s36, s36, 69120
    s_waitcnt vmcnt(16)
    buffer_load_dwordx4 v10, s[12:15], s36 offen lds
    s_add_u32 s36, s36, 69120
    s_waitcnt vmcnt(16)
    buffer_load_dwordx4 v10, s[12:15], s36 offen lds
    s_add_u32 s36, s36, 69120
    s_waitcnt vmcnt(16)
    buffer_load_dwordx4 v10, s[12:15], s36 offen lds
    s_add_u32 s36, s36, 69120
    s_waitcnt vmcnt(16)
    buffer_load_dwordx4 v10, s[12:15], s36 offen lds
    s_add_u32 s36, s36, 69120
    s_waitcnt vmcnt(16)
    buffer_load_dwordx4 v10, s[12:15], s36 offen lds
    s_add_u32 s36, s36, 69120
    s_waitcnt vmcnt(16)
    s_mov_b32 exec_hi, -1
    s_mov_b32 s12, s68
    s_mov_b32 s13, s69
    s_mov_b32 s14, 7077888
    s_mov_b32 s15, 0x20000
    v_lshrrev_b32 v10, 5, v0
    v_and_b32 v11, 31, v0
    v_lshlrev_b32 v10, 12, v10
    v_lshl_add_u32 v10, v11, 4, v10
    s_lshl_b32 s36, s24, 9
    s_lshl_b32 s32, s28, 13
    s_add_u32 s36, s36, s32
    s_add_u32 m0, s35, 9216
    s_nop 0
    buffer_load_dwordx4 v10, s[12:15], s36 offen lds
    s_add_u32 s36, s36, 163840
    buffer_load_dwordx4 v10, s[12:15], s36 offen lds
    s_add_u32 s36, s36, 163840
    buffer_load_dwordx4 v10, s[12:15], s36 offen lds
    s_add_u32 s36, s36, 163840
    buffer_load_dwordx4 v10, s[12:15], s36 offen lds
    s_add_u32 s36, s36, 163840
    buffer_load_dwordx4 v10, s[12:15], s36 offen lds
    s_add_u32 s36, s36, 163840
    buffer_load_dwordx4 v10, s[12:15], s36 offen lds
    s_add_u32 s36, s36, 163840
    buffer_load_dwordx4 v10, s[12:15], s36 offen lds
    s_add_u32 s36, s36, 163840
    buffer_load_dwordx4 v10, s[12:15], s36 offen lds
    s_add_u32 s36, s36, 163840
    buffer_load_dwordx4 v10, s[12:15], s36 offen lds
    s_add_u32 s36, s36, 163840
    buffer_load_dwordx4 v10, s[12:15], s36 offen lds
    s_add_u32 s36, s36, 163840
    buffer_load_dwordx4 v10, s[12:15], s36 offen lds
    s_add_u32 s36, s36, 163840
    buffer_load_dwordx4 v10, s[12:15], s36 offen lds
    s_add_u32 s36, s36, 163840
    buffer_load_dwordx4 v10, s[12:15], s36 offen lds
    s_add_u32 s36, s36, 163840
    s_waitcnt vmcnt(12)
    buffer_load_dwordx4 v10, s[12:15], s36 offen lds
    s_add_u32 s36, s36, 163840
    s_waitcnt vmcnt(12)
    buffer_load_dwordx4 v10, s[12:15], s36 offen lds
    s_add_u32 s36, s36, 163840
    s_waitcnt vmcnt(12)
    buffer_load_dwordx4 v10, s[12:15], s36 offen lds
    s_add_u32 s36, s36, 163840
    s_waitcnt vmcnt(12)
    buffer_load_dwordx4 v10, s[12:15], s36 offen lds
    s_add_u32 s36, s36, 163840
    s_waitcnt vmcnt(12)
    buffer_load_dwordx4 v10, s[12:15], s36 offen lds
    s_add_u32 s36, s36, 163840
    s_waitcnt vmcnt(12)
    buffer_load_dwordx4 v10, s[12:15], s36 offen lds
    s_add_u32 s36, s36, 163840
    s_waitcnt vmcnt(12)
    buffer_load_dwordx4 v10, s[12:15], s36 offen lds
    s_add_u32 s36, s36, 163840
    s_waitcnt vmcnt(12)
    buffer_load_dwordx4 v10, s[12:15], s36 offen lds
    s_add_u32 s36, s36, 163840
    s_waitcnt vmcnt(12)
    buffer_load_dwordx4 v10, s[12:15], s36 offen lds
    s_add_u32 s36, s36, 163840
    s_waitcnt vmcnt(12)
    buffer_load_dwordx4 v10, s[12:15], s36 offen lds
    s_add_u32 s36, s36, 163840
    s_waitcnt vmcnt(12)
    buffer_load_dwordx4 v10, s[12:15], s36 offen lds
    s_add_u32 s36, s36, 163840
    s_waitcnt vmcnt(12)
    buffer_load_dwordx4 v10, s[12:15], s36 offen lds
    s_add_u32 s36, s36, 163840
    s_waitcnt vmcnt(12)
    buffer_load_dwordx4 v10, s[12:15], s36 offen lds
    s_add_u32 s36, s36, 163840
    s_waitcnt vmcnt(12)
    buffer_load_dwordx4 v10, s[12:15], s36 offen lds
    s_add_u32 s36, s36, 163840
    s_waitcnt vmcnt(12)
    buffer_load_dwordx4 v10, s[12:15], s36 offen lds
    s_add_u32 s36, s36, 163840
    s_waitcnt vmcnt(12)
    buffer_load_dwordx4 v10, s[12:15], s36 offen lds
    s_add_u32 s36, s36, 163840
    s_waitcnt vmcnt(12)
    buffer_load_dwordx4 v10, s[12:15], s36 offen lds
    s_add_u32 s36, s36, 163840
    s_waitcnt vmcnt(12)
    buffer_load_dwordx4 v10, s[12:15], s36 offen lds
    s_add_u32 s36, s36, 163840
    s_waitcnt vmcnt(12)
    buffer_load_dwordx4 v10, s[12:15], s36 offen lds
    s_add_u32 s36, s36, 163840
    s_waitcnt vmcnt(12)
    buffer_load_dwordx4 v10, s[12:15], s36 offen lds
    s_add_u32 s36, s36, 163840
    s_waitcnt vmcnt(12)
    buffer_load_dwordx4 v10, s[12:15], s36 offen lds
    s_add_u32 s36, s36, 163840
    s_waitcnt vmcnt(12)
    buffer_load_dwordx4 v10, s[12:15], s36 offen lds
    s_add_u32 s36, s36, 163840
    s_waitcnt vmcnt(12)
    buffer_load_dwordx4 v10, s[12:15], s36 offen lds
    s_add_u32 s36, s36, 163840
    s_waitcnt vmcnt(12)
    buffer_load_dwordx4 v10, s[12:15], s36 offen lds
    s_add_u32 s36, s36, 163840
    s_waitcnt vmcnt(12)
    buffer_load_dwordx4 v10, s[12:15], s36 offen lds
    s_add_u32 s36, s36, 163840
    s_waitcnt vmcnt(12)
    buffer_load_dwordx4 v10, s[12:15], s36 offen lds
    s_add_u32 s36, s36, 163840
    s_waitcnt vmcnt(12)
    buffer_load_dwordx4 v10, s[12:15], s36 offen lds
    s_add_u32 s36, s36, 163840
    s_waitcnt vmcnt(12)
    buffer_load_dwordx4 v10, s[12:15], s36 offen lds
    s_add_u32 s36, s36, 163840
    s_waitcnt vmcnt(12)
    buffer_load_dwordx4 v10, s[12:15], s36 offen lds
    s_add_u32 s36, s36, 163840
    s_waitcnt vmcnt(12)
    buffer_load_dwordx4 v10, s[12:15], s36 offen lds
    s_add_u32 s36, s36, 163840
    s_waitcnt vmcnt(12)
    buffer_load_dwordx4 v10, s[12:15], s36 offen lds
    s_add_u32 s36, s36, 163840
    s_waitcnt vmcnt(12)
    v_and_b32 v96, 15, v0
    v_lshrrev_b32 v97, 4, v0
    v_lshrrev_b32 v10, 2, v96
    v_and_b32 v13, 1, v96
    v_lshl_add_u32 v13, v13, 3, s35
    v_lshl_add_u32 v11, v97, 3, v10
    v_lshl_add_u32 v6, v11, 7, v13
    v_bfe_u32 v11, v96, 3, 1
    v_lshlrev_b32 v11, 2, v11
    v_bfe_u32 v12, v96, 1, 1
    v_and_b32 v13, 1, v97
    v_lshl_or_b32 v11, v13, 1, v11
    v_xor_b32 v11, v12, v11
    v_lshl_add_u32 v6, v11, 4, v6
    v_xor_b32 v7, 32, v6
    v_xor_b32 v8, 64, v6
    v_xor_b32 v9, 96, v6
    s_add_u32 s31, s35, 4096
    v_lshl_add_u32 v13, v0, 4, s31
    s_waitcnt vmcnt(0)
    s_branch K2_merge2
K2_end:
    s_endpgm
K2_text_end:
.section .rodata,"a"
.p2align 6
K_desc:
.p2align 6
.amdhsa_kernel parallel_sum__grouped_kv_mqa__mixer_token_mlp__prompt_kernel
  .amdhsa_next_free_vgpr 168
  .amdhsa_next_free_sgpr 76
  .amdhsa_accum_offset 168
  .amdhsa_group_segment_fixed_size 0
  .amdhsa_kernarg_size 104
  .amdhsa_user_sgpr_count 2
  .amdhsa_user_sgpr_kernarg_segment_ptr 1
  .amdhsa_system_sgpr_workgroup_id_x 1
.end_amdhsa_kernel
```
